```python
import torch

def _softmax(x, axis=-1):
    return torch.softmax(x, dim=axis)
def _gelu(x):
    return torch.nn.functional.gelu(x, approximate="tanh")
def _silu(x):
    return torch.nn.functional.silu(x)
def _sigmoid(x):
    return torch.sigmoid(x)
def _layernorm(x, axis=-1, eps=1e-5):
    m = x.mean(dim=axis, keepdim=True)
    v = x.var(dim=axis, keepdim=True, unbiased=False)
    return (x - m) / torch.sqrt(v + eps)
def _scatter_add(tgt, idx, src, axis=0):
    return tgt.clone().index_add_(axis, idx, src)
def _segment_sum(src, seg, n):
    out = torch.zeros((n,) + src.shape[1:], dtype=src.dtype)
    return out.index_add_(0, seg, src)
def _pad(x, pw):
    flat = tuple(v for pair in reversed(pw) for v in pair)
    return torch.nn.functional.pad(x, flat)

kernel_name = 'parallel_sum__linear_attn_block__mixer_channel_mlp__prompt'

def setup_inputs():

    _w = (lambda a: (lambda t: t.to(torch.bfloat16) if t.is_floating_point() else t)(torch.as_tensor(a)))
    def _A_setup():
        B, S, D = 1, 2048, 640
        return {
            "x": _w((lambda *s: torch.randn(*s, dtype=torch.bfloat16) * 0.05)(B, S, D)),
            "wqkv": _w((lambda *s: torch.randn(*s, dtype=torch.bfloat16) * 0.1)(D, 3 * D)),
            "wo": _w((lambda *s: torch.randn(*s, dtype=torch.bfloat16) * 0.05)(D, D)),
        }
    _A_in = _A_setup()

    def _B_setup():
        B, S, D, F = 1, 2048, 640, 1728
        return {
            "x": _w((lambda *s: torch.randn(*s, dtype=torch.bfloat16) * 0.05)(B, S, D)),
            "w1": _w((lambda *s: torch.randn(*s, dtype=torch.bfloat16) * 1.6)(D, F) * (D ** -0.5)),
            "b1": _w((lambda *s: torch.randn(*s, dtype=torch.bfloat16) * 0.8)(F)),
            "w2": _w((lambda *s: torch.randn(*s, dtype=torch.bfloat16) * 0.05)(F, D) * (F ** -0.5)),
            "b2": _w((lambda *s: torch.randn(*s, dtype=torch.bfloat16) * 0.05)(D)),
        }
    _B_in = _B_setup()

    return {
        "A_x": _A_in["x"],
        "A_wqkv": _A_in["wqkv"],
        "A_wo": _A_in["wo"],
        "B_x": _B_in["x"],
        "B_w1": _B_in["w1"],
        "B_b1": _B_in["b1"],
        "B_w2": _B_in["w2"],
        "B_b2": _B_in["b2"],
    }

def reference(A_x, A_wqkv, A_wo, B_x, B_w1, B_b1, B_w2, B_b2):
    def _A_ref(x, wqkv, wo):
        B, S, D = x.shape
        H = 32; Dh = D // H
        qkv = (lambda x, *d: x.permute(*d))((x @ wqkv).reshape(B, S, 3, H, Dh), 2, 0, 3, 1, 4)
        q, k, v = qkv[0], qkv[1], qkv[2]
        phi = lambda t: torch.where(t > 0, t + 1, torch.exp(t)) + 1e-6
        pq, pk = phi(q), phi(k)
        kv = torch.einsum("bhsd,bhse->bhde", pk, v)
        z = torch.einsum("bhsd->bhd", pk)
        num = torch.einsum("bhqd,bhde->bhqe", pq, kv)
        den = torch.einsum("bhqd,bhd->bhq", pq, z)[..., None] + 1e-6
        o = num / den
        return (lambda x, *d: x.permute(*d))(o, 0, 2, 1, 3).reshape(B, S, D) @ wo

    def _B_ref(x, w1, b1, w2, b2):
        y = _layernorm(x, axis=-1)
        h = _gelu(torch.einsum("bsd,df->bsf", y, w1) + b1)
        return torch.einsum("bsf,fd->bsd", h, w2) + b2

    x = A_x
    xn = _layernorm(x, axis=-1)
    return x + _A_ref(xn, A_wqkv, A_wo) + _B_ref(xn, B_w1, B_b1, B_w2, B_b2)
```

```asm
; @launch grid=(256,1,1) block=(512,1,1) lds=163840
.amdgcn_target "amdgcn-amd-amdhsa--gfx950"
.text
.globl parallel_sum__linear_attn_block__mixer_channel_mlp__prompt_kernel
.p2align 8
.type parallel_sum__linear_attn_block__mixer_channel_mlp__prompt_kernel,@function
parallel_sum__linear_attn_block__mixer_channel_mlp__prompt_kernel:
    s_cmp_ge_u32 s2, 256
    s_cbranch_scc1 END
    s_load_dwordx16 s[4:19], s[0:1], 0
    s_load_dwordx4 s[20:23], s[0:1], 64
    s_load_dwordx2 s[24:25], s[0:1], 80
    v_lshrrev_b32 v104, 6, v0
    v_and_b32 v1, 63, v0
    v_readfirstlane_b32 s44, v104
    s_and_b32 s47, s2, 7
    s_lshr_b32 s48, s2, 7
    s_bfe_u32 s46, s2, 0x40003
    v_mov_b32 v2, 0
    v_lshlrev_b32 v6, 4, v1
    s_and_b32 s45, s44, 3
    s_mul_i32 s57, s47, 7
    s_min_u32 s57, s57, 47
    s_lshl_b32 s57, s57, 5
    s_mul_i32 s58, s47, 80
    s_cmp_eq_u32 s48, 0
    s_cselect_b32 s49, s58, s57
    s_lshr_b32 s57, s44, 2
    s_lshl_b32 s58, s48, 1
    s_add_u32 s60, s57, s58
    s_cmp_eq_u32 s60, 0
    s_cbranch_scc1 ROLE_KV
    s_cmp_eq_u32 s60, 2
    s_cbranch_scc1 ROLE_H0
    s_cmp_eq_u32 s60, 3
    s_cbranch_scc1 ROLE_H1
    s_mov_b32 s79, 0
    v_lshrrev_b32 v104, 3, v1
    s_lshl_b32 s57, s45, 3
    s_lshl_b32 s58, s46, 7
    s_add_u32 s57, s57, s58
    v_add_u32 v104, s57, v104
    v_mul_u32_u24 v218, 1280, v104
    v_lshrrev_b32 v104, 1, v104
    v_xor_b32 v104, v104, v1
    v_and_b32 v104, 7, v104
    v_lshl_add_u32 v218, v104, 4, v218
    s_lshl_b32 s54, s45, 10
    v_bfe_u32 v104, v1, 2, 2
    v_lshrrev_b32 v105, 4, v1
    v_and_b32 v109, 3, v1
    s_lshl_b32 s57, s47, 1
    s_add_u32 s57, s57, s48
    s_add_u32 s57, s57, s46
    s_mul_i32 s58, s57, 26
    s_lshr_b32 s58, s58, 8
    s_mul_i32 s58, s58, 10
    s_sub_u32 s57, s57, s58
    s_lshl_b32 s50, s57, 7
    s_mul_i32 s51, s57, 245760
    s_add_u32 s55, s54, 16384
    s_lshr_b32 s57, s45, 1
    s_lshl_b32 s57, s57, 2
    v_add_u32 v104, s57, v104
    v_mul_u32_u24 v104, 3840, v104
    s_and_b32 s57, s45, 1
    s_lshl_b32 s57, s57, 4
    v_lshl_add_u32 v109, v105, 2, v109
    v_add_u32 v112, s57, v109
    s_lshl_b32 s57, s49, 1
    v_xor_b32 v109, 0, v112
    v_mov_b32 v110, 0
    v_mov_b32 v111, 2130706432
    v_cmp_le_u32 vcc, 10, v109
    s_nop 1
    v_cndmask_b32 v110, v110, v111, vcc
    v_mov_b32 v111, 1088
    v_cmp_le_u32 vcc, 12, v109
    s_nop 1
    v_cndmask_b32 v110, v110, v111, vcc
    v_mov_b32 v111, 2208
    v_cmp_le_u32 vcc, 22, v109
    s_nop 1
    v_cndmask_b32 v110, v110, v111, vcc
    v_lshl_add_u32 v109, v109, 4, v110
    v_add3_u32 v219, v104, v109, s57
    v_xor_b32 v109, 2, v112
    v_mov_b32 v110, 0
    v_mov_b32 v111, 2130706432
    v_cmp_le_u32 vcc, 10, v109
    s_nop 1
    v_cndmask_b32 v110, v110, v111, vcc
    v_mov_b32 v111, 1088
    v_cmp_le_u32 vcc, 12, v109
    s_nop 1
    v_cndmask_b32 v110, v110, v111, vcc
    v_mov_b32 v111, 2208
    v_cmp_le_u32 vcc, 22, v109
    s_nop 1
    v_cndmask_b32 v110, v110, v111, vcc
    v_lshl_add_u32 v109, v109, 4, v110
    v_add3_u32 v220, v104, v109, s57
    s_waitcnt lgkmcnt(0)
    s_mov_b32 s28, s4
    s_mov_b32 s29, s5
    s_mov_b32 s30, 2621440
    s_mov_b32 s31, 0x20000
    s_mov_b32 s36, s24
    s_mov_b32 s37, s25
    s_mov_b32 s38, 12866560
    s_mov_b32 s39, 0x20000
    s_add_u32 s10, s24, 12812288
    s_addc_u32 s11, s25, 0
    s_mov_b32 s32, s6
    s_mov_b32 s33, s7
    s_mov_b32 s34, 2457600
    s_mov_b32 s35, 0x20000
    s_add_u32 m0, s55, 0
    s_add_u32 s53, s51, 0
    buffer_load_dwordx4 v219, s[32:35], s53 offen lds
    s_add_u32 m0, s54, 0
    s_add_u32 s53, s50, 0
    buffer_load_dwordx4 v218, s[28:31], s53 offen lds
    s_add_u32 m0, s55, 4096
    s_add_u32 s53, s51, 30720
    buffer_load_dwordx4 v220, s[32:35], s53 offen lds
    s_add_u32 m0, s55, 8192
    s_add_u32 s53, s51, 61440
    buffer_load_dwordx4 v219, s[32:35], s53 offen lds
    s_add_u32 m0, s54, 4096
    s_add_u32 s53, s50, 40960
    buffer_load_dwordx4 v218, s[28:31], s53 offen lds
    v_and_b32 v140, 15, v1
    s_lshl_b32 s57, s45, 5
    v_add_u32 v140, s57, v140
    v_bfe_u32 v141, v140, 1, 3
    v_lshrrev_b32 v142, 4, v1
    v_xor_b32 v141, v141, v142
    v_lshlrev_b32 v141, 4, v141
    v_lshl_add_u32 v194, v140, 7, v141
    v_mul_u32_u24 v140, 4096, v142
    v_and_b32 v142, 1, v142
    v_lshl_add_u32 v140, v142, 5, v140
    v_bfe_u32 v141, v1, 2, 2
    v_lshl_add_u32 v140, v141, 6, v140
    v_and_b32 v141, 3, v1
    v_lshl_add_u32 v140, v141, 3, v140
    v_add_u32 v197, 16384, v140
    s_min_u32 s57, s44, 7
    s_lshl_b32 s57, s57, 8
    s_add_u32 s57, s57, 16384
    v_add_u32 v226, s57, v140
    v_xor_b32 v227, 32, v226
    v_mov_b32 v136, 0x3f803f80
    v_mov_b32 v137, 0x3f803f80
    v_mov_b32 v138, 0x3f803f80
    v_mov_b32 v139, 0x3f803f80
    s_and_b32 s57, s2, 3
    s_lshl_b32 s57, s57, 3
    s_bfe_u32 s58, s2, 0x30003
    s_add_u32 s67, s57, s58
    s_bfe_u32 s57, s2, 0x10002
    s_lshl_b32 s57, s57, 2
    s_lshr_b32 s58, s2, 6
    s_add_u32 s68, s57, s58
    s_lshl_b32 s57, s45, 3
    s_lshr_b32 s70, 0x302a231c, s57
    s_and_b32 s70, s70, 255
    s_cmp_eq_u32 s48, 0
    s_cselect_b32 s60, 0, 0
    s_mul_i32 s57, s44, 7
    s_add_u32 s58, s70, s60
    s_cmp_lt_u32 s44, 6
    s_cselect_b32 s59, 7, 6
    s_sub_u32 s59, s59, s60
    s_cmp_lt_u32 s44, 4
    s_cselect_b32 s69, s57, s58
    s_cselect_b32 s73, 7, s59
    s_cselect_b32 s71, s60, 0
    s_and_b32 s57, s44, 1
    s_sub_u32 s74, 3, s57
    s_mul_i32 s57, s57, 3
    s_lshr_b32 s58, s44, 1
    s_mul_i32 s58, s58, 5
    s_add_u32 s57, s57, s58
    s_add_u32 s72, s57, 54
    s_and_b32 s57, s68, 3
    s_mul_i32 s75, s57, 2
    s_mul_i32 s76, s57, 1
    s_cmp_ge_u32 s75, s73
    s_cselect_b32 s57, s73, 0
    s_sub_u32 s75, s75, s57
    s_cmp_ge_u32 s75, s73
    s_cselect_b32 s57, s73, 0
    s_sub_u32 s75, s75, s57
    s_cmp_ge_u32 s76, s74
    s_cselect_b32 s57, s74, 0
    s_sub_u32 s76, s76, s57
    s_cmp_ge_u32 s76, s74
    s_cselect_b32 s57, s74, 0
    s_sub_u32 s76, s76, s57
    s_cmp_ge_u32 s76, s74
    s_cselect_b32 s57, s74, 0
    s_sub_u32 s76, s76, s57
    s_mul_i32 s77, s67, 303104
    s_mul_i32 s78, s68, 378880
    s_add_u32 s78, s78, 9699328
    v_mov_b32 v198, 0x3586
    v_mov_b32 v148, 47680
    v_and_b32 v140, 15, v1
    v_lshrrev_b32 v141, 4, v1
    v_lshlrev_b32 v141, 2, v141
    v_cmp_eq_u32 s[86:87], 0, v140
    s_movk_i32 s60, 84
    s_lshl_b32 s57, s44, 1
    s_add_u32 s57, s57, -10
    s_cmp_lt_u32 s44, 5
    s_cselect_b32 s58, s44, s57
    s_add_u32 s59, s44, -1
    s_lshl_b32 s57, s58, 4
    v_add_u32 v142, s57, v141
    s_lshl_b32 s57, s59, 4
    v_add_u32 v143, s57, v140
    v_mul_u32_u24 v144, 3277, v142
    v_lshrrev_b32 v144, 16, v144
    v_mul_u32_u24 v145, 3277, v143
    v_lshrrev_b32 v145, 16, v145
    v_mul_u32_u24 v146, 20, v145
    v_sub_u32 v146, v143, v146
    v_cmp_eq_u32 vcc, v144, v145
    s_nop 0
    s_mov_b64 s[88:89], vcc
    v_cmp_gt_u32 vcc, 80, v143
    s_nop 0
    s_and_b64 s[88:89], s[88:89], vcc
    s_cmp_lt_u32 s44, 5
    s_cselect_b64 s[88:89], s[88:89], s[86:87]
    s_cselect_b64 s[90:91], 0, -1
    v_cndmask_b32 v146, v146, 20, s[90:91]
    v_cmp_gt_u32 vcc, 80, v142
    s_nop 0
    s_and_b64 vcc, vcc, s[88:89]
    v_lshlrev_b32 v146, 2, v146
    v_mad_u32_u24 v146, v142, s60, v146
    v_add_u32 v146, 40960, v146
    v_cndmask_b32 v7, v148, v146, vcc
    s_lshl_b32 s57, s44, 1
    s_add_u32 s57, s57, -9
    s_cmp_lt_u32 s44, 5
    s_cselect_b32 s58, s44, s57
    s_add_u32 s59, s44, 0
    s_lshl_b32 s57, s58, 4
    v_add_u32 v142, s57, v141
    s_lshl_b32 s57, s59, 4
    v_add_u32 v143, s57, v140
    v_mul_u32_u24 v144, 3277, v142
    v_lshrrev_b32 v144, 16, v144
    v_mul_u32_u24 v145, 3277, v143
    v_lshrrev_b32 v145, 16, v145
    v_mul_u32_u24 v146, 20, v145
    v_sub_u32 v146, v143, v146
    v_cmp_eq_u32 vcc, v144, v145
    s_nop 0
    s_mov_b64 s[88:89], vcc
    v_cmp_gt_u32 vcc, 80, v143
    s_nop 0
    s_and_b64 s[88:89], s[88:89], vcc
    s_cmp_lt_u32 s44, 5
    s_cselect_b64 s[88:89], s[88:89], s[86:87]
    s_cselect_b64 s[90:91], 0, -1
    v_cndmask_b32 v146, v146, 20, s[90:91]
    v_cmp_gt_u32 vcc, 80, v142
    s_nop 0
    s_and_b64 vcc, vcc, s[88:89]
    v_lshlrev_b32 v146, 2, v146
    v_mad_u32_u24 v146, v142, s60, v146
    v_add_u32 v146, 40960, v146
    v_cndmask_b32 v8, v148, v146, vcc
    s_lshl_b32 s57, s44, 1
    s_add_u32 s57, s57, -8
    s_cmp_lt_u32 s44, 5
    s_cselect_b32 s58, s44, s57
    s_add_u32 s59, s44, 1
    s_lshl_b32 s57, s58, 4
    v_add_u32 v142, s57, v141
    s_lshl_b32 s57, s59, 4
    v_add_u32 v143, s57, v140
    v_mul_u32_u24 v144, 3277, v142
    v_lshrrev_b32 v144, 16, v144
    v_mul_u32_u24 v145, 3277, v143
    v_lshrrev_b32 v145, 16, v145
    v_mul_u32_u24 v146, 20, v145
    v_sub_u32 v146, v143, v146
    v_cmp_eq_u32 vcc, v144, v145
    s_nop 0
    s_mov_b64 s[88:89], vcc
    v_cmp_gt_u32 vcc, 80, v143
    s_nop 0
    s_and_b64 s[88:89], s[88:89], vcc
    s_cmp_lt_u32 s44, 5
    s_cselect_b64 s[88:89], s[88:89], 0
    s_cselect_b64 s[90:91], 0, -1
    v_cndmask_b32 v146, v146, 20, s[90:91]
    v_cmp_gt_u32 vcc, 80, v142
    s_nop 0
    s_and_b64 vcc, vcc, s[88:89]
    v_lshlrev_b32 v146, 2, v146
    v_mad_u32_u24 v146, v142, s60, v146
    v_add_u32 v146, 40960, v146
    v_cndmask_b32 v9, v148, v146, vcc
    v_add_u32 v140, -256, v0
    v_mul_u32_u24 v141, 3121, v140
    v_lshrrev_b32 v141, 16, v141
    v_mul_u32_u24 v142, 21, v141
    v_sub_u32 v142, v140, v142
    v_mul_u32_u24 v143, 3277, v141
    v_lshrrev_b32 v143, 16, v143
    v_mad_u32_u24 v144, v143, 20, v142
    v_lshrrev_b32 v145, 4, v144
    v_and_b32 v144, 15, v144
    v_cmp_le_u32 vcc, 3, v145
    s_nop 1
    v_cndmask_b32 v146, 1, 2, vcc
    v_lshlrev_b32 v145, 1, v145
    v_sub_u32 v145, v145, v146
    v_max_i32 v145, 0, v145
    v_cmp_eq_u32 vcc, 20, v142
    s_nop 1
    v_cndmask_b32 v145, v145, 9, vcc
    v_cndmask_b32 v144, v144, v143, vcc
    v_lshrrev_b32 v146, 5, v141
    v_add_u32 v145, v145, v146
    v_mul_u32_u24 v146, 52, v145
    v_lshrrev_b32 v146, 8, v146
    v_mad_u32_u24 v145, v146, 15, v145
    v_lshlrev_b32 v145, 10, v145
    v_bfe_u32 v146, v141, 2, 2
    v_lshl_add_u32 v144, v146, 4, v144
    v_lshl_add_u32 v145, v144, 4, v145
    v_bfe_u32 v146, v141, 4, 1
    v_and_b32 v144, 3, v141
    v_lshl_add_u32 v144, v146, 2, v144
    v_lshl_add_u32 v145, v144, 1, v145
    v_add_u32 v145, 97280, v145
    v_mov_b32 v146, 15360
    v_cmp_gt_u32 vcc, 1680, v140
    s_nop 1
    v_cndmask_b32 v11, v146, v145, vcc
    v_add_u32 v140, 0, v0
    v_mul_u32_u24 v141, 3121, v140
    v_lshrrev_b32 v141, 16, v141
    v_mul_u32_u24 v142, 21, v141
    v_sub_u32 v142, v140, v142
    v_mul_u32_u24 v143, 3277, v141
    v_lshrrev_b32 v143, 16, v143
    v_mad_u32_u24 v144, v143, 20, v142
    v_lshrrev_b32 v145, 4, v144
    v_and_b32 v144, 15, v144
    v_cmp_le_u32 vcc, 3, v145
    s_nop 1
    v_cndmask_b32 v146, 1, 2, vcc
    v_lshlrev_b32 v145, 1, v145
    v_sub_u32 v145, v145, v146
    v_max_i32 v145, 0, v145
    v_cmp_eq_u32 vcc, 20, v142
    s_nop 1
    v_cndmask_b32 v145, v145, 9, vcc
    v_cndmask_b32 v144, v144, v143, vcc
    v_lshrrev_b32 v146, 5, v141
    v_add_u32 v145, v145, v146
    v_mul_u32_u24 v146, 52, v145
    v_lshrrev_b32 v146, 8, v146
    v_mad_u32_u24 v145, v146, 15, v145
    v_lshlrev_b32 v145, 10, v145
    v_bfe_u32 v146, v141, 2, 2
    v_lshl_add_u32 v144, v146, 4, v144
    v_lshl_add_u32 v145, v144, 4, v145
    v_bfe_u32 v146, v141, 4, 1
    v_and_b32 v144, 3, v141
    v_lshl_add_u32 v144, v146, 2, v144
    v_lshl_add_u32 v145, v144, 1, v145
    v_add_u32 v145, 97280, v145
    v_mov_b32 v146, 15360
    v_cmp_gt_u32 vcc, 1680, v140
    s_nop 1
    v_cndmask_b32 v12, v146, v145, vcc
    v_add_u32 v140, 256, v0
    v_mul_u32_u24 v141, 3121, v140
    v_lshrrev_b32 v141, 16, v141
    v_mul_u32_u24 v142, 21, v141
    v_sub_u32 v142, v140, v142
    v_mul_u32_u24 v143, 3277, v141
    v_lshrrev_b32 v143, 16, v143
    v_mad_u32_u24 v144, v143, 20, v142
    v_lshrrev_b32 v145, 4, v144
    v_and_b32 v144, 15, v144
    v_cmp_le_u32 vcc, 3, v145
    s_nop 1
    v_cndmask_b32 v146, 1, 2, vcc
    v_lshlrev_b32 v145, 1, v145
    v_sub_u32 v145, v145, v146
    v_max_i32 v145, 0, v145
    v_cmp_eq_u32 vcc, 20, v142
    s_nop 1
    v_cndmask_b32 v145, v145, 9, vcc
    v_cndmask_b32 v144, v144, v143, vcc
    v_lshrrev_b32 v146, 5, v141
    v_add_u32 v145, v145, v146
    v_mul_u32_u24 v146, 52, v145
    v_lshrrev_b32 v146, 8, v146
    v_mad_u32_u24 v145, v146, 15, v145
    v_lshlrev_b32 v145, 10, v145
    v_bfe_u32 v146, v141, 2, 2
    v_lshl_add_u32 v144, v146, 4, v144
    v_lshl_add_u32 v145, v144, 4, v145
    v_bfe_u32 v146, v141, 4, 1
    v_and_b32 v144, 3, v141
    v_lshl_add_u32 v144, v146, 2, v144
    v_lshl_add_u32 v145, v144, 1, v145
    v_add_u32 v145, 97280, v145
    v_mov_b32 v146, 15360
    v_cmp_gt_u32 vcc, 1680, v140
    s_nop 1
    v_cndmask_b32 v13, v146, v145, vcc
    v_add_u32 v140, 512, v0
    v_mul_u32_u24 v141, 3121, v140
    v_lshrrev_b32 v141, 16, v141
    v_mul_u32_u24 v142, 21, v141
    v_sub_u32 v142, v140, v142
    v_mul_u32_u24 v143, 3277, v141
    v_lshrrev_b32 v143, 16, v143
    v_mad_u32_u24 v144, v143, 20, v142
    v_lshrrev_b32 v145, 4, v144
    v_and_b32 v144, 15, v144
    v_cmp_le_u32 vcc, 3, v145
    s_nop 1
    v_cndmask_b32 v146, 1, 2, vcc
    v_lshlrev_b32 v145, 1, v145
    v_sub_u32 v145, v145, v146
    v_max_i32 v145, 0, v145
    v_cmp_eq_u32 vcc, 20, v142
    s_nop 1
    v_cndmask_b32 v145, v145, 9, vcc
    v_cndmask_b32 v144, v144, v143, vcc
    v_lshrrev_b32 v146, 5, v141
    v_add_u32 v145, v145, v146
    v_mul_u32_u24 v146, 52, v145
    v_lshrrev_b32 v146, 8, v146
    v_mad_u32_u24 v145, v146, 15, v145
    v_lshlrev_b32 v145, 10, v145
    v_bfe_u32 v146, v141, 2, 2
    v_lshl_add_u32 v144, v146, 4, v144
    v_lshl_add_u32 v145, v144, 4, v145
    v_bfe_u32 v146, v141, 4, 1
    v_and_b32 v144, 3, v141
    v_lshl_add_u32 v144, v146, 2, v144
    v_lshl_add_u32 v145, v144, 1, v145
    v_add_u32 v145, 97280, v145
    v_mov_b32 v146, 15360
    v_cmp_gt_u32 vcc, 1680, v140
    s_nop 1
    v_cndmask_b32 v14, v146, v145, vcc
    v_add_u32 v140, 768, v0
    v_mul_u32_u24 v141, 3121, v140
    v_lshrrev_b32 v141, 16, v141
    v_mul_u32_u24 v142, 21, v141
    v_sub_u32 v142, v140, v142
    v_mul_u32_u24 v143, 3277, v141
    v_lshrrev_b32 v143, 16, v143
    v_mad_u32_u24 v144, v143, 20, v142
    v_lshrrev_b32 v145, 4, v144
    v_and_b32 v144, 15, v144
    v_cmp_le_u32 vcc, 3, v145
    s_nop 1
    v_cndmask_b32 v146, 1, 2, vcc
    v_lshlrev_b32 v145, 1, v145
    v_sub_u32 v145, v145, v146
    v_max_i32 v145, 0, v145
    v_cmp_eq_u32 vcc, 20, v142
    s_nop 1
    v_cndmask_b32 v145, v145, 9, vcc
    v_cndmask_b32 v144, v144, v143, vcc
    v_lshrrev_b32 v146, 5, v141
    v_add_u32 v145, v145, v146
    v_mul_u32_u24 v146, 52, v145
    v_lshrrev_b32 v146, 8, v146
    v_mad_u32_u24 v145, v146, 15, v145
    v_lshlrev_b32 v145, 10, v145
    v_bfe_u32 v146, v141, 2, 2
    v_lshl_add_u32 v144, v146, 4, v144
    v_lshl_add_u32 v145, v144, 4, v145
    v_bfe_u32 v146, v141, 4, 1
    v_and_b32 v144, 3, v141
    v_lshl_add_u32 v144, v146, 2, v144
    v_lshl_add_u32 v145, v144, 1, v145
    v_add_u32 v145, 97280, v145
    v_mov_b32 v146, 15360
    v_cmp_gt_u32 vcc, 1680, v140
    s_nop 1
    v_cndmask_b32 v15, v146, v145, vcc
    v_add_u32 v140, 1024, v0
    v_mul_u32_u24 v141, 3121, v140
    v_lshrrev_b32 v141, 16, v141
    v_mul_u32_u24 v142, 21, v141
    v_sub_u32 v142, v140, v142
    v_mul_u32_u24 v143, 3277, v141
    v_lshrrev_b32 v143, 16, v143
    v_mad_u32_u24 v144, v143, 20, v142
    v_lshrrev_b32 v145, 4, v144
    v_and_b32 v144, 15, v144
    v_cmp_le_u32 vcc, 3, v145
    s_nop 1
    v_cndmask_b32 v146, 1, 2, vcc
    v_lshlrev_b32 v145, 1, v145
    v_sub_u32 v145, v145, v146
    v_max_i32 v145, 0, v145
    v_cmp_eq_u32 vcc, 20, v142
    s_nop 1
    v_cndmask_b32 v145, v145, 9, vcc
    v_cndmask_b32 v144, v144, v143, vcc
    v_lshrrev_b32 v146, 5, v141
    v_add_u32 v145, v145, v146
    v_mul_u32_u24 v146, 52, v145
    v_lshrrev_b32 v146, 8, v146
    v_mad_u32_u24 v145, v146, 15, v145
    v_lshlrev_b32 v145, 10, v145
    v_bfe_u32 v146, v141, 2, 2
    v_lshl_add_u32 v144, v146, 4, v144
    v_lshl_add_u32 v145, v144, 4, v145
    v_bfe_u32 v146, v141, 4, 1
    v_and_b32 v144, 3, v141
    v_lshl_add_u32 v144, v146, 2, v144
    v_lshl_add_u32 v145, v144, 1, v145
    v_add_u32 v145, 97280, v145
    v_mov_b32 v146, 15360
    v_cmp_gt_u32 vcc, 1680, v140
    s_nop 1
    v_cndmask_b32 v16, v146, v145, vcc
    v_add_u32 v140, 1280, v0
    v_mul_u32_u24 v141, 3121, v140
    v_lshrrev_b32 v141, 16, v141
    v_mul_u32_u24 v142, 21, v141
    v_sub_u32 v142, v140, v142
    v_mul_u32_u24 v143, 3277, v141
    v_lshrrev_b32 v143, 16, v143
    v_mad_u32_u24 v144, v143, 20, v142
    v_lshrrev_b32 v145, 4, v144
    v_and_b32 v144, 15, v144
    v_cmp_le_u32 vcc, 3, v145
    s_nop 1
    v_cndmask_b32 v146, 1, 2, vcc
    v_lshlrev_b32 v145, 1, v145
    v_sub_u32 v145, v145, v146
    v_max_i32 v145, 0, v145
    v_cmp_eq_u32 vcc, 20, v142
    s_nop 1
    v_cndmask_b32 v145, v145, 9, vcc
    v_cndmask_b32 v144, v144, v143, vcc
    v_lshrrev_b32 v146, 5, v141
    v_add_u32 v145, v145, v146
    v_mul_u32_u24 v146, 52, v145
    v_lshrrev_b32 v146, 8, v146
    v_mad_u32_u24 v145, v146, 15, v145
    v_lshlrev_b32 v145, 10, v145
    v_bfe_u32 v146, v141, 2, 2
    v_lshl_add_u32 v144, v146, 4, v144
    v_lshl_add_u32 v145, v144, 4, v145
    v_bfe_u32 v146, v141, 4, 1
    v_and_b32 v144, 3, v141
    v_lshl_add_u32 v144, v146, 2, v144
    v_lshl_add_u32 v145, v144, 1, v145
    v_add_u32 v145, 97280, v145
    v_mov_b32 v146, 15360
    v_cmp_gt_u32 vcc, 1680, v140
    s_nop 1
    v_cndmask_b32 v17, v146, v145, vcc
    s_add_u32 m0, s55, 12288
    s_add_u32 s53, s51, 92160
    buffer_load_dwordx4 v220, s[32:35], s53 offen lds
    s_add_u32 m0, s55, 16384
    s_add_u32 s53, s51, 122880
    buffer_load_dwordx4 v219, s[32:35], s53 offen lds
    s_add_u32 m0, s54, 8192
    s_add_u32 s53, s50, 81920
    buffer_load_dwordx4 v218, s[28:31], s53 offen lds
    s_add_u32 m0, s55, 20480
    s_add_u32 s53, s51, 153600
    buffer_load_dwordx4 v220, s[32:35], s53 offen lds
    s_add_u32 m0, s55, 24576
    s_add_u32 s53, s51, 184320
    buffer_load_dwordx4 v219, s[32:35], s53 offen lds
    s_add_u32 m0, s54, 12288
    s_add_u32 s53, s50, 122880
    buffer_load_dwordx4 v218, s[28:31], s53 offen lds
    s_add_u32 m0, s55, 28672
    s_add_u32 s53, s51, 215040
    buffer_load_dwordx4 v220, s[32:35], s53 offen lds
    s_barrier
    s_add_u32 s50, s50, 128
    s_add_u32 s51, s51, 245760
    s_cmp_eq_u32 s50, 1280
    s_cselect_b32 s50, 0, s50
    s_cselect_b32 s51, 0, s51
    s_add_u32 m0, s55, 49152
    s_add_u32 s53, s51, 0
    buffer_load_dwordx4 v219, s[32:35], s53 offen lds
    s_add_u32 m0, s54, 49152
    s_add_u32 s53, s50, 0
    buffer_load_dwordx4 v218, s[28:31], s53 offen lds
    s_add_u32 m0, s55, 53248
    s_add_u32 s53, s51, 30720
    buffer_load_dwordx4 v220, s[32:35], s53 offen lds
    s_add_u32 m0, s55, 57344
    s_add_u32 s53, s51, 61440
    buffer_load_dwordx4 v219, s[32:35], s53 offen lds
    s_add_u32 m0, s54, 53248
    s_add_u32 s53, s50, 40960
    buffer_load_dwordx4 v218, s[28:31], s53 offen lds
    s_add_u32 m0, s55, 61440
    s_add_u32 s53, s51, 92160
    buffer_load_dwordx4 v220, s[32:35], s53 offen lds
    s_add_u32 m0, s55, 65536
    s_add_u32 s53, s51, 122880
    buffer_load_dwordx4 v219, s[32:35], s53 offen lds
    s_add_u32 m0, s54, 57344
    s_add_u32 s53, s50, 81920
    buffer_load_dwordx4 v218, s[28:31], s53 offen lds
    s_add_u32 m0, s55, 69632
    s_add_u32 s53, s51, 153600
    buffer_load_dwordx4 v220, s[32:35], s53 offen lds
    s_add_u32 m0, s55, 73728
    s_add_u32 s53, s51, 184320
    buffer_load_dwordx4 v219, s[32:35], s53 offen lds
    s_add_u32 m0, s54, 61440
    s_add_u32 s53, s50, 122880
    buffer_load_dwordx4 v218, s[28:31], s53 offen lds
    s_add_u32 m0, s55, 77824
    s_add_u32 s53, s51, 215040
    buffer_load_dwordx4 v220, s[32:35], s53 offen lds
    v_add_u32 v192, 0, v194
    v_add_u32 v195, 0, v197
    v_xor_b32 v193, 64, v192
    v_xor_b32 v196, 32, v195
    s_waitcnt vmcnt(12)
    s_setprio 1
    s_barrier
    ds_read_b128 v[152:155], v192 offset:0
    ds_read_b128 v[156:159], v192 offset:2048
    ds_read_b64_tr_b16 v[168:169], v195 offset:0
    ds_read_b64_tr_b16 v[170:171], v195 offset:2048
    ds_read_b64_tr_b16 v[172:173], v196 offset:0
    ds_read_b64_tr_b16 v[174:175], v196 offset:2048
    ds_read_b64_tr_b16 v[176:177], v195 offset:256
    ds_read_b64_tr_b16 v[178:179], v195 offset:2304
    ds_read_b64_tr_b16 v[180:181], v196 offset:256
    ds_read_b64_tr_b16 v[182:183], v196 offset:2304
    ds_read_b64_tr_b16 v[184:185], v195 offset:512
    ds_read_b64_tr_b16 v[186:187], v195 offset:2560
    s_waitcnt lgkmcnt(8)
    v_mfma_f32_16x16x32_bf16 v[24:27], v[168:171], v[152:155], 0
    ds_read_b128 v[160:163], v193 offset:0
    v_mfma_f32_16x16x32_bf16 v[28:31], v[168:171], v[156:159], 0
    ds_read_b128 v[164:167], v193 offset:2048
    s_add_u32 s50, s50, 128
    s_add_u32 s51, s51, 245760
    s_cmp_eq_u32 s50, 1280
    s_cselect_b32 s50, 0, s50
    s_cselect_b32 s51, 0, s51
    s_add_u32 m0, s55, 98304
    s_add_u32 s53, s51, 0
    buffer_load_dwordx4 v219, s[32:35], s53 offen lds
    s_add_u32 m0, s54, 98304
    s_add_u32 s53, s50, 0
    buffer_load_dwordx4 v218, s[28:31], s53 offen lds
    ds_read_b64_tr_b16 v[104:105], v226 offset:0
    ds_read_b64_tr_b16 v[106:107], v226 offset:2048
    ds_read_b64_tr_b16 v[108:109], v226 offset:16384
    s_waitcnt lgkmcnt(11)
    v_mfma_f32_16x16x32_bf16 v[32:35], v[172:175], v[152:155], 0
    ds_read_b64_tr_b16 v[188:189], v195 offset:16384
    v_mfma_f32_16x16x32_bf16 v[36:39], v[172:175], v[156:159], 0
    ds_read_b64_tr_b16 v[190:191], v195 offset:18432
    s_add_u32 m0, s55, 102400
    s_add_u32 s53, s51, 30720
    buffer_load_dwordx4 v220, s[32:35], s53 offen lds
    s_add_u32 m0, s55, 106496
    s_add_u32 s53, s51, 61440
    buffer_load_dwordx4 v219, s[32:35], s53 offen lds
    ds_read_b64_tr_b16 v[110:111], v226 offset:18432
    ds_read_b64_tr_b16 v[112:113], v227 offset:0
    ds_read_b64_tr_b16 v[114:115], v227 offset:2048
    s_waitcnt lgkmcnt(14)
    v_mfma_f32_16x16x32_bf16 v[40:43], v[176:179], v[152:155], 0
    ds_read_b64_tr_b16 v[168:169], v196 offset:16384
    v_mfma_f32_16x16x32_bf16 v[44:47], v[176:179], v[156:159], 0
    ds_read_b64_tr_b16 v[170:171], v196 offset:18432
    s_add_u32 m0, s54, 102400
    s_add_u32 s53, s50, 40960
    buffer_load_dwordx4 v218, s[28:31], s53 offen lds
    s_add_u32 m0, s55, 110592
    s_add_u32 s53, s51, 92160
    buffer_load_dwordx4 v220, s[32:35], s53 offen lds
    ds_read_b64_tr_b16 v[116:117], v227 offset:16384
    ds_read_b64_tr_b16 v[118:119], v227 offset:18432
    s_waitcnt lgkmcnt(10)
    v_mfma_f32_16x16x32_bf16 v[48:51], v[180:183], v[152:155], 0
    ds_read_b64_tr_b16 v[172:173], v195 offset:16640
    v_mfma_f32_16x16x32_bf16 v[52:55], v[180:183], v[156:159], 0
    ds_read_b64_tr_b16 v[174:175], v195 offset:18688
    s_add_u32 m0, s55, 114688
    s_add_u32 s53, s51, 122880
    buffer_load_dwordx4 v219, s[32:35], s53 offen lds
    s_add_u32 m0, s54, 106496
    s_add_u32 s53, s50, 81920
    buffer_load_dwordx4 v218, s[28:31], s53 offen lds
    v_mfma_f32_16x16x32_bf16 v[208:211], v[136:139], v[104:107], 0
    s_waitcnt lgkmcnt(8)
    v_mfma_f32_16x16x32_bf16 v[208:211], v[136:139], v[108:111], v[208:211]
    v_mfma_f32_16x16x32_bf16 v[56:59], v[184:187], v[152:155], 0
    ds_read_b64_tr_b16 v[176:177], v196 offset:16640
    v_mfma_f32_16x16x32_bf16 v[60:63], v[184:187], v[156:159], 0
    ds_read_b64_tr_b16 v[178:179], v196 offset:18688
    s_add_u32 m0, s55, 118784
    s_add_u32 s53, s51, 153600
    buffer_load_dwordx4 v220, s[32:35], s53 offen lds
    s_add_u32 m0, s55, 122880
    s_add_u32 s53, s51, 184320
    buffer_load_dwordx4 v219, s[32:35], s53 offen lds
    s_waitcnt lgkmcnt(8)
    v_mfma_f32_16x16x32_bf16 v[212:215], v[136:139], v[112:115], 0
    s_waitcnt lgkmcnt(4)
    v_mfma_f32_16x16x32_bf16 v[24:27], v[188:191], v[160:163], v[24:27]
    ds_read_b64_tr_b16 v[180:181], v195 offset:16896
    v_mfma_f32_16x16x32_bf16 v[28:31], v[188:191], v[164:167], v[28:31]
    ds_read_b64_tr_b16 v[182:183], v195 offset:18944
    v_add_u32 v192, 49152, v194
    v_add_u32 v195, 49152, v197
    v_xor_b32 v193, 64, v192
    v_xor_b32 v196, 32, v195
    s_add_u32 m0, s54, 110592
    s_add_u32 s53, s50, 122880
    buffer_load_dwordx4 v218, s[28:31], s53 offen lds
    s_add_u32 m0, s55, 126976
    s_add_u32 s53, s51, 215040
    buffer_load_dwordx4 v220, s[32:35], s53 offen lds
    v_mfma_f32_16x16x32_bf16 v[212:215], v[136:139], v[116:119], v[212:215]
    v_mfma_f32_16x16x32_bf16 v[32:35], v[168:171], v[160:163], v[32:35]
    v_mfma_f32_16x16x32_bf16 v[36:39], v[168:171], v[164:167], v[36:39]
    s_waitcnt vmcnt(12) lgkmcnt(0)
    s_barrier
    ds_read_b128 v[152:155], v192 offset:0
    ds_read_b128 v[156:159], v192 offset:2048
    ds_read_b64_tr_b16 v[184:185], v195 offset:0
    ds_read_b64_tr_b16 v[186:187], v195 offset:2048
    ds_read_b64_tr_b16 v[188:189], v196 offset:0
    ds_read_b64_tr_b16 v[190:191], v196 offset:2048
    v_mfma_f32_16x16x32_bf16 v[40:43], v[172:175], v[160:163], v[40:43]
    v_mfma_f32_16x16x32_bf16 v[44:47], v[172:175], v[164:167], v[44:47]
    s_add_u32 s50, s50, 128
    s_add_u32 s51, s51, 245760
    s_cmp_eq_u32 s50, 1280
    s_cselect_b32 s50, 0, s50
    s_cselect_b32 s51, 0, s51
    s_add_u32 m0, s55, 0
    s_add_u32 s53, s51, 0
    buffer_load_dwordx4 v219, s[32:35], s53 offen lds
    s_add_u32 m0, s54, 0
    s_add_u32 s53, s50, 0
    buffer_load_dwordx4 v218, s[28:31], s53 offen lds
    v_mfma_f32_16x16x32_bf16 v[48:51], v[176:179], v[160:163], v[48:51]
    ds_read_b64_tr_b16 v[168:169], v195 offset:256
    v_mfma_f32_16x16x32_bf16 v[52:55], v[176:179], v[164:167], v[52:55]
    ds_read_b64_tr_b16 v[170:171], v195 offset:2304
    s_add_u32 m0, s55, 4096
    s_add_u32 s53, s51, 30720
    buffer_load_dwordx4 v220, s[32:35], s53 offen lds
    s_add_u32 m0, s55, 8192
    s_add_u32 s53, s51, 61440
    buffer_load_dwordx4 v219, s[32:35], s53 offen lds
    v_mfma_f32_16x16x32_bf16 v[56:59], v[180:183], v[160:163], v[56:59]
    ds_read_b64_tr_b16 v[172:173], v196 offset:256
    v_mfma_f32_16x16x32_bf16 v[60:63], v[180:183], v[164:167], v[60:63]
    ds_read_b64_tr_b16 v[174:175], v196 offset:2304
    s_add_u32 m0, s54, 4096
    s_add_u32 s53, s50, 40960
    buffer_load_dwordx4 v218, s[28:31], s53 offen lds
    s_add_u32 m0, s55, 12288
    s_add_u32 s53, s51, 92160
    buffer_load_dwordx4 v220, s[32:35], s53 offen lds
    s_waitcnt lgkmcnt(6)
    v_mfma_f32_16x16x32_bf16 v[24:27], v[184:187], v[152:155], v[24:27]
    ds_read_b128 v[160:163], v193 offset:0
    v_mfma_f32_16x16x32_bf16 v[28:31], v[184:187], v[156:159], v[28:31]
    ds_read_b128 v[164:167], v193 offset:2048
    ds_read_b64_tr_b16 v[176:177], v195 offset:512
    ds_read_b64_tr_b16 v[178:179], v195 offset:2560
    s_add_u32 m0, s55, 16384
    s_add_u32 s53, s51, 122880
    buffer_load_dwordx4 v219, s[32:35], s53 offen lds
    s_lshl_b32 s65, s44, 5
    v_add_u32 v140, s65, v1
    s_mov_b32 s90, 0xffff0000
    s_waitcnt lgkmcnt(8)
    v_mfma_f32_16x16x32_bf16 v[32:35], v[188:191], v[152:155], v[32:35]
    ds_read_b64_tr_b16 v[180:181], v195 offset:16384
    v_mfma_f32_16x16x32_bf16 v[36:39], v[188:191], v[156:159], v[36:39]
    ds_read_b64_tr_b16 v[182:183], v195 offset:18432
    s_add_u32 m0, s54, 8192
    s_add_u32 s53, s50, 81920
    buffer_load_dwordx4 v218, s[28:31], s53 offen lds
    s_mov_b32 s91, 0
    v_cndmask_b32 v208, v208, v212, s[90:91]
    s_mov_b32 s90, -1
    s_waitcnt lgkmcnt(8)
    v_mfma_f32_16x16x32_bf16 v[40:43], v[168:171], v[152:155], v[40:43]
    ds_read_b64_tr_b16 v[184:185], v196 offset:16384
    v_mfma_f32_16x16x32_bf16 v[44:47], v[168:171], v[156:159], v[44:47]
    ds_read_b64_tr_b16 v[186:187], v196 offset:18432
    s_add_u32 m0, s55, 20480
    s_add_u32 s53, s51, 153600
    buffer_load_dwordx4 v220, s[32:35], s53 offen lds
    s_cmp_eq_u32 s44, 2
    s_cselect_b32 s90, 0xffff, s90
    v_mov_b32 v141, 0
    v_mov_b32 v142, -16
    s_waitcnt lgkmcnt(8)
    v_mfma_f32_16x16x32_bf16 v[48:51], v[172:175], v[152:155], v[48:51]
    ds_read_b64_tr_b16 v[188:189], v195 offset:16640
    v_mfma_f32_16x16x32_bf16 v[52:55], v[172:175], v[156:159], v[52:55]
    ds_read_b64_tr_b16 v[190:191], v195 offset:18688
    s_add_u32 m0, s55, 24576
    s_add_u32 s53, s51, 184320
    buffer_load_dwordx4 v219, s[32:35], s53 offen lds
    v_cmp_le_u32 vcc, 80, v140
    s_nop 1
    v_cndmask_b32 v141, v141, v142, vcc
    v_mov_b32 v142, 544
    s_waitcnt lgkmcnt(6)
    v_mfma_f32_16x16x32_bf16 v[56:59], v[176:179], v[152:155], v[56:59]
    ds_read_b64_tr_b16 v[168:169], v196 offset:16640
    v_mfma_f32_16x16x32_bf16 v[60:63], v[176:179], v[156:159], v[60:63]
    ds_read_b64_tr_b16 v[170:171], v196 offset:18688
    s_add_u32 m0, s54, 12288
    s_add_u32 s53, s50, 122880
    buffer_load_dwordx4 v218, s[28:31], s53 offen lds
    v_cmp_le_u32 vcc, 96, v140
    s_nop 1
    v_cndmask_b32 v141, v141, v142, vcc
    v_mov_b32 v142, 1104
    s_waitcnt lgkmcnt(6)
    v_mfma_f32_16x16x32_bf16 v[24:27], v[180:183], v[160:163], v[24:27]
    ds_read_b64_tr_b16 v[172:173], v195 offset:16896
    v_mfma_f32_16x16x32_bf16 v[28:31], v[180:183], v[164:167], v[28:31]
    ds_read_b64_tr_b16 v[174:175], v195 offset:18944
    v_add_u32 v192, 98304, v194
    v_add_u32 v195, 98304, v197
    v_xor_b32 v193, 64, v192
    v_xor_b32 v196, 32, v195
    s_add_u32 m0, s55, 28672
    s_add_u32 s53, s51, 215040
    buffer_load_dwordx4 v220, s[32:35], s53 offen lds
    v_cmp_le_u32 vcc, 176, v140
    s_nop 1
    v_cndmask_b32 v141, v141, v142, vcc
    v_add_u32 v140, v140, v141
    s_waitcnt lgkmcnt(6)
    v_mfma_f32_16x16x32_bf16 v[32:35], v[184:187], v[160:163], v[32:35]
    v_mfma_f32_16x16x32_bf16 v[36:39], v[184:187], v[164:167], v[36:39]
    s_lshl_b32 s65, s49, 2
    s_add_u32 s65, s65, 12795904
    s_cmp_ge_u32 s46, 10
    s_cselect_b32 s65, 2130706432, s65
    v_lshlrev_b32 v140, 2, v140
    v_mov_b32 v141, 2130706432
    v_cndmask_b32 v140, v141, v140, s[90:91]
    buffer_atomic_add_f32 v208, v140, s[36:39], s65 offen
    s_waitcnt vmcnt(13) lgkmcnt(0)
    s_barrier
    ds_read_b128 v[152:155], v192 offset:0
    ds_read_b128 v[156:159], v192 offset:2048
    ds_read_b64_tr_b16 v[176:177], v195 offset:0
    ds_read_b64_tr_b16 v[178:179], v195 offset:2048
    ds_read_b64_tr_b16 v[180:181], v196 offset:0
    ds_read_b64_tr_b16 v[182:183], v196 offset:2048
    v_mfma_f32_16x16x32_bf16 v[40:43], v[188:191], v[160:163], v[40:43]
    v_mfma_f32_16x16x32_bf16 v[44:47], v[188:191], v[164:167], v[44:47]
    s_add_u32 s50, s50, 128
    s_add_u32 s51, s51, 245760
    s_cmp_eq_u32 s50, 1280
    s_cselect_b32 s50, 0, s50
    s_cselect_b32 s51, 0, s51
    s_add_u32 m0, s55, 49152
    s_add_u32 s53, s51, 0
    buffer_load_dwordx4 v219, s[32:35], s53 offen lds
    s_add_u32 m0, s54, 49152
    s_add_u32 s53, s50, 0
    buffer_load_dwordx4 v218, s[28:31], s53 offen lds
    v_mfma_f32_16x16x32_bf16 v[48:51], v[168:171], v[160:163], v[48:51]
    ds_read_b64_tr_b16 v[184:185], v195 offset:256
    v_mfma_f32_16x16x32_bf16 v[52:55], v[168:171], v[164:167], v[52:55]
    ds_read_b64_tr_b16 v[186:187], v195 offset:2304
    s_add_u32 m0, s55, 53248
    s_add_u32 s53, s51, 30720
    buffer_load_dwordx4 v220, s[32:35], s53 offen lds
    s_add_u32 m0, s55, 57344
    s_add_u32 s53, s51, 61440
    buffer_load_dwordx4 v219, s[32:35], s53 offen lds
    v_mfma_f32_16x16x32_bf16 v[56:59], v[172:175], v[160:163], v[56:59]
    ds_read_b64_tr_b16 v[188:189], v196 offset:256
    v_mfma_f32_16x16x32_bf16 v[60:63], v[172:175], v[164:167], v[60:63]
    ds_read_b64_tr_b16 v[190:191], v196 offset:2304
    s_add_u32 m0, s54, 53248
    s_add_u32 s53, s50, 40960
    buffer_load_dwordx4 v218, s[28:31], s53 offen lds
    s_add_u32 m0, s55, 61440
    s_add_u32 s53, s51, 92160
    buffer_load_dwordx4 v220, s[32:35], s53 offen lds
    s_waitcnt lgkmcnt(6)
    v_mfma_f32_16x16x32_bf16 v[24:27], v[176:179], v[152:155], v[24:27]
    ds_read_b128 v[160:163], v193 offset:0
    v_mfma_f32_16x16x32_bf16 v[28:31], v[176:179], v[156:159], v[28:31]
    ds_read_b128 v[164:167], v193 offset:2048
    ds_read_b64_tr_b16 v[168:169], v195 offset:512
    ds_read_b64_tr_b16 v[170:171], v195 offset:2560
    s_add_u32 m0, s55, 65536
    s_add_u32 s53, s51, 122880
    buffer_load_dwordx4 v219, s[32:35], s53 offen lds
    s_waitcnt lgkmcnt(8)
    v_mfma_f32_16x16x32_bf16 v[32:35], v[180:183], v[152:155], v[32:35]
    ds_read_b64_tr_b16 v[172:173], v195 offset:16384
    v_mfma_f32_16x16x32_bf16 v[36:39], v[180:183], v[156:159], v[36:39]
    ds_read_b64_tr_b16 v[174:175], v195 offset:18432
    s_add_u32 m0, s54, 57344
    s_add_u32 s53, s50, 81920
    buffer_load_dwordx4 v218, s[28:31], s53 offen lds
    s_waitcnt lgkmcnt(8)
    v_mfma_f32_16x16x32_bf16 v[40:43], v[184:187], v[152:155], v[40:43]
    ds_read_b64_tr_b16 v[176:177], v196 offset:16384
    v_mfma_f32_16x16x32_bf16 v[44:47], v[184:187], v[156:159], v[44:47]
    ds_read_b64_tr_b16 v[178:179], v196 offset:18432
    s_add_u32 m0, s55, 69632
    s_add_u32 s53, s51, 153600
    buffer_load_dwordx4 v220, s[32:35], s53 offen lds
    s_waitcnt lgkmcnt(8)
    v_mfma_f32_16x16x32_bf16 v[48:51], v[188:191], v[152:155], v[48:51]
    ds_read_b64_tr_b16 v[180:181], v195 offset:16640
    v_mfma_f32_16x16x32_bf16 v[52:55], v[188:191], v[156:159], v[52:55]
    ds_read_b64_tr_b16 v[182:183], v195 offset:18688
    s_add_u32 m0, s55, 73728
    s_add_u32 s53, s51, 184320
    buffer_load_dwordx4 v219, s[32:35], s53 offen lds
    s_waitcnt lgkmcnt(6)
    v_mfma_f32_16x16x32_bf16 v[56:59], v[168:171], v[152:155], v[56:59]
    ds_read_b64_tr_b16 v[184:185], v196 offset:16640
    v_mfma_f32_16x16x32_bf16 v[60:63], v[168:171], v[156:159], v[60:63]
    ds_read_b64_tr_b16 v[186:187], v196 offset:18688
    s_add_u32 m0, s54, 61440
    s_add_u32 s53, s50, 122880
    buffer_load_dwordx4 v218, s[28:31], s53 offen lds
    s_waitcnt lgkmcnt(6)
    v_mfma_f32_16x16x32_bf16 v[24:27], v[172:175], v[160:163], v[24:27]
    ds_read_b64_tr_b16 v[188:189], v195 offset:16896
    v_mfma_f32_16x16x32_bf16 v[28:31], v[172:175], v[164:167], v[28:31]
    ds_read_b64_tr_b16 v[190:191], v195 offset:18944
    v_add_u32 v192, 0, v194
    v_add_u32 v195, 0, v197
    v_xor_b32 v193, 64, v192
    v_xor_b32 v196, 32, v195
    s_add_u32 m0, s55, 77824
    s_add_u32 s53, s51, 215040
    buffer_load_dwordx4 v220, s[32:35], s53 offen lds
    s_waitcnt lgkmcnt(6)
    v_mfma_f32_16x16x32_bf16 v[32:35], v[176:179], v[160:163], v[32:35]
    v_mfma_f32_16x16x32_bf16 v[36:39], v[176:179], v[164:167], v[36:39]
    s_waitcnt vmcnt(12) lgkmcnt(0)
    s_barrier
    ds_read_b128 v[152:155], v192 offset:0
    ds_read_b128 v[156:159], v192 offset:2048
    ds_read_b64_tr_b16 v[168:169], v195 offset:0
    ds_read_b64_tr_b16 v[170:171], v195 offset:2048
    ds_read_b64_tr_b16 v[172:173], v196 offset:0
    ds_read_b64_tr_b16 v[174:175], v196 offset:2048
    v_mfma_f32_16x16x32_bf16 v[40:43], v[180:183], v[160:163], v[40:43]
    v_mfma_f32_16x16x32_bf16 v[44:47], v[180:183], v[164:167], v[44:47]
    s_add_u32 s50, s50, 128
    s_add_u32 s51, s51, 245760
    s_cmp_eq_u32 s50, 1280
    s_cselect_b32 s50, 0, s50
    s_cselect_b32 s51, 0, s51
    s_add_u32 m0, s55, 98304
    s_add_u32 s53, s51, 0
    buffer_load_dwordx4 v219, s[32:35], s53 offen lds
    s_add_u32 m0, s54, 98304
    s_add_u32 s53, s50, 0
    buffer_load_dwordx4 v218, s[28:31], s53 offen lds
    v_mfma_f32_16x16x32_bf16 v[48:51], v[184:187], v[160:163], v[48:51]
    ds_read_b64_tr_b16 v[176:177], v195 offset:256
    v_mfma_f32_16x16x32_bf16 v[52:55], v[184:187], v[164:167], v[52:55]
    ds_read_b64_tr_b16 v[178:179], v195 offset:2304
    s_add_u32 m0, s55, 102400
    s_add_u32 s53, s51, 30720
    buffer_load_dwordx4 v220, s[32:35], s53 offen lds
    s_add_u32 m0, s55, 106496
    s_add_u32 s53, s51, 61440
    buffer_load_dwordx4 v219, s[32:35], s53 offen lds
    v_mfma_f32_16x16x32_bf16 v[56:59], v[188:191], v[160:163], v[56:59]
    ds_read_b64_tr_b16 v[180:181], v196 offset:256
    v_mfma_f32_16x16x32_bf16 v[60:63], v[188:191], v[164:167], v[60:63]
    ds_read_b64_tr_b16 v[182:183], v196 offset:2304
    s_add_u32 m0, s54, 102400
    s_add_u32 s53, s50, 40960
    buffer_load_dwordx4 v218, s[28:31], s53 offen lds
    s_add_u32 m0, s55, 110592
    s_add_u32 s53, s51, 92160
    buffer_load_dwordx4 v220, s[32:35], s53 offen lds
    s_waitcnt lgkmcnt(6)
    v_mfma_f32_16x16x32_bf16 v[24:27], v[168:171], v[152:155], v[24:27]
    ds_read_b128 v[160:163], v193 offset:0
    v_mfma_f32_16x16x32_bf16 v[28:31], v[168:171], v[156:159], v[28:31]
    ds_read_b128 v[164:167], v193 offset:2048
    ds_read_b64_tr_b16 v[184:185], v195 offset:512
    ds_read_b64_tr_b16 v[186:187], v195 offset:2560
    s_add_u32 m0, s55, 114688
    s_add_u32 s53, s51, 122880
    buffer_load_dwordx4 v219, s[32:35], s53 offen lds
    s_waitcnt lgkmcnt(8)
    v_mfma_f32_16x16x32_bf16 v[32:35], v[172:175], v[152:155], v[32:35]
    ds_read_b64_tr_b16 v[188:189], v195 offset:16384
    v_mfma_f32_16x16x32_bf16 v[36:39], v[172:175], v[156:159], v[36:39]
    ds_read_b64_tr_b16 v[190:191], v195 offset:18432
    s_add_u32 m0, s54, 106496
    s_add_u32 s53, s50, 81920
    buffer_load_dwordx4 v218, s[28:31], s53 offen lds
    s_waitcnt lgkmcnt(8)
    v_mfma_f32_16x16x32_bf16 v[40:43], v[176:179], v[152:155], v[40:43]
    ds_read_b64_tr_b16 v[168:169], v196 offset:16384
    v_mfma_f32_16x16x32_bf16 v[44:47], v[176:179], v[156:159], v[44:47]
    ds_read_b64_tr_b16 v[170:171], v196 offset:18432
    s_add_u32 m0, s55, 118784
    s_add_u32 s53, s51, 153600
    buffer_load_dwordx4 v220, s[32:35], s53 offen lds
    s_waitcnt lgkmcnt(8)
    v_mfma_f32_16x16x32_bf16 v[48:51], v[180:183], v[152:155], v[48:51]
    ds_read_b64_tr_b16 v[172:173], v195 offset:16640
    v_mfma_f32_16x16x32_bf16 v[52:55], v[180:183], v[156:159], v[52:55]
    ds_read_b64_tr_b16 v[174:175], v195 offset:18688
    s_add_u32 m0, s55, 122880
    s_add_u32 s53, s51, 184320
    buffer_load_dwordx4 v219, s[32:35], s53 offen lds
    s_waitcnt lgkmcnt(6)
    v_mfma_f32_16x16x32_bf16 v[56:59], v[184:187], v[152:155], v[56:59]
    ds_read_b64_tr_b16 v[176:177], v196 offset:16640
    v_mfma_f32_16x16x32_bf16 v[60:63], v[184:187], v[156:159], v[60:63]
    ds_read_b64_tr_b16 v[178:179], v196 offset:18688
    s_add_u32 m0, s54, 110592
    s_add_u32 s53, s50, 122880
    buffer_load_dwordx4 v218, s[28:31], s53 offen lds
    s_waitcnt lgkmcnt(6)
    v_mfma_f32_16x16x32_bf16 v[24:27], v[188:191], v[160:163], v[24:27]
    ds_read_b64_tr_b16 v[180:181], v195 offset:16896
    v_mfma_f32_16x16x32_bf16 v[28:31], v[188:191], v[164:167], v[28:31]
    ds_read_b64_tr_b16 v[182:183], v195 offset:18944
    v_add_u32 v192, 49152, v194
    v_add_u32 v195, 49152, v197
    v_xor_b32 v193, 64, v192
    v_xor_b32 v196, 32, v195
    s_add_u32 m0, s55, 126976
    s_add_u32 s53, s51, 215040
    buffer_load_dwordx4 v220, s[32:35], s53 offen lds
    s_waitcnt lgkmcnt(6)
    v_mfma_f32_16x16x32_bf16 v[32:35], v[168:171], v[160:163], v[32:35]
    v_mfma_f32_16x16x32_bf16 v[36:39], v[168:171], v[164:167], v[36:39]
    s_waitcnt vmcnt(12) lgkmcnt(0)
    s_barrier
    ds_read_b128 v[152:155], v192 offset:0
    ds_read_b128 v[156:159], v192 offset:2048
    ds_read_b64_tr_b16 v[184:185], v195 offset:0
    ds_read_b64_tr_b16 v[186:187], v195 offset:2048
    ds_read_b64_tr_b16 v[188:189], v196 offset:0
    ds_read_b64_tr_b16 v[190:191], v196 offset:2048
    v_mfma_f32_16x16x32_bf16 v[40:43], v[172:175], v[160:163], v[40:43]
    v_mfma_f32_16x16x32_bf16 v[44:47], v[172:175], v[164:167], v[44:47]
    s_add_u32 s50, s50, 128
    s_add_u32 s51, s51, 245760
    s_cmp_eq_u32 s50, 1280
    s_cselect_b32 s50, 0, s50
    s_cselect_b32 s51, 0, s51
    s_add_u32 m0, s55, 0
    s_add_u32 s53, s51, 0
    buffer_load_dwordx4 v219, s[32:35], s53 offen lds
    s_add_u32 m0, s54, 0
    s_add_u32 s53, s50, 0
    buffer_load_dwordx4 v218, s[28:31], s53 offen lds
    v_mfma_f32_16x16x32_bf16 v[48:51], v[176:179], v[160:163], v[48:51]
    ds_read_b64_tr_b16 v[168:169], v195 offset:256
    v_mfma_f32_16x16x32_bf16 v[52:55], v[176:179], v[164:167], v[52:55]
    ds_read_b64_tr_b16 v[170:171], v195 offset:2304
    s_add_u32 m0, s55, 4096
    s_add_u32 s53, s51, 30720
    buffer_load_dwordx4 v220, s[32:35], s53 offen lds
    s_add_u32 m0, s55, 8192
    s_add_u32 s53, s51, 61440
    buffer_load_dwordx4 v219, s[32:35], s53 offen lds
    v_mfma_f32_16x16x32_bf16 v[56:59], v[180:183], v[160:163], v[56:59]
    ds_read_b64_tr_b16 v[172:173], v196 offset:256
    v_mfma_f32_16x16x32_bf16 v[60:63], v[180:183], v[164:167], v[60:63]
    ds_read_b64_tr_b16 v[174:175], v196 offset:2304
    s_add_u32 m0, s54, 4096
    s_add_u32 s53, s50, 40960
    buffer_load_dwordx4 v218, s[28:31], s53 offen lds
    s_add_u32 m0, s55, 12288
    s_add_u32 s53, s51, 92160
    buffer_load_dwordx4 v220, s[32:35], s53 offen lds
    s_waitcnt lgkmcnt(6)
    v_mfma_f32_16x16x32_bf16 v[24:27], v[184:187], v[152:155], v[24:27]
    ds_read_b128 v[160:163], v193 offset:0
    v_mfma_f32_16x16x32_bf16 v[28:31], v[184:187], v[156:159], v[28:31]
    ds_read_b128 v[164:167], v193 offset:2048
    ds_read_b64_tr_b16 v[176:177], v195 offset:512
    ds_read_b64_tr_b16 v[178:179], v195 offset:2560
    s_add_u32 m0, s55, 16384
    s_add_u32 s53, s51, 122880
    buffer_load_dwordx4 v219, s[32:35], s53 offen lds
    s_waitcnt lgkmcnt(8)
    v_mfma_f32_16x16x32_bf16 v[32:35], v[188:191], v[152:155], v[32:35]
    ds_read_b64_tr_b16 v[180:181], v195 offset:16384
    v_mfma_f32_16x16x32_bf16 v[36:39], v[188:191], v[156:159], v[36:39]
    ds_read_b64_tr_b16 v[182:183], v195 offset:18432
    s_add_u32 m0, s54, 8192
    s_add_u32 s53, s50, 81920
    buffer_load_dwordx4 v218, s[28:31], s53 offen lds
    s_waitcnt lgkmcnt(8)
    v_mfma_f32_16x16x32_bf16 v[40:43], v[168:171], v[152:155], v[40:43]
    ds_read_b64_tr_b16 v[184:185], v196 offset:16384
    v_mfma_f32_16x16x32_bf16 v[44:47], v[168:171], v[156:159], v[44:47]
    ds_read_b64_tr_b16 v[186:187], v196 offset:18432
    s_add_u32 m0, s55, 20480
    s_add_u32 s53, s51, 153600
    buffer_load_dwordx4 v220, s[32:35], s53 offen lds
    s_waitcnt lgkmcnt(8)
    v_mfma_f32_16x16x32_bf16 v[48:51], v[172:175], v[152:155], v[48:51]
    ds_read_b64_tr_b16 v[188:189], v195 offset:16640
    v_mfma_f32_16x16x32_bf16 v[52:55], v[172:175], v[156:159], v[52:55]
    ds_read_b64_tr_b16 v[190:191], v195 offset:18688
    s_add_u32 m0, s55, 24576
    s_add_u32 s53, s51, 184320
    buffer_load_dwordx4 v219, s[32:35], s53 offen lds
    s_waitcnt lgkmcnt(6)
    v_mfma_f32_16x16x32_bf16 v[56:59], v[176:179], v[152:155], v[56:59]
    ds_read_b64_tr_b16 v[168:169], v196 offset:16640
    v_mfma_f32_16x16x32_bf16 v[60:63], v[176:179], v[156:159], v[60:63]
    ds_read_b64_tr_b16 v[170:171], v196 offset:18688
    s_add_u32 m0, s54, 12288
    s_add_u32 s53, s50, 122880
    buffer_load_dwordx4 v218, s[28:31], s53 offen lds
    s_waitcnt lgkmcnt(6)
    v_mfma_f32_16x16x32_bf16 v[24:27], v[180:183], v[160:163], v[24:27]
    ds_read_b64_tr_b16 v[172:173], v195 offset:16896
    v_mfma_f32_16x16x32_bf16 v[28:31], v[180:183], v[164:167], v[28:31]
    ds_read_b64_tr_b16 v[174:175], v195 offset:18944
    v_add_u32 v192, 98304, v194
    v_add_u32 v195, 98304, v197
    v_xor_b32 v193, 64, v192
    v_xor_b32 v196, 32, v195
    s_add_u32 m0, s55, 28672
    s_add_u32 s53, s51, 215040
    buffer_load_dwordx4 v220, s[32:35], s53 offen lds
    s_waitcnt lgkmcnt(6)
    v_mfma_f32_16x16x32_bf16 v[32:35], v[184:187], v[160:163], v[32:35]
    v_mfma_f32_16x16x32_bf16 v[36:39], v[184:187], v[164:167], v[36:39]
    s_waitcnt vmcnt(12) lgkmcnt(0)
    s_barrier
    ds_read_b128 v[152:155], v192 offset:0
    ds_read_b128 v[156:159], v192 offset:2048
    ds_read_b64_tr_b16 v[176:177], v195 offset:0
    ds_read_b64_tr_b16 v[178:179], v195 offset:2048
    ds_read_b64_tr_b16 v[180:181], v196 offset:0
    ds_read_b64_tr_b16 v[182:183], v196 offset:2048
    v_mfma_f32_16x16x32_bf16 v[40:43], v[188:191], v[160:163], v[40:43]
    v_mfma_f32_16x16x32_bf16 v[44:47], v[188:191], v[164:167], v[44:47]
    s_add_u32 s50, s50, 128
    s_add_u32 s51, s51, 245760
    s_cmp_eq_u32 s50, 1280
    s_cselect_b32 s50, 0, s50
    s_cselect_b32 s51, 0, s51
    s_add_u32 m0, s55, 49152
    s_add_u32 s53, s51, 0
    buffer_load_dwordx4 v219, s[32:35], s53 offen lds
    s_add_u32 m0, s54, 49152
    s_add_u32 s53, s50, 0
    buffer_load_dwordx4 v218, s[28:31], s53 offen lds
    v_mfma_f32_16x16x32_bf16 v[48:51], v[168:171], v[160:163], v[48:51]
    ds_read_b64_tr_b16 v[184:185], v195 offset:256
    v_mfma_f32_16x16x32_bf16 v[52:55], v[168:171], v[164:167], v[52:55]
    ds_read_b64_tr_b16 v[186:187], v195 offset:2304
    s_add_u32 m0, s55, 53248
    s_add_u32 s53, s51, 30720
    buffer_load_dwordx4 v220, s[32:35], s53 offen lds
    s_add_u32 m0, s55, 57344
    s_add_u32 s53, s51, 61440
    buffer_load_dwordx4 v219, s[32:35], s53 offen lds
    v_mfma_f32_16x16x32_bf16 v[56:59], v[172:175], v[160:163], v[56:59]
    ds_read_b64_tr_b16 v[188:189], v196 offset:256
    v_mfma_f32_16x16x32_bf16 v[60:63], v[172:175], v[164:167], v[60:63]
    ds_read_b64_tr_b16 v[190:191], v196 offset:2304
    s_add_u32 m0, s54, 53248
    s_add_u32 s53, s50, 40960
    buffer_load_dwordx4 v218, s[28:31], s53 offen lds
    s_add_u32 m0, s55, 61440
    s_add_u32 s53, s51, 92160
    buffer_load_dwordx4 v220, s[32:35], s53 offen lds
    s_waitcnt lgkmcnt(6)
    v_mfma_f32_16x16x32_bf16 v[24:27], v[176:179], v[152:155], v[24:27]
    ds_read_b128 v[160:163], v193 offset:0
    v_mfma_f32_16x16x32_bf16 v[28:31], v[176:179], v[156:159], v[28:31]
    ds_read_b128 v[164:167], v193 offset:2048
    ds_read_b64_tr_b16 v[168:169], v195 offset:512
    ds_read_b64_tr_b16 v[170:171], v195 offset:2560
    s_add_u32 m0, s55, 65536
    s_add_u32 s53, s51, 122880
    buffer_load_dwordx4 v219, s[32:35], s53 offen lds
    s_waitcnt lgkmcnt(8)
    v_mfma_f32_16x16x32_bf16 v[32:35], v[180:183], v[152:155], v[32:35]
    ds_read_b64_tr_b16 v[172:173], v195 offset:16384
    v_mfma_f32_16x16x32_bf16 v[36:39], v[180:183], v[156:159], v[36:39]
    ds_read_b64_tr_b16 v[174:175], v195 offset:18432
    s_add_u32 m0, s54, 57344
    s_add_u32 s53, s50, 81920
    buffer_load_dwordx4 v218, s[28:31], s53 offen lds
    s_waitcnt lgkmcnt(8)
    v_mfma_f32_16x16x32_bf16 v[40:43], v[184:187], v[152:155], v[40:43]
    ds_read_b64_tr_b16 v[176:177], v196 offset:16384
    v_mfma_f32_16x16x32_bf16 v[44:47], v[184:187], v[156:159], v[44:47]
    ds_read_b64_tr_b16 v[178:179], v196 offset:18432
    s_add_u32 m0, s55, 69632
    s_add_u32 s53, s51, 153600
    buffer_load_dwordx4 v220, s[32:35], s53 offen lds
    s_waitcnt lgkmcnt(8)
    v_mfma_f32_16x16x32_bf16 v[48:51], v[188:191], v[152:155], v[48:51]
    ds_read_b64_tr_b16 v[180:181], v195 offset:16640
    v_mfma_f32_16x16x32_bf16 v[52:55], v[188:191], v[156:159], v[52:55]
    ds_read_b64_tr_b16 v[182:183], v195 offset:18688
    s_add_u32 m0, s55, 73728
    s_add_u32 s53, s51, 184320
    buffer_load_dwordx4 v219, s[32:35], s53 offen lds
    s_waitcnt lgkmcnt(6)
    v_mfma_f32_16x16x32_bf16 v[56:59], v[168:171], v[152:155], v[56:59]
    ds_read_b64_tr_b16 v[184:185], v196 offset:16640
    v_mfma_f32_16x16x32_bf16 v[60:63], v[168:171], v[156:159], v[60:63]
    ds_read_b64_tr_b16 v[186:187], v196 offset:18688
    s_add_u32 m0, s54, 61440
    s_add_u32 s53, s50, 122880
    buffer_load_dwordx4 v218, s[28:31], s53 offen lds
    s_waitcnt lgkmcnt(6)
    v_mfma_f32_16x16x32_bf16 v[24:27], v[172:175], v[160:163], v[24:27]
    ds_read_b64_tr_b16 v[188:189], v195 offset:16896
    v_mfma_f32_16x16x32_bf16 v[28:31], v[172:175], v[164:167], v[28:31]
    ds_read_b64_tr_b16 v[190:191], v195 offset:18944
    v_add_u32 v192, 0, v194
    v_add_u32 v195, 0, v197
    v_xor_b32 v193, 64, v192
    v_xor_b32 v196, 32, v195
    s_add_u32 m0, s55, 77824
    s_add_u32 s53, s51, 215040
    buffer_load_dwordx4 v220, s[32:35], s53 offen lds
    s_waitcnt lgkmcnt(6)
    v_mfma_f32_16x16x32_bf16 v[32:35], v[176:179], v[160:163], v[32:35]
    v_mfma_f32_16x16x32_bf16 v[36:39], v[176:179], v[164:167], v[36:39]
    s_waitcnt vmcnt(12) lgkmcnt(0)
    s_barrier
    ds_read_b128 v[152:155], v192 offset:0
    ds_read_b128 v[156:159], v192 offset:2048
    ds_read_b64_tr_b16 v[168:169], v195 offset:0
    ds_read_b64_tr_b16 v[170:171], v195 offset:2048
    ds_read_b64_tr_b16 v[172:173], v196 offset:0
    ds_read_b64_tr_b16 v[174:175], v196 offset:2048
    v_mfma_f32_16x16x32_bf16 v[40:43], v[180:183], v[160:163], v[40:43]
    v_mfma_f32_16x16x32_bf16 v[44:47], v[180:183], v[164:167], v[44:47]
    s_add_u32 s50, s50, 128
    s_add_u32 s51, s51, 245760
    s_cmp_eq_u32 s50, 1280
    s_cselect_b32 s50, 0, s50
    s_cselect_b32 s51, 0, s51
    s_add_u32 m0, s55, 98304
    s_add_u32 s53, s51, 0
    buffer_load_dwordx4 v219, s[32:35], s53 offen lds
    s_add_u32 m0, s54, 98304
    s_add_u32 s53, s50, 0
    buffer_load_dwordx4 v218, s[28:31], s53 offen lds
    v_mfma_f32_16x16x32_bf16 v[48:51], v[184:187], v[160:163], v[48:51]
    ds_read_b64_tr_b16 v[176:177], v195 offset:256
    v_mfma_f32_16x16x32_bf16 v[52:55], v[184:187], v[164:167], v[52:55]
    ds_read_b64_tr_b16 v[178:179], v195 offset:2304
    s_add_u32 m0, s55, 102400
    s_add_u32 s53, s51, 30720
    buffer_load_dwordx4 v220, s[32:35], s53 offen lds
    s_add_u32 m0, s55, 106496
    s_add_u32 s53, s51, 61440
    buffer_load_dwordx4 v219, s[32:35], s53 offen lds
    v_mfma_f32_16x16x32_bf16 v[56:59], v[188:191], v[160:163], v[56:59]
    ds_read_b64_tr_b16 v[180:181], v196 offset:256
    v_mfma_f32_16x16x32_bf16 v[60:63], v[188:191], v[164:167], v[60:63]
    ds_read_b64_tr_b16 v[182:183], v196 offset:2304
    s_add_u32 m0, s54, 102400
    s_add_u32 s53, s50, 40960
    buffer_load_dwordx4 v218, s[28:31], s53 offen lds
    s_add_u32 m0, s55, 110592
    s_add_u32 s53, s51, 92160
    buffer_load_dwordx4 v220, s[32:35], s53 offen lds
    s_waitcnt lgkmcnt(6)
    v_mfma_f32_16x16x32_bf16 v[24:27], v[168:171], v[152:155], v[24:27]
    ds_read_b128 v[160:163], v193 offset:0
    v_mfma_f32_16x16x32_bf16 v[28:31], v[168:171], v[156:159], v[28:31]
    ds_read_b128 v[164:167], v193 offset:2048
    ds_read_b64_tr_b16 v[184:185], v195 offset:512
    ds_read_b64_tr_b16 v[186:187], v195 offset:2560
    s_add_u32 m0, s55, 114688
    s_add_u32 s53, s51, 122880
    buffer_load_dwordx4 v219, s[32:35], s53 offen lds
    s_waitcnt lgkmcnt(8)
    v_mfma_f32_16x16x32_bf16 v[32:35], v[172:175], v[152:155], v[32:35]
    ds_read_b64_tr_b16 v[188:189], v195 offset:16384
    v_mfma_f32_16x16x32_bf16 v[36:39], v[172:175], v[156:159], v[36:39]
    ds_read_b64_tr_b16 v[190:191], v195 offset:18432
    s_add_u32 m0, s54, 106496
    s_add_u32 s53, s50, 81920
    buffer_load_dwordx4 v218, s[28:31], s53 offen lds
    s_waitcnt lgkmcnt(8)
    v_mfma_f32_16x16x32_bf16 v[40:43], v[176:179], v[152:155], v[40:43]
    ds_read_b64_tr_b16 v[168:169], v196 offset:16384
    v_mfma_f32_16x16x32_bf16 v[44:47], v[176:179], v[156:159], v[44:47]
    ds_read_b64_tr_b16 v[170:171], v196 offset:18432
    s_add_u32 m0, s55, 118784
    s_add_u32 s53, s51, 153600
    buffer_load_dwordx4 v220, s[32:35], s53 offen lds
    s_waitcnt lgkmcnt(8)
    v_mfma_f32_16x16x32_bf16 v[48:51], v[180:183], v[152:155], v[48:51]
    ds_read_b64_tr_b16 v[172:173], v195 offset:16640
    v_mfma_f32_16x16x32_bf16 v[52:55], v[180:183], v[156:159], v[52:55]
    ds_read_b64_tr_b16 v[174:175], v195 offset:18688
    s_add_u32 m0, s55, 122880
    s_add_u32 s53, s51, 184320
    buffer_load_dwordx4 v219, s[32:35], s53 offen lds
    s_waitcnt lgkmcnt(6)
    v_mfma_f32_16x16x32_bf16 v[56:59], v[184:187], v[152:155], v[56:59]
    ds_read_b64_tr_b16 v[176:177], v196 offset:16640
    v_mfma_f32_16x16x32_bf16 v[60:63], v[184:187], v[156:159], v[60:63]
    ds_read_b64_tr_b16 v[178:179], v196 offset:18688
    s_add_u32 m0, s54, 110592
    s_add_u32 s53, s50, 122880
    buffer_load_dwordx4 v218, s[28:31], s53 offen lds
    s_waitcnt lgkmcnt(6)
    v_mfma_f32_16x16x32_bf16 v[24:27], v[188:191], v[160:163], v[24:27]
    ds_read_b64_tr_b16 v[180:181], v195 offset:16896
    v_mfma_f32_16x16x32_bf16 v[28:31], v[188:191], v[164:167], v[28:31]
    ds_read_b64_tr_b16 v[182:183], v195 offset:18944
    v_add_u32 v192, 49152, v194
    v_add_u32 v195, 49152, v197
    v_xor_b32 v193, 64, v192
    v_xor_b32 v196, 32, v195
    s_add_u32 m0, s55, 126976
    s_add_u32 s53, s51, 215040
    buffer_load_dwordx4 v220, s[32:35], s53 offen lds
    s_waitcnt lgkmcnt(6)
    v_mfma_f32_16x16x32_bf16 v[32:35], v[168:171], v[160:163], v[32:35]
    v_mfma_f32_16x16x32_bf16 v[36:39], v[168:171], v[164:167], v[36:39]
    s_waitcnt vmcnt(12) lgkmcnt(0)
    s_barrier
    ds_read_b128 v[152:155], v192 offset:0
    ds_read_b128 v[156:159], v192 offset:2048
    ds_read_b64_tr_b16 v[184:185], v195 offset:0
    ds_read_b64_tr_b16 v[186:187], v195 offset:2048
    ds_read_b64_tr_b16 v[188:189], v196 offset:0
    ds_read_b64_tr_b16 v[190:191], v196 offset:2048
    v_mfma_f32_16x16x32_bf16 v[40:43], v[172:175], v[160:163], v[40:43]
    v_mfma_f32_16x16x32_bf16 v[44:47], v[172:175], v[164:167], v[44:47]
    s_add_u32 s50, s50, 128
    s_add_u32 s51, s51, 245760
    s_cmp_eq_u32 s50, 1280
    s_cselect_b32 s50, 0, s50
    s_cselect_b32 s51, 0, s51
    s_add_u32 m0, s55, 0
    s_add_u32 s53, s51, 0
    buffer_load_dwordx4 v219, s[32:35], s53 offen lds
    s_add_u32 m0, s54, 0
    s_add_u32 s53, s50, 0
    buffer_load_dwordx4 v218, s[28:31], s53 offen lds
    v_mfma_f32_16x16x32_bf16 v[48:51], v[176:179], v[160:163], v[48:51]
    ds_read_b64_tr_b16 v[168:169], v195 offset:256
    v_mfma_f32_16x16x32_bf16 v[52:55], v[176:179], v[164:167], v[52:55]
    ds_read_b64_tr_b16 v[170:171], v195 offset:2304
    s_add_u32 m0, s55, 4096
    s_add_u32 s53, s51, 30720
    buffer_load_dwordx4 v220, s[32:35], s53 offen lds
    s_add_u32 m0, s55, 8192
    s_add_u32 s53, s51, 61440
    buffer_load_dwordx4 v219, s[32:35], s53 offen lds
    v_mfma_f32_16x16x32_bf16 v[56:59], v[180:183], v[160:163], v[56:59]
    ds_read_b64_tr_b16 v[172:173], v196 offset:256
    v_mfma_f32_16x16x32_bf16 v[60:63], v[180:183], v[164:167], v[60:63]
    ds_read_b64_tr_b16 v[174:175], v196 offset:2304
    s_add_u32 m0, s54, 4096
    s_add_u32 s53, s50, 40960
    buffer_load_dwordx4 v218, s[28:31], s53 offen lds
    s_add_u32 m0, s55, 12288
    s_add_u32 s53, s51, 92160
    buffer_load_dwordx4 v220, s[32:35], s53 offen lds
    s_waitcnt lgkmcnt(6)
    v_mfma_f32_16x16x32_bf16 v[24:27], v[184:187], v[152:155], v[24:27]
    ds_read_b128 v[160:163], v193 offset:0
    v_mfma_f32_16x16x32_bf16 v[28:31], v[184:187], v[156:159], v[28:31]
    ds_read_b128 v[164:167], v193 offset:2048
    ds_read_b64_tr_b16 v[176:177], v195 offset:512
    ds_read_b64_tr_b16 v[178:179], v195 offset:2560
    s_add_u32 m0, s55, 16384
    s_add_u32 s53, s51, 122880
    buffer_load_dwordx4 v219, s[32:35], s53 offen lds
    s_waitcnt lgkmcnt(8)
    v_mfma_f32_16x16x32_bf16 v[32:35], v[188:191], v[152:155], v[32:35]
    ds_read_b64_tr_b16 v[180:181], v195 offset:16384
    v_mfma_f32_16x16x32_bf16 v[36:39], v[188:191], v[156:159], v[36:39]
    ds_read_b64_tr_b16 v[182:183], v195 offset:18432
    s_add_u32 m0, s54, 8192
    s_add_u32 s53, s50, 81920
    buffer_load_dwordx4 v218, s[28:31], s53 offen lds
    s_waitcnt lgkmcnt(8)
    v_mfma_f32_16x16x32_bf16 v[40:43], v[168:171], v[152:155], v[40:43]
    ds_read_b64_tr_b16 v[184:185], v196 offset:16384
    v_mfma_f32_16x16x32_bf16 v[44:47], v[168:171], v[156:159], v[44:47]
    ds_read_b64_tr_b16 v[186:187], v196 offset:18432
    s_add_u32 m0, s55, 20480
    s_add_u32 s53, s51, 153600
    buffer_load_dwordx4 v220, s[32:35], s53 offen lds
    s_waitcnt lgkmcnt(8)
    v_mfma_f32_16x16x32_bf16 v[48:51], v[172:175], v[152:155], v[48:51]
    ds_read_b64_tr_b16 v[188:189], v195 offset:16640
    v_mfma_f32_16x16x32_bf16 v[52:55], v[172:175], v[156:159], v[52:55]
    ds_read_b64_tr_b16 v[190:191], v195 offset:18688
    s_add_u32 m0, s55, 24576
    s_add_u32 s53, s51, 184320
    buffer_load_dwordx4 v219, s[32:35], s53 offen lds
    s_waitcnt lgkmcnt(6)
    v_mfma_f32_16x16x32_bf16 v[56:59], v[176:179], v[152:155], v[56:59]
    ds_read_b64_tr_b16 v[168:169], v196 offset:16640
    v_mfma_f32_16x16x32_bf16 v[60:63], v[176:179], v[156:159], v[60:63]
    ds_read_b64_tr_b16 v[170:171], v196 offset:18688
    s_add_u32 m0, s54, 12288
    s_add_u32 s53, s50, 122880
    buffer_load_dwordx4 v218, s[28:31], s53 offen lds
    s_waitcnt lgkmcnt(6)
    v_mfma_f32_16x16x32_bf16 v[24:27], v[180:183], v[160:163], v[24:27]
    ds_read_b64_tr_b16 v[172:173], v195 offset:16896
    v_mfma_f32_16x16x32_bf16 v[28:31], v[180:183], v[164:167], v[28:31]
    ds_read_b64_tr_b16 v[174:175], v195 offset:18944
    v_add_u32 v192, 98304, v194
    v_add_u32 v195, 98304, v197
    v_xor_b32 v193, 64, v192
    v_xor_b32 v196, 32, v195
    s_add_u32 m0, s55, 28672
    s_add_u32 s53, s51, 215040
    buffer_load_dwordx4 v220, s[32:35], s53 offen lds
    s_waitcnt lgkmcnt(6)
    v_mfma_f32_16x16x32_bf16 v[32:35], v[184:187], v[160:163], v[32:35]
    v_mfma_f32_16x16x32_bf16 v[36:39], v[184:187], v[164:167], v[36:39]
    s_waitcnt vmcnt(12) lgkmcnt(0)
    s_barrier
    ds_read_b128 v[152:155], v192 offset:0
    ds_read_b128 v[156:159], v192 offset:2048
    ds_read_b64_tr_b16 v[176:177], v195 offset:0
    ds_read_b64_tr_b16 v[178:179], v195 offset:2048
    ds_read_b64_tr_b16 v[180:181], v196 offset:0
    ds_read_b64_tr_b16 v[182:183], v196 offset:2048
    s_setprio 0
    v_mfma_f32_16x16x32_bf16 v[40:43], v[188:191], v[160:163], v[40:43]
    v_mfma_f32_16x16x32_bf16 v[44:47], v[188:191], v[164:167], v[44:47]
    v_mfma_f32_16x16x32_bf16 v[48:51], v[168:171], v[160:163], v[48:51]
    ds_read_b64_tr_b16 v[184:185], v195 offset:256
    v_mfma_f32_16x16x32_bf16 v[52:55], v[168:171], v[164:167], v[52:55]
    ds_read_b64_tr_b16 v[186:187], v195 offset:2304
    v_mfma_f32_16x16x32_bf16 v[56:59], v[172:175], v[160:163], v[56:59]
    ds_read_b64_tr_b16 v[188:189], v196 offset:256
    v_mfma_f32_16x16x32_bf16 v[60:63], v[172:175], v[164:167], v[60:63]
    ds_read_b64_tr_b16 v[190:191], v196 offset:2304
    s_waitcnt lgkmcnt(6)
    v_mfma_f32_16x16x32_bf16 v[24:27], v[176:179], v[152:155], v[24:27]
    ds_read_b128 v[160:163], v193 offset:0
    v_mfma_f32_16x16x32_bf16 v[28:31], v[176:179], v[156:159], v[28:31]
    ds_read_b128 v[164:167], v193 offset:2048
    ds_read_b64_tr_b16 v[168:169], v195 offset:512
    ds_read_b64_tr_b16 v[170:171], v195 offset:2560
    s_waitcnt lgkmcnt(8)
    v_mfma_f32_16x16x32_bf16 v[32:35], v[180:183], v[152:155], v[32:35]
    ds_read_b64_tr_b16 v[172:173], v195 offset:16384
    v_mfma_f32_16x16x32_bf16 v[36:39], v[180:183], v[156:159], v[36:39]
    ds_read_b64_tr_b16 v[174:175], v195 offset:18432
    s_waitcnt lgkmcnt(8)
    v_mfma_f32_16x16x32_bf16 v[40:43], v[184:187], v[152:155], v[40:43]
    ds_read_b64_tr_b16 v[176:177], v196 offset:16384
    v_mfma_f32_16x16x32_bf16 v[44:47], v[184:187], v[156:159], v[44:47]
    ds_read_b64_tr_b16 v[178:179], v196 offset:18432
    s_waitcnt lgkmcnt(8)
    v_mfma_f32_16x16x32_bf16 v[48:51], v[188:191], v[152:155], v[48:51]
    ds_read_b64_tr_b16 v[180:181], v195 offset:16640
    v_mfma_f32_16x16x32_bf16 v[52:55], v[188:191], v[156:159], v[52:55]
    ds_read_b64_tr_b16 v[182:183], v195 offset:18688
    s_waitcnt lgkmcnt(6)
    v_mfma_f32_16x16x32_bf16 v[56:59], v[168:171], v[152:155], v[56:59]
    ds_read_b64_tr_b16 v[184:185], v196 offset:16640
    v_mfma_f32_16x16x32_bf16 v[60:63], v[168:171], v[156:159], v[60:63]
    ds_read_b64_tr_b16 v[186:187], v196 offset:18688
    s_waitcnt lgkmcnt(6)
    v_mfma_f32_16x16x32_bf16 v[24:27], v[172:175], v[160:163], v[24:27]
    ds_read_b64_tr_b16 v[188:189], v195 offset:16896
    v_mfma_f32_16x16x32_bf16 v[28:31], v[172:175], v[164:167], v[28:31]
    ds_read_b64_tr_b16 v[190:191], v195 offset:18944
    v_add_u32 v192, 0, v194
    v_add_u32 v195, 0, v197
    v_xor_b32 v193, 64, v192
    v_xor_b32 v196, 32, v195
    s_waitcnt lgkmcnt(6)
    v_mfma_f32_16x16x32_bf16 v[32:35], v[176:179], v[160:163], v[32:35]
    v_mfma_f32_16x16x32_bf16 v[36:39], v[176:179], v[164:167], v[36:39]
    s_waitcnt vmcnt(0) lgkmcnt(0)
    s_barrier
    ds_read_b128 v[152:155], v192 offset:0
    ds_read_b128 v[156:159], v192 offset:2048
    ds_read_b64_tr_b16 v[168:169], v195 offset:0
    ds_read_b64_tr_b16 v[170:171], v195 offset:2048
    ds_read_b64_tr_b16 v[172:173], v196 offset:0
    ds_read_b64_tr_b16 v[174:175], v196 offset:2048
    v_mfma_f32_16x16x32_bf16 v[40:43], v[180:183], v[160:163], v[40:43]
    v_mfma_f32_16x16x32_bf16 v[44:47], v[180:183], v[164:167], v[44:47]
    v_mfma_f32_16x16x32_bf16 v[48:51], v[184:187], v[160:163], v[48:51]
    ds_read_b64_tr_b16 v[176:177], v195 offset:256
    v_mfma_f32_16x16x32_bf16 v[52:55], v[184:187], v[164:167], v[52:55]
    ds_read_b64_tr_b16 v[178:179], v195 offset:2304
    v_mfma_f32_16x16x32_bf16 v[56:59], v[188:191], v[160:163], v[56:59]
    ds_read_b64_tr_b16 v[180:181], v196 offset:256
    v_mfma_f32_16x16x32_bf16 v[60:63], v[188:191], v[164:167], v[60:63]
    ds_read_b64_tr_b16 v[182:183], v196 offset:2304
    s_waitcnt lgkmcnt(6)
    v_mfma_f32_16x16x32_bf16 v[24:27], v[168:171], v[152:155], v[24:27]
    ds_read_b128 v[160:163], v193 offset:0
    v_mfma_f32_16x16x32_bf16 v[28:31], v[168:171], v[156:159], v[28:31]
    ds_read_b128 v[164:167], v193 offset:2048
    ds_read_b64_tr_b16 v[184:185], v195 offset:512
    ds_read_b64_tr_b16 v[186:187], v195 offset:2560
    v_and_b32 v208, 15, v1
    s_lshl_b32 s65, s45, 5
    v_add_lshl_u32 v209, v208, s65, 2
    s_waitcnt lgkmcnt(8)
    v_mfma_f32_16x16x32_bf16 v[32:35], v[172:175], v[152:155], v[32:35]
    ds_read_b64_tr_b16 v[188:189], v195 offset:16384
    v_mfma_f32_16x16x32_bf16 v[36:39], v[172:175], v[156:159], v[36:39]
    ds_read_b64_tr_b16 v[190:191], v195 offset:18432
    v_add_u32 v209, 147456, v209
    s_lshl_b32 s65, s79, 7
    s_add_u32 s65, s65, 161792
    s_waitcnt lgkmcnt(8)
    v_mfma_f32_16x16x32_bf16 v[40:43], v[176:179], v[152:155], v[40:43]
    ds_read_b64_tr_b16 v[168:169], v196 offset:16384
    v_mfma_f32_16x16x32_bf16 v[44:47], v[176:179], v[156:159], v[44:47]
    ds_read_b64_tr_b16 v[170:171], v196 offset:18432
    v_lshl_add_u32 v208, v208, 2, s65
    ds_read_b32 v210, v209 offset:12288
    ds_read_b32 v4, v209 offset:12800
    s_waitcnt lgkmcnt(10)
    v_mfma_f32_16x16x32_bf16 v[48:51], v[180:183], v[152:155], v[48:51]
    ds_read_b64_tr_b16 v[172:173], v195 offset:16640
    v_mfma_f32_16x16x32_bf16 v[52:55], v[180:183], v[156:159], v[52:55]
    ds_read_b64_tr_b16 v[174:175], v195 offset:18688
    ds_read_b32 v5, v209 offset:13312
    ds_read_b32 v211, v209 offset:12352
    ds_read_b32 v252, v209 offset:12864
    s_waitcnt lgkmcnt(11)
    v_mfma_f32_16x16x32_bf16 v[56:59], v[184:187], v[152:155], v[56:59]
    ds_read_b64_tr_b16 v[176:177], v196 offset:16640
    v_mfma_f32_16x16x32_bf16 v[60:63], v[184:187], v[156:159], v[60:63]
    ds_read_b64_tr_b16 v[178:179], v196 offset:18688
    ds_read_b32 v253, v209 offset:13376
    ds_read_b32 v107, v208 offset:0
    ds_read_b32 v111, v208 offset:64
    s_waitcnt lgkmcnt(14)
    v_mfma_f32_16x16x32_bf16 v[24:27], v[188:191], v[160:163], v[24:27]
    ds_read_b64_tr_b16 v[180:181], v195 offset:16896
    v_mfma_f32_16x16x32_bf16 v[28:31], v[188:191], v[164:167], v[28:31]
    ds_read_b64_tr_b16 v[182:183], v195 offset:18944
    ds_read_b32 v115, v208 offset:128
    ds_read_b32 v119, v208 offset:192
    ds_read_b32 v123, v208 offset:256
    s_waitcnt lgkmcnt(15)
    v_mfma_f32_16x16x32_bf16 v[32:35], v[168:171], v[160:163], v[32:35]
    v_mfma_f32_16x16x32_bf16 v[36:39], v[168:171], v[164:167], v[36:39]
    s_mov_b32 s88, 0xffff
    s_mov_b32 s89, 0
    s_waitcnt lgkmcnt(0)
    s_barrier
    v_mfma_f32_16x16x32_bf16 v[40:43], v[172:175], v[160:163], v[40:43]
    v_mfma_f32_16x16x32_bf16 v[44:47], v[172:175], v[164:167], v[44:47]
    v_sub_f32 v210, 0, v210
    v_cvt_pk_bf16_f32 v212, v210, v5
    v_lshlrev_b32 v213, 16, v212
    v_mfma_f32_16x16x32_bf16 v[48:51], v[176:179], v[160:163], v[48:51]
    v_mfma_f32_16x16x32_bf16 v[52:55], v[176:179], v[164:167], v[52:55]
    v_and_b32 v214, 0xffff0000, v212
    v_sub_f32 v213, v210, v213
    v_sub_f32 v214, v5, v214
    v_mfma_f32_16x16x32_bf16 v[56:59], v[180:183], v[160:163], v[56:59]
    v_mfma_f32_16x16x32_bf16 v[60:63], v[180:183], v[164:167], v[60:63]
    v_cvt_pk_bf16_f32 v213, v210, v213
    v_cvt_pk_bf16_f32 v214, v214, v2
    v_cndmask_b32 v144, 0, v213, s[88:89]
    v_cndmask_b32 v145, 0, v212, s[88:89]
    v_cndmask_b32 v146, 0, v214, s[88:89]
    v_mov_b32 v147, 0
    v_sub_f32 v211, 0, v211
    v_cvt_pk_bf16_f32 v212, v211, v253
    v_lshlrev_b32 v213, 16, v212
    v_and_b32 v214, 0xffff0000, v212
    v_sub_f32 v213, v211, v213
    v_sub_f32 v214, v253, v214
    v_cvt_pk_bf16_f32 v213, v211, v213
    v_cvt_pk_bf16_f32 v214, v214, v2
    v_cndmask_b32 v148, 0, v213, s[88:89]
    v_cndmask_b32 v149, 0, v212, s[88:89]
    v_cndmask_b32 v150, 0, v214, s[88:89]
    v_mov_b32 v151, 0
    v_cvt_pk_bf16_f32 v104, v107, v107
    v_and_b32 v105, 0xffff0000, v104
    v_sub_f32 v105, v107, v105
    v_cvt_pk_bf16_f32 v105, v105, v2
    v_lshl_or_b32 v105, v198, 16, v105
    v_mov_b32 v106, v198
    v_mov_b32 v107, 0
    v_cvt_pk_bf16_f32 v108, v111, v111
    v_and_b32 v109, 0xffff0000, v108
    v_sub_f32 v109, v111, v109
    v_cvt_pk_bf16_f32 v109, v109, v2
    v_lshl_or_b32 v109, v198, 16, v109
    v_mov_b32 v110, v198
    v_mov_b32 v111, 0
    v_cvt_pk_bf16_f32 v112, v115, v115
    v_and_b32 v113, 0xffff0000, v112
    v_sub_f32 v113, v115, v113
    v_cvt_pk_bf16_f32 v113, v113, v2
    v_lshl_or_b32 v113, v198, 16, v113
    v_mov_b32 v114, v198
    v_mov_b32 v115, 0
    v_cvt_pk_bf16_f32 v116, v119, v119
    v_and_b32 v117, 0xffff0000, v116
    v_sub_f32 v117, v119, v117
    v_cvt_pk_bf16_f32 v117, v117, v2
    v_lshl_or_b32 v117, v198, 16, v117
    v_mov_b32 v118, v198
    v_mov_b32 v119, 0
    v_cvt_pk_bf16_f32 v120, v123, v123
    v_and_b32 v121, 0xffff0000, v120
    v_sub_f32 v121, v123, v121
    v_cvt_pk_bf16_f32 v121, v121, v2
    v_lshl_or_b32 v121, v198, 16, v121
    v_mov_b32 v122, v198
    v_mov_b32 v123, 0
    v_mfma_f32_16x16x32_bf16 v[24:27], v[104:107], v[144:147], v[24:27]
    v_mfma_f32_16x16x32_bf16 v[28:31], v[104:107], v[148:151], v[28:31]
    v_mfma_f32_16x16x32_bf16 v[32:35], v[108:111], v[144:147], v[32:35]
    v_mfma_f32_16x16x32_bf16 v[36:39], v[108:111], v[148:151], v[36:39]
    v_mfma_f32_16x16x32_bf16 v[40:43], v[112:115], v[144:147], v[40:43]
    v_mfma_f32_16x16x32_bf16 v[44:47], v[112:115], v[148:151], v[44:47]
    v_mfma_f32_16x16x32_bf16 v[48:51], v[116:119], v[144:147], v[48:51]
    v_mfma_f32_16x16x32_bf16 v[52:55], v[116:119], v[148:151], v[52:55]
    v_mfma_f32_16x16x32_bf16 v[56:59], v[120:123], v[144:147], v[56:59]
    v_mfma_f32_16x16x32_bf16 v[60:63], v[120:123], v[148:151], v[60:63]
    s_mov_b32 s63, 1
    v_mov_b32 v112, 0
    v_mov_b32 v113, 0
    v_mov_b32 v114, 0
    v_mov_b32 v115, 0
    v_lshlrev_b32 v111, 4, v0
    v_add_u32 v110, 93184, v111
    ds_write_b128 v110, v[112:115]
    ds_write_b128 v110, v[112:115] offset:1024
    ds_write_b128 v110, v[112:115] offset:20480
    ds_write_b128 v110, v[112:115] offset:21504
    ds_write_b128 v110, v[112:115] offset:40960
    s_add_u32 s65, s75, 0
    s_cmp_ge_u32 s65, s73
    s_cselect_b32 s61, s73, 0
    s_sub_u32 s65, s65, s61
    s_add_u32 s65, s65, s69
    s_mul_i32 s65, s65, 5120
    s_add_u32 s65, s65, s78
    buffer_load_dwordx4 v[152:155], v6, s[36:39], s65 offen offset:0 sc1
    buffer_load_dwordx4 v[156:159], v6, s[36:39], s65 offen offset:1024 sc1
    buffer_load_dwordx4 v[160:163], v6, s[36:39], s65 offen offset:2048 sc1
    buffer_load_dwordx4 v[164:167], v6, s[36:39], s65 offen offset:3072 sc1
    s_add_u32 s65, s65, 4096
    buffer_load_dwordx4 v[168:171], v6, s[36:39], s65 offen offset:0 sc1
    s_add_u32 s65, s75, 1
    s_cmp_ge_u32 s65, s73
    s_cselect_b32 s61, s73, 0
    s_sub_u32 s65, s65, s61
    s_add_u32 s65, s65, s69
    s_mul_i32 s65, s65, 5120
    s_add_u32 s65, s65, s78
    buffer_load_dwordx4 v[172:175], v6, s[36:39], s65 offen offset:0 sc1
    buffer_load_dwordx4 v[176:179], v6, s[36:39], s65 offen offset:1024 sc1
    buffer_load_dwordx4 v[180:183], v6, s[36:39], s65 offen offset:2048 sc1
    buffer_load_dwordx4 v[184:187], v6, s[36:39], s65 offen offset:3072 sc1
    s_add_u32 s65, s65, 4096
    buffer_load_dwordx4 v[188:191], v6, s[36:39], s65 offen offset:0 sc1
    s_add_u32 s65, s75, 2
    s_cmp_ge_u32 s65, s73
    s_cselect_b32 s61, s73, 0
    s_sub_u32 s65, s65, s61
    s_add_u32 s65, s65, s69
    s_mul_i32 s65, s65, 5120
    s_add_u32 s65, s65, s78
    buffer_load_dwordx4 v[192:195], v6, s[36:39], s65 offen offset:0 sc1
    buffer_load_dwordx4 v[196:199], v6, s[36:39], s65 offen offset:1024 sc1
    buffer_load_dwordx4 v[200:203], v6, s[36:39], s65 offen offset:2048 sc1
    buffer_load_dwordx4 v[204:207], v6, s[36:39], s65 offen offset:3072 sc1
    s_add_u32 s65, s65, 4096
    buffer_load_dwordx4 v[208:211], v6, s[36:39], s65 offen offset:0 sc1
    s_add_u32 s65, s75, 3
    s_cmp_ge_u32 s65, s73
    s_cselect_b32 s61, s73, 0
    s_sub_u32 s65, s65, s61
    s_add_u32 s65, s65, s69
    s_mul_i32 s65, s65, 5120
    s_add_u32 s65, s65, s78
    buffer_load_dwordx4 v[212:215], v6, s[36:39], s65 offen offset:0 sc1
    buffer_load_dwordx4 v[216:219], v6, s[36:39], s65 offen offset:1024 sc1
    buffer_load_dwordx4 v[220:223], v6, s[36:39], s65 offen offset:2048 sc1
    buffer_load_dwordx4 v[224:227], v6, s[36:39], s65 offen offset:3072 sc1
    s_add_u32 s65, s65, 4096
    buffer_load_dwordx4 v[228:231], v6, s[36:39], s65 offen offset:0 sc1
    s_add_u32 s65, s75, 4
    s_cmp_ge_u32 s65, s73
    s_cselect_b32 s61, s73, 0
    s_sub_u32 s65, s65, s61
    s_add_u32 s65, s65, s69
    s_mul_i32 s65, s65, 5120
    s_add_u32 s65, s65, s78
    buffer_load_dwordx4 v[232:235], v6, s[36:39], s65 offen offset:0 sc1
    buffer_load_dwordx4 v[236:239], v6, s[36:39], s65 offen offset:1024 sc1
    buffer_load_dwordx4 v[240:243], v6, s[36:39], s65 offen offset:2048 sc1
    buffer_load_dwordx4 v[244:247], v6, s[36:39], s65 offen offset:3072 sc1
    s_add_u32 s65, s65, 4096
    buffer_load_dwordx4 v[248:251], v6, s[36:39], s65 offen offset:0 sc1
    s_setprio 3
    s_lshl_b32 s57, s44, 1
    s_sub_u32 s57, s57, 10
    s_cmp_lt_u32 s44, 5
    s_cselect_b32 s57, s44, s57
    s_lshl_b32 s57, s57, 10
    v_add_u32 v144, s57, v6
    s_max_u32 s58, s44, 1
    s_add_u32 s58, s58, 4
    s_lshl_b32 s58, s58, 10
    v_add_u32 v145, s58, v6
    s_min_u32 s58, s44, 3
    s_add_u32 s58, s58, 6
    s_lshl_b32 s58, s58, 10
    v_add_u32 v147, s58, v6
    v_add_u32 v146, 5120, v144
    s_waitcnt lgkmcnt(0)
    s_barrier
    s_cmp_ge_u32 s44, 5
    s_cbranch_scc1 PZ_1
    ds_read_b128 v[104:107], v144 offset:0
    ds_read_b128 v[108:111], v144 offset:10240
    ds_read_b128 v[112:115], v144 offset:20480
    ds_read_b128 v[116:119], v144 offset:30720
    ds_read_b128 v[76:79], v145 offset:0
    ds_read_b128 v[80:83], v146 offset:0
    ds_read_b128 v[84:87], v147 offset:0
    ds_read_b128 v[88:91], v145 offset:10240
    ds_read_b128 v[92:95], v146 offset:10240
    ds_read_b128 v[96:99], v147 offset:10240
    ds_read_b128 v[100:103], v145 offset:20480
    s_waitcnt lgkmcnt(6)
    v_mfma_f32_16x16x32_bf16 v[64:67], v[104:107], v[76:79], 0
    ds_read_b128 v[76:79], v146 offset:20480
    s_waitcnt lgkmcnt(6)
    v_mfma_f32_16x16x32_bf16 v[68:71], v[104:107], v[80:83], 0
    ds_read_b128 v[80:83], v147 offset:20480
    s_waitcnt lgkmcnt(6)
    v_mfma_f32_16x16x32_bf16 v[72:75], v[104:107], v[84:87], 0
    ds_read_b128 v[84:87], v145 offset:30720
    s_waitcnt lgkmcnt(6)
    v_mfma_f32_16x16x32_bf16 v[64:67], v[108:111], v[88:91], v[64:67]
    ds_read_b128 v[88:91], v146 offset:30720
    s_waitcnt lgkmcnt(6)
    v_mfma_f32_16x16x32_bf16 v[68:71], v[108:111], v[92:95], v[68:71]
    ds_read_b128 v[92:95], v147 offset:30720
    s_waitcnt lgkmcnt(6)
    v_mfma_f32_16x16x32_bf16 v[72:75], v[108:111], v[96:99], v[72:75]
    s_waitcnt lgkmcnt(5)
    v_mfma_f32_16x16x32_bf16 v[64:67], v[112:115], v[100:103], v[64:67]
    s_waitcnt lgkmcnt(4)
    v_mfma_f32_16x16x32_bf16 v[68:71], v[112:115], v[76:79], v[68:71]
    s_waitcnt lgkmcnt(3)
    v_mfma_f32_16x16x32_bf16 v[72:75], v[112:115], v[80:83], v[72:75]
    s_waitcnt lgkmcnt(2)
    v_mfma_f32_16x16x32_bf16 v[64:67], v[116:119], v[84:87], v[64:67]
    s_waitcnt lgkmcnt(1)
    v_mfma_f32_16x16x32_bf16 v[68:71], v[116:119], v[88:91], v[68:71]
    s_waitcnt lgkmcnt(0)
    v_mfma_f32_16x16x32_bf16 v[72:75], v[116:119], v[92:95], v[72:75]
    s_branch PD_2
PZ_1:
    ds_read_b128 v[104:107], v144 offset:0
    ds_read_b128 v[108:111], v144 offset:1024
    ds_read_b128 v[112:115], v144 offset:10240
    ds_read_b128 v[116:119], v144 offset:11264
    ds_read_b128 v[120:123], v144 offset:20480
    ds_read_b128 v[124:127], v144 offset:21504
    ds_read_b128 v[128:131], v144 offset:30720
    ds_read_b128 v[132:135], v144 offset:31744
    v_mov_b32 v76, 0x3f803f80
    v_mov_b32 v77, 0x3f803f80
    v_mov_b32 v78, 0x3f803f80
    v_mov_b32 v79, 0x3f803f80
    s_waitcnt lgkmcnt(7)
    s_nop 0
    v_mfma_f32_16x16x32_bf16 v[64:67], v[104:107], v[76:79], 0
    s_waitcnt lgkmcnt(6)
    v_mfma_f32_16x16x32_bf16 v[68:71], v[108:111], v[76:79], 0
    s_waitcnt lgkmcnt(5)
    v_mfma_f32_16x16x32_bf16 v[64:67], v[112:115], v[76:79], v[64:67]
    s_waitcnt lgkmcnt(4)
    v_mfma_f32_16x16x32_bf16 v[68:71], v[116:119], v[76:79], v[68:71]
    s_waitcnt lgkmcnt(3)
    v_mfma_f32_16x16x32_bf16 v[64:67], v[120:123], v[76:79], v[64:67]
    s_waitcnt lgkmcnt(2)
    v_mfma_f32_16x16x32_bf16 v[68:71], v[124:127], v[76:79], v[68:71]
    s_waitcnt lgkmcnt(1)
    v_mfma_f32_16x16x32_bf16 v[64:67], v[128:131], v[76:79], v[64:67]
    s_waitcnt lgkmcnt(0)
    v_mfma_f32_16x16x32_bf16 v[68:71], v[132:135], v[76:79], v[68:71]
PD_2:
    s_lshl_b32 s57, s47, 13
    s_add_u32 s96, s24, s57
    s_addc_u32 s97, s25, 0
    s_add_u32 s96, s96, 12730368
    s_addc_u32 s97, s97, 0
    v_lshlrev_b32 v144, 2, v0
    v_add_u32 v145, 4096, v144
    v_add_u32 v146, 40960, v144
    v_cmp_gt_u32 vcc, 144, v0
    ds_write_b32 v7, v64 offset:0
    ds_write_b32 v7, v65 offset:84
    ds_write_b32 v7, v66 offset:168
    ds_write_b32 v7, v67 offset:252
    ds_write_b32 v8, v68 offset:0
    ds_write_b32 v8, v69 offset:84
    ds_write_b32 v8, v70 offset:168
    ds_write_b32 v8, v71 offset:252
    ds_write_b32 v9, v72 offset:0
    ds_write_b32 v9, v73 offset:84
    ds_write_b32 v9, v74 offset:168
    ds_write_b32 v9, v75 offset:252
    s_waitcnt lgkmcnt(0)
    s_barrier
    ds_read_b32 v136, v146 offset:0
    ds_read_b32 v137, v146 offset:2048
    ds_read_b32 v138, v146 offset:4096
    ds_read_b32 v139, v146 offset:6144
    s_waitcnt lgkmcnt(3)
    global_atomic_add_f32 v144, v136, s[96:97] offset:0
    s_waitcnt lgkmcnt(2)
    global_atomic_add_f32 v144, v137, s[96:97] offset:2048
    s_waitcnt lgkmcnt(1)
    global_atomic_add_f32 v145, v138, s[96:97] offset:0
    s_waitcnt lgkmcnt(0)
    s_mov_b64 exec, vcc
    global_atomic_add_f32 v145, v139, s[96:97] offset:2048
    s_mov_b64 exec, -1
    v_mul_f32 v112, 0x3fb8aa3b, v4
    v_mul_f32 v113, 0x35860000, v5
    v_mov_b32 v114, v4
    v_mul_f32 v116, 0x3fb8aa3b, v252
    v_mul_f32 v117, 0x35860000, v253
    v_mov_b32 v118, v252
    s_waitcnt vmcnt(0)
    s_barrier
    v_pk_mul_f32 v[104:105], v[24:25], v[112:113] op_sel_hi:[1,0]
    v_pk_mul_f32 v[106:107], v[26:27], v[112:113] op_sel_hi:[1,0]
    v_pk_mul_f32 v[108:109], v[32:33], v[112:113] op_sel_hi:[1,0]
    v_pk_mul_f32 v[110:111], v[34:35], v[112:113] op_sel_hi:[1,0]
    v_exp_f32 v104, v104 clamp
    v_exp_f32 v105, v105 clamp
    v_exp_f32 v106, v106 clamp
    v_exp_f32 v107, v107 clamp
    v_exp_f32 v108, v108 clamp
    v_exp_f32 v109, v109 clamp
    v_exp_f32 v110, v110 clamp
    v_exp_f32 v111, v111 clamp
    v_max_f32 v24, v24, v113
    v_max_f32 v25, v25, v113
    v_max_f32 v26, v26, v113
    v_max_f32 v27, v27, v113
    v_max_f32 v32, v32, v113
    v_max_f32 v33, v33, v113
    v_max_f32 v34, v34, v113
    v_max_f32 v35, v35, v113
    v_pk_fma_f32 v[104:105], v[24:25], v[114:115], v[104:105] op_sel_hi:[1,0,1]
    v_pk_fma_f32 v[106:107], v[26:27], v[114:115], v[106:107] op_sel_hi:[1,0,1]
    v_pk_fma_f32 v[108:109], v[32:33], v[114:115], v[108:109] op_sel_hi:[1,0,1]
    v_pk_fma_f32 v[110:111], v[34:35], v[114:115], v[110:111] op_sel_hi:[1,0,1]
    v_cvt_pk_bf16_f32 v64, v104, v105
    v_cvt_pk_bf16_f32 v65, v106, v107
    v_cvt_pk_bf16_f32 v66, v108, v109
    v_cvt_pk_bf16_f32 v67, v110, v111
    v_pk_mul_f32 v[104:105], v[28:29], v[116:117] op_sel_hi:[1,0]
    v_pk_mul_f32 v[106:107], v[30:31], v[116:117] op_sel_hi:[1,0]
    v_pk_mul_f32 v[108:109], v[36:37], v[116:117] op_sel_hi:[1,0]
    v_pk_mul_f32 v[110:111], v[38:39], v[116:117] op_sel_hi:[1,0]
    v_exp_f32 v104, v104 clamp
    v_exp_f32 v105, v105 clamp
    v_exp_f32 v106, v106 clamp
    v_exp_f32 v107, v107 clamp
    v_exp_f32 v108, v108 clamp
    v_exp_f32 v109, v109 clamp
    v_exp_f32 v110, v110 clamp
    v_exp_f32 v111, v111 clamp
    v_max_f32 v28, v28, v117
    v_max_f32 v29, v29, v117
    v_max_f32 v30, v30, v117
    v_max_f32 v31, v31, v117
    v_max_f32 v36, v36, v117
    v_max_f32 v37, v37, v117
    v_max_f32 v38, v38, v117
    v_max_f32 v39, v39, v117
    v_pk_fma_f32 v[104:105], v[28:29], v[118:119], v[104:105] op_sel_hi:[1,0,1]
    v_pk_fma_f32 v[106:107], v[30:31], v[118:119], v[106:107] op_sel_hi:[1,0,1]
    v_pk_fma_f32 v[108:109], v[36:37], v[118:119], v[108:109] op_sel_hi:[1,0,1]
    v_pk_fma_f32 v[110:111], v[38:39], v[118:119], v[110:111] op_sel_hi:[1,0,1]
    v_cvt_pk_bf16_f32 v76, v104, v105
    v_cvt_pk_bf16_f32 v77, v106, v107
    v_cvt_pk_bf16_f32 v78, v108, v109
    v_cvt_pk_bf16_f32 v79, v110, v111
    v_pk_mul_f32 v[104:105], v[40:41], v[112:113] op_sel_hi:[1,0]
    v_pk_mul_f32 v[106:107], v[42:43], v[112:113] op_sel_hi:[1,0]
    v_pk_mul_f32 v[108:109], v[48:49], v[112:113] op_sel_hi:[1,0]
    v_pk_mul_f32 v[110:111], v[50:51], v[112:113] op_sel_hi:[1,0]
    v_exp_f32 v104, v104 clamp
    v_exp_f32 v105, v105 clamp
    v_exp_f32 v106, v106 clamp
    v_exp_f32 v107, v107 clamp
    v_exp_f32 v108, v108 clamp
    v_exp_f32 v109, v109 clamp
    v_exp_f32 v110, v110 clamp
    v_exp_f32 v111, v111 clamp
    v_max_f32 v40, v40, v113
    v_max_f32 v41, v41, v113
    v_max_f32 v42, v42, v113
    v_max_f32 v43, v43, v113
    v_max_f32 v48, v48, v113
    v_max_f32 v49, v49, v113
    v_max_f32 v50, v50, v113
    v_max_f32 v51, v51, v113
    v_pk_fma_f32 v[104:105], v[40:41], v[114:115], v[104:105] op_sel_hi:[1,0,1]
    v_pk_fma_f32 v[106:107], v[42:43], v[114:115], v[106:107] op_sel_hi:[1,0,1]
    v_pk_fma_f32 v[108:109], v[48:49], v[114:115], v[108:109] op_sel_hi:[1,0,1]
    v_pk_fma_f32 v[110:111], v[50:51], v[114:115], v[110:111] op_sel_hi:[1,0,1]
    v_cvt_pk_bf16_f32 v68, v104, v105
    v_cvt_pk_bf16_f32 v69, v106, v107
    v_cvt_pk_bf16_f32 v70, v108, v109
    v_cvt_pk_bf16_f32 v71, v110, v111
    v_pk_mul_f32 v[104:105], v[44:45], v[116:117] op_sel_hi:[1,0]
    v_pk_mul_f32 v[106:107], v[46:47], v[116:117] op_sel_hi:[1,0]
    v_pk_mul_f32 v[108:109], v[52:53], v[116:117] op_sel_hi:[1,0]
    v_pk_mul_f32 v[110:111], v[54:55], v[116:117] op_sel_hi:[1,0]
    v_exp_f32 v104, v104 clamp
    v_exp_f32 v105, v105 clamp
    v_exp_f32 v106, v106 clamp
    v_exp_f32 v107, v107 clamp
    v_exp_f32 v108, v108 clamp
    v_exp_f32 v109, v109 clamp
    v_exp_f32 v110, v110 clamp
    v_exp_f32 v111, v111 clamp
    v_max_f32 v44, v44, v117
    v_max_f32 v45, v45, v117
    v_max_f32 v46, v46, v117
    v_max_f32 v47, v47, v117
    v_max_f32 v52, v52, v117
    v_max_f32 v53, v53, v117
    v_max_f32 v54, v54, v117
    v_max_f32 v55, v55, v117
    v_pk_fma_f32 v[104:105], v[44:45], v[118:119], v[104:105] op_sel_hi:[1,0,1]
    v_pk_fma_f32 v[106:107], v[46:47], v[118:119], v[106:107] op_sel_hi:[1,0,1]
    v_pk_fma_f32 v[108:109], v[52:53], v[118:119], v[108:109] op_sel_hi:[1,0,1]
    v_pk_fma_f32 v[110:111], v[54:55], v[118:119], v[110:111] op_sel_hi:[1,0,1]
    v_cvt_pk_bf16_f32 v80, v104, v105
    v_cvt_pk_bf16_f32 v81, v106, v107
    v_cvt_pk_bf16_f32 v82, v108, v109
    v_cvt_pk_bf16_f32 v83, v110, v111
    v_pk_mul_f32 v[104:105], v[56:57], v[112:113] op_sel_hi:[1,0]
    v_pk_mul_f32 v[106:107], v[58:59], v[112:113] op_sel_hi:[1,0]
    v_pk_mul_f32 v[108:109], v[60:61], v[116:117] op_sel_hi:[1,0]
    v_pk_mul_f32 v[110:111], v[62:63], v[116:117] op_sel_hi:[1,0]
    v_exp_f32 v104, v104 clamp
    v_exp_f32 v105, v105 clamp
    v_exp_f32 v106, v106 clamp
    v_exp_f32 v107, v107 clamp
    v_exp_f32 v108, v108 clamp
    v_exp_f32 v109, v109 clamp
    v_exp_f32 v110, v110 clamp
    v_exp_f32 v111, v111 clamp
    v_max_f32 v56, v56, v113
    v_max_f32 v57, v57, v113
    v_max_f32 v58, v58, v113
    v_max_f32 v59, v59, v113
    v_max_f32 v60, v60, v117
    v_max_f32 v61, v61, v117
    v_max_f32 v62, v62, v117
    v_max_f32 v63, v63, v117
    v_pk_fma_f32 v[104:105], v[56:57], v[114:115], v[104:105] op_sel_hi:[1,0,1]
    v_pk_fma_f32 v[106:107], v[58:59], v[114:115], v[106:107] op_sel_hi:[1,0,1]
    v_pk_fma_f32 v[108:109], v[60:61], v[118:119], v[108:109] op_sel_hi:[1,0,1]
    v_pk_fma_f32 v[110:111], v[62:63], v[118:119], v[110:111] op_sel_hi:[1,0,1]
    v_cvt_pk_bf16_f32 v72, v104, v105
    v_cvt_pk_bf16_f32 v73, v106, v107
    v_cvt_pk_bf16_f32 v84, v108, v109
    v_cvt_pk_bf16_f32 v85, v110, v111
    v_mov_b32 v74, 0
    v_mov_b32 v75, 0
    v_mov_b32 v86, 0
    v_mov_b32 v87, 0
    s_lshl_b32 s57, s46, 1
    s_lshr_b32 s58, s45, 1
    s_add_u32 s57, s57, s58
    s_mul_i32 s57, s57, 303104
    s_and_b32 s58, s45, 1
    s_lshl_b32 s58, s58, 11
    s_add_u32 s57, s57, s58
    v_add_u32 v148, s57, v6
    v_add_u32 v150, 97280, v6
    v_lshlrev_b32 v112, 2, v0
    v_subrev_u32 v112, 1024, v112
    v_add_u32 v113, 4096, v112
    s_cmp_lg_u32 s44, 4
    s_cbranch_scc1 WF_3
    s_mov_b32 s57, s47
    s_add_u32 s57, s57, 0
    s_lshl_b32 s57, s57, 7
    v_mov_b32 v4, s57
    s_mov_b64 exec, 1
    global_load_dword v5, v4, s[10:11] sc1
    s_waitcnt vmcnt(0)
    v_readfirstlane_b32 s57, v5
    s_nop 0
    s_cmp_ge_u32 s57, 16
    s_cbranch_scc0 PL_4
PB_5:
    s_mov_b64 exec, -1
    v_mov_b32 v4, 162816
    v_mov_b32 v5, 1
    s_mov_b64 exec, 1
    ds_add_u32 v4, v5 offset:0
    s_mov_b64 exec, -1
WF_3:
    v_mov_b32 v4, 162816
    ds_read_b32 v5, v4 offset:0
    s_waitcnt lgkmcnt(0)
    v_readfirstlane_b32 s57, v5
    s_nop 0
    s_cmp_ge_u32 s57, 1
    s_cbranch_scc0 PL_6
PB_7:
    global_load_dword v104, v112, s[96:97] offset:0 sc1
    global_load_dword v105, v112, s[96:97] offset:1024 sc1
    global_load_dword v106, v112, s[96:97] offset:2048 sc1
    global_load_dword v107, v112, s[96:97] offset:3072 sc1
    global_load_dword v108, v113, s[96:97] offset:0 sc1
    global_load_dword v109, v113, s[96:97] offset:1024 sc1
    global_load_dword v110, v113, s[96:97] offset:2048 sc1
    v_cmp_le_u32 vcc, 121856, v11
    s_waitcnt vmcnt(6)
    v_cvt_pk_bf16_f32 v104, v104, v104
    ds_write_b16 v11, v104
    s_mov_b64 exec, vcc
    ds_write_b16 v11, v104 offset:64
    ds_write_b16 v11, v104 offset:128
    ds_write_b16 v11, v104 offset:192
    s_mov_b64 exec, -1
    v_cmp_le_u32 vcc, 121856, v12
    s_waitcnt vmcnt(5)
    v_cvt_pk_bf16_f32 v105, v105, v105
    ds_write_b16 v12, v105
    s_mov_b64 exec, vcc
    ds_write_b16 v12, v105 offset:64
    ds_write_b16 v12, v105 offset:128
    ds_write_b16 v12, v105 offset:192
    s_mov_b64 exec, -1
    v_cmp_le_u32 vcc, 121856, v13
    s_waitcnt vmcnt(4)
    v_cvt_pk_bf16_f32 v106, v106, v106
    ds_write_b16 v13, v106
    s_mov_b64 exec, vcc
    ds_write_b16 v13, v106 offset:64
    ds_write_b16 v13, v106 offset:128
    ds_write_b16 v13, v106 offset:192
    s_mov_b64 exec, -1
    v_cmp_le_u32 vcc, 121856, v14
    s_waitcnt vmcnt(3)
    v_cvt_pk_bf16_f32 v107, v107, v107
    ds_write_b16 v14, v107
    s_mov_b64 exec, vcc
    ds_write_b16 v14, v107 offset:64
    ds_write_b16 v14, v107 offset:128
    ds_write_b16 v14, v107 offset:192
    s_mov_b64 exec, -1
    v_cmp_le_u32 vcc, 121856, v15
    s_waitcnt vmcnt(2)
    v_cvt_pk_bf16_f32 v108, v108, v108
    ds_write_b16 v15, v108
    s_mov_b64 exec, vcc
    ds_write_b16 v15, v108 offset:64
    ds_write_b16 v15, v108 offset:128
    ds_write_b16 v15, v108 offset:192
    s_mov_b64 exec, -1
    v_cmp_le_u32 vcc, 121856, v16
    s_waitcnt vmcnt(1)
    v_cvt_pk_bf16_f32 v109, v109, v109
    ds_write_b16 v16, v109
    s_mov_b64 exec, vcc
    ds_write_b16 v16, v109 offset:64
    ds_write_b16 v16, v109 offset:128
    ds_write_b16 v16, v109 offset:192
    s_mov_b64 exec, -1
    v_cmp_le_u32 vcc, 121856, v17
    s_waitcnt vmcnt(0)
    v_cvt_pk_bf16_f32 v110, v110, v110
    ds_write_b16 v17, v110
    s_mov_b64 exec, vcc
    ds_write_b16 v17, v110 offset:64
    ds_write_b16 v17, v110 offset:128
    ds_write_b16 v17, v110 offset:192
    s_mov_b64 exec, -1
    s_waitcnt lgkmcnt(0)
    v_mov_b32 v4, 162816
    v_mov_b32 v5, 1
    s_mov_b64 exec, 1
    ds_add_u32 v4, v5 offset:4
    s_mov_b64 exec, -1
    v_mov_b32 v4, 162816
    ds_read_b32 v5, v4 offset:4
    s_waitcnt lgkmcnt(0)
    v_readfirstlane_b32 s57, v5
    s_nop 0
    s_cmp_ge_u32 s57, 4
    s_cbranch_scc0 PL_8
PB_9:
    ds_read_b128 v[104:107], v150 offset:24576
    ds_read_b128 v[108:111], v150 offset:40960
    ds_read_b128 v[112:115], v150 offset:41984
    ds_read_b128 v[116:119], v150 offset:0
    ds_read_b128 v[120:123], v150 offset:1024
    ds_read_b128 v[124:127], v150 offset:2048
    ds_read_b128 v[128:131], v150 offset:3072
    ds_read_b128 v[132:135], v150 offset:4096
    ds_read_b128 v[136:139], v150 offset:20480
    ds_read_b128 v[140:143], v150 offset:21504
    ds_read_b128 v[144:147], v150 offset:22528
    s_waitcnt lgkmcnt(10)
    v_mfma_f32_16x16x32_bf16 v[88:91], v[104:107], v[64:67], 0
    v_mfma_f32_16x16x32_bf16 v[92:95], v[104:107], v[76:79], 0
    ds_read_b128 v[104:107], v150 offset:23552
    s_waitcnt lgkmcnt(10)
    v_mfma_f32_16x16x32_bf16 v[88:91], v[108:111], v[68:71], v[88:91]
    v_mfma_f32_16x16x32_bf16 v[92:95], v[108:111], v[80:83], v[92:95]
    s_waitcnt lgkmcnt(9)
    v_mfma_f32_16x16x32_bf16 v[88:91], v[112:115], v[72:75], v[88:91]
    v_mfma_f32_16x16x32_bf16 v[92:95], v[112:115], v[84:87], v[92:95]
    s_waitcnt lgkmcnt(8)
    v_mfma_f32_16x16x32_bf16 v[24:27], v[116:119], v[64:67], 0
    v_mfma_f32_16x16x32_bf16 v[28:31], v[116:119], v[76:79], 0
    s_waitcnt lgkmcnt(7)
    v_mfma_f32_16x16x32_bf16 v[32:35], v[120:123], v[64:67], 0
    v_mfma_f32_16x16x32_bf16 v[36:39], v[120:123], v[76:79], 0
    s_waitcnt lgkmcnt(6)
    v_mfma_f32_16x16x32_bf16 v[32:35], v[124:127], v[68:71], v[32:35]
    v_mfma_f32_16x16x32_bf16 v[36:39], v[124:127], v[80:83], v[36:39]
    s_waitcnt lgkmcnt(5)
    v_mfma_f32_16x16x32_bf16 v[40:43], v[128:131], v[64:67], 0
    v_mfma_f32_16x16x32_bf16 v[44:47], v[128:131], v[76:79], 0
    v_add_f32 v88, 0x358637bd, v88
    v_add_f32 v89, 0x358637bd, v89
    v_add_f32 v90, 0x358637bd, v90
    v_add_f32 v91, 0x358637bd, v91
    v_add_f32 v92, 0x358637bd, v92
    v_add_f32 v93, 0x358637bd, v93
    v_add_f32 v94, 0x358637bd, v94
    v_add_f32 v95, 0x358637bd, v95
    v_rcp_f32 v88, v88
    v_rcp_f32 v89, v89
    v_rcp_f32 v90, v90
    v_rcp_f32 v91, v91
    v_rcp_f32 v92, v92
    v_rcp_f32 v93, v93
    v_rcp_f32 v94, v94
    v_rcp_f32 v95, v95
    s_waitcnt lgkmcnt(4)
    v_mfma_f32_16x16x32_bf16 v[40:43], v[132:135], v[68:71], v[40:43]
    v_mfma_f32_16x16x32_bf16 v[44:47], v[132:135], v[80:83], v[44:47]
    s_waitcnt lgkmcnt(3)
    v_mfma_f32_16x16x32_bf16 v[48:51], v[136:139], v[68:71], 0
    v_mfma_f32_16x16x32_bf16 v[52:55], v[136:139], v[80:83], 0
    s_waitcnt lgkmcnt(2)
    v_mfma_f32_16x16x32_bf16 v[48:51], v[140:143], v[72:75], v[48:51]
    v_mfma_f32_16x16x32_bf16 v[52:55], v[140:143], v[84:87], v[52:55]
    s_waitcnt lgkmcnt(1)
    v_mfma_f32_16x16x32_bf16 v[56:59], v[144:147], v[68:71], 0
    v_mfma_f32_16x16x32_bf16 v[60:63], v[144:147], v[80:83], 0
    s_waitcnt lgkmcnt(0)
    v_mfma_f32_16x16x32_bf16 v[56:59], v[104:107], v[72:75], v[56:59]
    v_mfma_f32_16x16x32_bf16 v[60:63], v[104:107], v[84:87], v[60:63]
    s_mov_b32 s88, 0xffff0000
    s_mov_b32 s89, -1
    s_mov_b32 s90, 0
    s_mov_b32 s91, -1
    s_mov_b32 s86, 0
    s_mov_b32 s87, 0xffff0000
    v_cndmask_b32 v96, v88, v89, s[88:89]
    v_cndmask_b32 v97, v89, v90, s[90:91]
    v_cndmask_b32 v98, v90, v91, s[86:87]
    v_cndmask_b32 v99, v92, v93, s[88:89]
    v_cndmask_b32 v100, v93, v94, s[90:91]
    v_cndmask_b32 v101, v94, v95, s[86:87]
    v_mul_f32 v24, v24, v88
    v_mul_f32 v25, v25, v88
    v_mul_f32 v26, v26, v88
    v_mul_f32 v27, v27, v88
    v_cvt_pk_bf16_f32 v64, v24, v25
    v_cvt_pk_bf16_f32 v65, v26, v27
    v_mul_f32 v32, v32, v96
    v_mul_f32 v33, v33, v96
    v_mul_f32 v34, v34, v96
    v_mul_f32 v35, v35, v96
    v_cvt_pk_bf16_f32 v66, v32, v33
    v_cvt_pk_bf16_f32 v67, v34, v35
    v_mul_f32 v40, v40, v97
    v_mul_f32 v41, v41, v97
    v_mul_f32 v42, v42, v97
    v_mul_f32 v43, v43, v97
    v_cvt_pk_bf16_f32 v68, v40, v41
    v_cvt_pk_bf16_f32 v69, v42, v43
    v_mul_f32 v48, v48, v98
    v_mul_f32 v49, v49, v98
    v_mul_f32 v50, v50, v98
    v_mul_f32 v51, v51, v98
    v_cvt_pk_bf16_f32 v70, v48, v49
    v_cvt_pk_bf16_f32 v71, v50, v51
    v_mul_f32 v56, v56, v91
    v_mul_f32 v57, v57, v91
    v_mul_f32 v58, v58, v91
    v_mul_f32 v59, v59, v91
    v_cvt_pk_bf16_f32 v72, v56, v57
    v_cvt_pk_bf16_f32 v73, v58, v59
    v_mul_f32 v28, v28, v92
    v_mul_f32 v29, v29, v92
    v_mul_f32 v30, v30, v92
    v_mul_f32 v31, v31, v92
    v_cvt_pk_bf16_f32 v74, v28, v29
    v_cvt_pk_bf16_f32 v75, v30, v31
    v_mul_f32 v36, v36, v99
    v_mul_f32 v37, v37, v99
    v_mul_f32 v38, v38, v99
    v_mul_f32 v39, v39, v99
    v_cvt_pk_bf16_f32 v76, v36, v37
    v_cvt_pk_bf16_f32 v77, v38, v39
    v_mul_f32 v44, v44, v100
    v_mul_f32 v45, v45, v100
    v_mul_f32 v46, v46, v100
    v_mul_f32 v47, v47, v100
    v_cvt_pk_bf16_f32 v78, v44, v45
    v_cvt_pk_bf16_f32 v79, v46, v47
    v_mul_f32 v52, v52, v101
    v_mul_f32 v53, v53, v101
    v_mul_f32 v54, v54, v101
    v_mul_f32 v55, v55, v101
    v_cvt_pk_bf16_f32 v80, v52, v53
    v_cvt_pk_bf16_f32 v81, v54, v55
    v_mul_f32 v60, v60, v95
    v_mul_f32 v61, v61, v95
    v_mul_f32 v62, v62, v95
    v_mul_f32 v63, v63, v95
    v_cvt_pk_bf16_f32 v82, v60, v61
    v_cvt_pk_bf16_f32 v83, v62, v63
    s_mul_i32 s57, s47, 5
    s_lshr_b32 s57, s57, 1
    s_add_u32 s57, s57, 54
    s_lshl_b32 s57, s57, 12
    s_add_u32 s58, s57, 4096
    s_add_u32 s59, s57, 8192
    s_bitcmp1_b32 s47, 0
    s_cbranch_scc1 O_ODD
    buffer_store_dwordx4 v[64:67], v148, s[36:39], s57 offen offset:0 sc1
    buffer_store_dwordx4 v[68:71], v148, s[36:39], s58 offen offset:0 sc1
    buffer_store_dwordx2 v[72:73], v148, s[36:39], s59 offen offset:0 sc1
    buffer_store_dwordx4 v[74:77], v148, s[36:39], s57 offen offset:1024 sc1
    buffer_store_dwordx4 v[78:81], v148, s[36:39], s58 offen offset:1024 sc1
    buffer_store_dwordx2 v[82:83], v148, s[36:39], s59 offen offset:1024 sc1
    s_branch O_DONE
O_ODD:
    buffer_store_dwordx2 v[64:65], v148, s[36:39], s57 offen offset:8 sc1
    buffer_store_dwordx4 v[66:69], v148, s[36:39], s58 offen offset:0 sc1
    buffer_store_dwordx4 v[70:73], v148, s[36:39], s59 offen offset:0 sc1
    buffer_store_dwordx2 v[74:75], v148, s[36:39], s57 offen offset:1032 sc1
    buffer_store_dwordx4 v[76:79], v148, s[36:39], s58 offen offset:1024 sc1
    buffer_store_dwordx4 v[80:83], v148, s[36:39], s59 offen offset:1024 sc1
O_DONE:
    s_lshl_b32 s57, s46, 3
    s_add_u32 s57, s57, s47
    s_add_u32 s57, s57, 136
    s_lshl_b32 s57, s57, 7
    v_mov_b32 v252, s57
    v_mov_b32 v253, 1
    s_waitcnt vmcnt(0)
    s_mov_b64 exec, 1
    global_atomic_add v252, v253, s[10:11]
    s_mov_b64 exec, -1
    s_lshr_b32 s57, s67, 1
    s_lshl_b32 s57, s57, 3
    s_add_u32 s57, s57, s44
    s_add_u32 s57, s57, 8
    v_lshlrev_b32 v4, 2, v1
    v_or_b32 v4, s44, v4
    s_sub_u32 s57, s57, s44
    v_add_u32 v4, s57, v4
    v_lshlrev_b32 v4, 7, v4
    s_mov_b64 exec, 3
    global_load_dword v5, v4, s[10:11] sc1
    s_waitcnt vmcnt(0)
    v_cmp_gt_u32 vcc, 1, v5
    s_nop 0
    s_cmp_eq_u64 vcc, 0
    s_cbranch_scc0 PL_10
PB_11:
    s_mov_b64 exec, -1
    s_add_u32 s65, s76, 0
    s_cmp_ge_u32 s65, s74
    s_cselect_b32 s61, s74, 0
    s_sub_u32 s65, s65, s61
    s_add_u32 s65, s65, s72
    s_mul_i32 s65, s65, 5120
    s_add_u32 s65, s65, s78
    s_mul_i32 s66, s44, 20480
    s_add_u32 m0, s66, 0
    s_nop 0
    buffer_load_dwordx4 v6, s[36:39], s65 offen sc1 lds
    s_add_u32 s65, s65, 1024
    s_add_u32 m0, s66, 1024
    s_nop 0
    buffer_load_dwordx4 v6, s[36:39], s65 offen sc1 lds
    s_add_u32 s65, s65, 1024
    s_add_u32 m0, s66, 2048
    s_nop 0
    buffer_load_dwordx4 v6, s[36:39], s65 offen sc1 lds
    s_add_u32 s65, s65, 1024
    s_add_u32 m0, s66, 3072
    s_nop 0
    buffer_load_dwordx4 v6, s[36:39], s65 offen sc1 lds
    s_add_u32 s65, s65, 1024
    s_add_u32 m0, s66, 4096
    s_nop 0
    buffer_load_dwordx4 v6, s[36:39], s65 offen sc1 lds
    s_add_u32 s65, s76, 1
    s_cmp_ge_u32 s65, s74
    s_cselect_b32 s61, s74, 0
    s_sub_u32 s65, s65, s61
    s_add_u32 s65, s65, s72
    s_mul_i32 s65, s65, 5120
    s_add_u32 s65, s65, s78
    s_mul_i32 s66, s44, 20480
    s_add_u32 m0, s66, 5120
    s_nop 0
    buffer_load_dwordx4 v6, s[36:39], s65 offen sc1 lds
    s_add_u32 s65, s65, 1024
    s_add_u32 m0, s66, 6144
    s_nop 0
    buffer_load_dwordx4 v6, s[36:39], s65 offen sc1 lds
    s_add_u32 s65, s65, 1024
    s_add_u32 m0, s66, 7168
    s_nop 0
    buffer_load_dwordx4 v6, s[36:39], s65 offen sc1 lds
    s_add_u32 s65, s65, 1024
    s_add_u32 m0, s66, 8192
    s_nop 0
    buffer_load_dwordx4 v6, s[36:39], s65 offen sc1 lds
    s_add_u32 s65, s65, 1024
    s_add_u32 m0, s66, 9216
    s_nop 0
    buffer_load_dwordx4 v6, s[36:39], s65 offen sc1 lds
    s_add_u32 s65, s76, 2
    s_cmp_ge_u32 s65, s74
    s_cselect_b32 s61, s74, 0
    s_sub_u32 s65, s65, s61
    s_add_u32 s65, s65, s72
    s_mul_i32 s65, s65, 5120
    s_add_u32 s65, s65, s78
    s_cmp_gt_u32 s74, 2
    s_cselect_b32 s65, s65, 2130706432
    s_mul_i32 s66, s44, 20480
    s_add_u32 m0, s66, 10240
    s_nop 0
    buffer_load_dwordx4 v6, s[36:39], s65 offen sc1 lds
    s_add_u32 s65, s65, 1024
    s_add_u32 m0, s66, 11264
    s_nop 0
    buffer_load_dwordx4 v6, s[36:39], s65 offen sc1 lds
    s_add_u32 s65, s65, 1024
    s_add_u32 m0, s66, 12288
    s_nop 0
    buffer_load_dwordx4 v6, s[36:39], s65 offen sc1 lds
    s_add_u32 s65, s65, 1024
    s_add_u32 m0, s66, 13312
    s_nop 0
    buffer_load_dwordx4 v6, s[36:39], s65 offen sc1 lds
    s_add_u32 s65, s65, 1024
    s_add_u32 m0, s66, 14336
    s_nop 0
    buffer_load_dwordx4 v6, s[36:39], s65 offen sc1 lds
    s_add_u32 s53, s75, 0
    s_cmp_ge_u32 s53, s73
    s_cselect_b32 s61, s73, 0
    s_sub_u32 s53, s53, s61
    s_add_u32 s53, s53, s69
    s_mul_i32 s53, s53, 4096
    s_add_u32 s53, s53, s77
    s_setprio 3
    buffer_load_dwordx4 v[104:107], v6, s[36:39], s53 offen offset:0 sc1
    buffer_load_dwordx4 v[108:111], v6, s[36:39], s53 offen offset:1024 sc1
    buffer_load_dwordx4 v[112:115], v6, s[36:39], s53 offen offset:2048 sc1
    buffer_load_dwordx4 v[116:119], v6, s[36:39], s53 offen offset:3072 sc1
    s_add_u32 s53, s75, 1
    s_cmp_ge_u32 s53, s73
    s_cselect_b32 s61, s73, 0
    s_sub_u32 s53, s53, s61
    s_add_u32 s53, s53, s69
    s_mul_i32 s53, s53, 4096
    s_add_u32 s53, s53, s77
    s_setprio 2
    buffer_load_dwordx4 v[120:123], v6, s[36:39], s53 offen offset:0 sc1
    buffer_load_dwordx4 v[124:127], v6, s[36:39], s53 offen offset:1024 sc1
    buffer_load_dwordx4 v[128:131], v6, s[36:39], s53 offen offset:2048 sc1
    buffer_load_dwordx4 v[132:135], v6, s[36:39], s53 offen offset:3072 sc1
    s_add_u32 s53, s75, 2
    s_cmp_ge_u32 s53, s73
    s_cselect_b32 s61, s73, 0
    s_sub_u32 s53, s53, s61
    s_add_u32 s53, s53, s69
    s_mul_i32 s53, s53, 4096
    s_add_u32 s53, s53, s77
    s_setprio 1
    buffer_load_dwordx4 v[136:139], v6, s[36:39], s53 offen offset:0 sc1
    buffer_load_dwordx4 v[140:143], v6, s[36:39], s53 offen offset:1024 sc1
    buffer_load_dwordx4 v[144:147], v6, s[36:39], s53 offen offset:2048 sc1
    buffer_load_dwordx4 v[148:151], v6, s[36:39], s53 offen offset:3072 sc1
    s_setprio 0
    s_branch PHASE2C
ROLE_KV:
    s_mov_b32 s79, 0
    s_waitcnt lgkmcnt(0)
    s_mov_b32 s28, s4
    s_mov_b32 s29, s5
    s_mov_b32 s30, 2621440
    s_mov_b32 s31, 0x20000
    s_mov_b32 s36, s24
    s_mov_b32 s37, s25
    s_mov_b32 s38, 12866560
    s_mov_b32 s39, 0x20000
    s_add_u32 s10, s24, 12812288
    s_addc_u32 s11, s25, 0
    v_mov_b32 v112, 0
    v_mov_b32 v113, 0
    v_mov_b32 v114, 0
    v_mov_b32 v115, 0
    v_mov_b32 v117, 162816
    ds_write_b128 v117, v[112:115]
    ds_write_b128 v117, v[112:115] offset:16
    s_cmp_lg_u32 s45, 3
    s_cbranch_scc1 NI_12
    s_and_b32 s57, s2, 196
    s_cbranch_scc1 NI_12
    v_mov_b32 v112, 0
    v_mov_b32 v113, 0
    v_mov_b32 v114, 0
    v_mov_b32 v115, 0
    s_lshr_b32 s57, s2, 3
    s_lshl_b32 s57, s57, 2
    s_and_b32 s58, s2, 3
    s_add_u32 s57, s57, s58
    s_mul_i32 s57, s57, 4256
    s_add_u32 s57, s57, 12730368
    buffer_store_dwordx4 v[112:115], v6, s[36:39], s57 offen sc1
    buffer_store_dwordx4 v[112:115], v6, s[36:39], s57 offen offset:1024 sc1
    buffer_store_dwordx4 v[112:115], v6, s[36:39], s57 offen offset:2048 sc1
    buffer_store_dwordx4 v[112:115], v6, s[36:39], s57 offen offset:3072 sc1
    buffer_store_dwordx4 v[112:115], v6, s[36:39], s57 offen offset:3232 sc1
    v_mov_b32 v116, 1
    s_waitcnt vmcnt(0)
    s_mov_b64 exec, 1
    global_atomic_add v2, v116, s[22:23]
    s_mov_b64 exec, -1
NI_12:
    s_getpc_b64 s[26:27]
PC_13:
    s_sub_u32 s26, s26, PC_13-parallel_sum__linear_attn_block__mixer_channel_mlp__prompt_kernel
    s_subb_u32 s27, s27, 0
    s_bfe_u32 s57, s2, 0x20003
    s_lshl_b32 s57, s57, 14
    v_lshlrev_b32 v106, 6, v0
    v_add_u32 v106, s57, v106
    v_min_u32 v106, CODE_END-parallel_sum__linear_attn_block__mixer_channel_mlp__prompt_kernel-4, v106
    v_mov_b32 v107, s27
    v_add_co_u32 v106, vcc, s26, v106
    s_nop 1
    v_addc_co_u32 v107, vcc, 0, v107, vcc
    s_mov_b32 exec_lo, 0x55555555
    s_mov_b32 exec_hi, 0x55555555
    global_load_dword v4, v[106:107], off
    s_mov_b64 exec, -1
    s_lshl_b32 s57, s45, 8
    s_add_u32 s60, s57, s2
    s_mul_i32 s59, s60, 6554
    s_lshr_b32 s59, s59, 16
    s_mul_i32 s57, s59, 10
    s_sub_u32 s58, s60, s57
    s_min_u32 s53, s45, 2
    s_lshl_b32 s53, s53, 12
    s_add_u32 s63, s53, 147456
    s_cmp_lt_u32 s59, 54
    s_cselect_b32 s40, s16, s8
    s_cselect_b32 s41, s17, s9
    s_mov_b32 s42, 819200
    s_cselect_b32 s42, 2211840, s42
    s_mov_b32 s43, 0x20000
    s_cselect_b32 s57, 0, 54
    s_sub_u32 s57, s59, s57
    s_mul_i32 s57, s57, 40960
    s_lshl_b32 s53, s58, 7
    s_add_u32 s62, s57, s53
    v_lshrrev_b32 v140, 3, v1
    v_mul_u32_u24 v140, 1280, v140
    v_and_b32 v141, 7, v1
    v_lshl_add_u32 v206, v141, 4, v140
    s_cmp_lt_u32 s60, 740
    s_cselect_b32 s64, -1, 0
    s_barrier
    s_mov_b32 exec_lo, s64
    s_mov_b32 exec_hi, s64
    s_add_u32 m0, s63, 0
    s_add_u32 s65, s62, 0
    buffer_load_dwordx4 v206, s[40:43], s65 offen nt lds
    s_add_u32 m0, s63, 1024
    s_add_u32 s65, s62, 10240
    buffer_load_dwordx4 v206, s[40:43], s65 offen nt lds
    s_add_u32 m0, s63, 2048
    s_add_u32 s65, s62, 20480
    buffer_load_dwordx4 v206, s[40:43], s65 offen nt lds
    s_add_u32 m0, s63, 3072
    s_add_u32 s65, s62, 30720
    buffer_load_dwordx4 v206, s[40:43], s65 offen nt lds
    s_mov_b64 exec, -1
    s_lshl_b32 s57, s58, 2
    s_add_u32 s57, s57, 0
    s_mul_i32 s65, s57, 52
    s_lshr_b32 s65, s65, 8
    s_mul_i32 s65, s65, 373760
    s_lshl_b32 s57, s57, 10
    s_add_u32 s57, s57, s65
    s_mul_i32 s65, s59, 5120
    s_add_u32 s57, s57, s65
    s_add_u32 s57, s57, 9699328
    s_cmp_lt_u32 s60, 740
    s_cselect_b32 s80, s57, 2130706432
    s_lshl_b32 s57, s58, 2
    s_add_u32 s57, s57, 1
    s_mul_i32 s65, s57, 52
    s_lshr_b32 s65, s65, 8
    s_mul_i32 s65, s65, 373760
    s_lshl_b32 s57, s57, 10
    s_add_u32 s57, s57, s65
    s_mul_i32 s65, s59, 5120
    s_add_u32 s57, s57, s65
    s_add_u32 s57, s57, 9699328
    s_cmp_lt_u32 s60, 740
    s_cselect_b32 s81, s57, 2130706432
    s_lshl_b32 s57, s58, 2
    s_add_u32 s57, s57, 2
    s_mul_i32 s65, s57, 52
    s_lshr_b32 s65, s65, 8
    s_mul_i32 s65, s65, 373760
    s_lshl_b32 s57, s57, 10
    s_add_u32 s57, s57, s65
    s_mul_i32 s65, s59, 5120
    s_add_u32 s57, s57, s65
    s_add_u32 s57, s57, 9699328
    s_cmp_lt_u32 s60, 740
    s_cselect_b32 s82, s57, 2130706432
    s_lshl_b32 s57, s58, 2
    s_add_u32 s57, s57, 3
    s_mul_i32 s65, s57, 52
    s_lshr_b32 s65, s65, 8
    s_mul_i32 s65, s65, 373760
    s_lshl_b32 s57, s57, 10
    s_add_u32 s57, s57, s65
    s_mul_i32 s65, s59, 5120
    s_add_u32 s57, s57, s65
    s_add_u32 s57, s57, 9699328
    s_cmp_lt_u32 s60, 740
    s_cselect_b32 s83, s57, 2130706432
    v_lshrrev_b32 v140, 2, v1
    v_lshlrev_b32 v140, 7, v140
    v_and_b32 v141, 3, v1
    v_lshl_add_u32 v140, v141, 3, v140
    v_add_u32 v218, s63, v140
    v_and_b32 v140, 15, v1
    s_lshl_b32 s57, s45, 5
    v_add_u32 v140, s57, v140
    v_bfe_u32 v141, v140, 1, 3
    v_lshrrev_b32 v142, 4, v1
    v_xor_b32 v141, v141, v142
    v_lshlrev_b32 v141, 4, v141
    v_lshl_add_u32 v194, v140, 7, v141
    v_mul_u32_u24 v140, 4096, v142
    v_and_b32 v142, 1, v142
    v_lshl_add_u32 v140, v142, 5, v140
    v_bfe_u32 v141, v1, 2, 2
    v_lshl_add_u32 v140, v141, 6, v140
    v_and_b32 v141, 3, v1
    v_lshl_add_u32 v140, v141, 3, v140
    v_add_u32 v197, 16384, v140
    s_min_u32 s57, s44, 7
    s_lshl_b32 s57, s57, 8
    s_add_u32 s57, s57, 16384
    v_add_u32 v226, s57, v140
    v_xor_b32 v227, 32, v226
    v_mov_b32 v136, 0x3f803f80
    v_mov_b32 v137, 0x3f803f80
    v_mov_b32 v138, 0x3f803f80
    v_mov_b32 v139, 0x3f803f80
    s_and_b32 s57, s2, 3
    s_lshl_b32 s57, s57, 3
    s_bfe_u32 s58, s2, 0x30003
    s_add_u32 s67, s57, s58
    s_bfe_u32 s57, s2, 0x10002
    s_lshl_b32 s57, s57, 2
    s_lshr_b32 s58, s2, 6
    s_add_u32 s68, s57, s58
    s_lshl_b32 s57, s45, 3
    s_lshr_b32 s70, 0x302a231c, s57
    s_and_b32 s70, s70, 255
    s_cmp_eq_u32 s48, 0
    s_cselect_b32 s60, 0, 0
    s_mul_i32 s57, s44, 7
    s_add_u32 s58, s70, s60
    s_cmp_lt_u32 s44, 6
    s_cselect_b32 s59, 7, 6
    s_sub_u32 s59, s59, s60
    s_cmp_lt_u32 s44, 4
    s_cselect_b32 s69, s57, s58
    s_cselect_b32 s73, 7, s59
    s_cselect_b32 s71, s60, 0
    s_and_b32 s57, s44, 1
    s_sub_u32 s74, 3, s57
    s_mul_i32 s57, s57, 3
    s_lshr_b32 s58, s44, 1
    s_mul_i32 s58, s58, 5
    s_add_u32 s57, s57, s58
    s_add_u32 s72, s57, 54
    s_and_b32 s57, s68, 3
    s_mul_i32 s75, s57, 2
    s_mul_i32 s76, s57, 1
    s_cmp_ge_u32 s75, s73
    s_cselect_b32 s57, s73, 0
    s_sub_u32 s75, s75, s57
    s_cmp_ge_u32 s75, s73
    s_cselect_b32 s57, s73, 0
    s_sub_u32 s75, s75, s57
    s_cmp_ge_u32 s76, s74
    s_cselect_b32 s57, s74, 0
    s_sub_u32 s76, s76, s57
    s_cmp_ge_u32 s76, s74
    s_cselect_b32 s57, s74, 0
    s_sub_u32 s76, s76, s57
    s_cmp_ge_u32 s76, s74
    s_cselect_b32 s57, s74, 0
    s_sub_u32 s76, s76, s57
    s_mul_i32 s77, s67, 303104
    s_mul_i32 s78, s68, 378880
    s_add_u32 s78, s78, 9699328
    v_mov_b32 v198, 0x3586
    v_mov_b32 v148, 47680
    v_and_b32 v140, 15, v1
    v_lshrrev_b32 v141, 4, v1
    v_lshlrev_b32 v141, 2, v141
    v_cmp_eq_u32 s[86:87], 0, v140
    s_movk_i32 s60, 84
    s_lshl_b32 s57, s44, 1
    s_add_u32 s57, s57, -10
    s_cmp_lt_u32 s44, 5
    s_cselect_b32 s58, s44, s57
    s_add_u32 s59, s44, -1
    s_lshl_b32 s57, s58, 4
    v_add_u32 v142, s57, v141
    s_lshl_b32 s57, s59, 4
    v_add_u32 v143, s57, v140
    v_mul_u32_u24 v144, 3277, v142
    v_lshrrev_b32 v144, 16, v144
    v_mul_u32_u24 v145, 3277, v143
    v_lshrrev_b32 v145, 16, v145
    v_mul_u32_u24 v146, 20, v145
    v_sub_u32 v146, v143, v146
    v_cmp_eq_u32 vcc, v144, v145
    s_nop 0
    s_mov_b64 s[88:89], vcc
    v_cmp_gt_u32 vcc, 80, v143
    s_nop 0
    s_and_b64 s[88:89], s[88:89], vcc
    s_cmp_lt_u32 s44, 5
    s_cselect_b64 s[88:89], s[88:89], s[86:87]
    s_cselect_b64 s[90:91], 0, -1
    v_cndmask_b32 v146, v146, 20, s[90:91]
    v_cmp_gt_u32 vcc, 80, v142
    s_nop 0
    s_and_b64 vcc, vcc, s[88:89]
    v_lshlrev_b32 v146, 2, v146
    v_mad_u32_u24 v146, v142, s60, v146
    v_add_u32 v146, 40960, v146
    v_cndmask_b32 v7, v148, v146, vcc
    s_lshl_b32 s57, s44, 1
    s_add_u32 s57, s57, -9
    s_cmp_lt_u32 s44, 5
    s_cselect_b32 s58, s44, s57
    s_add_u32 s59, s44, 0
    s_lshl_b32 s57, s58, 4
    v_add_u32 v142, s57, v141
    s_lshl_b32 s57, s59, 4
    v_add_u32 v143, s57, v140
    v_mul_u32_u24 v144, 3277, v142
    v_lshrrev_b32 v144, 16, v144
    v_mul_u32_u24 v145, 3277, v143
    v_lshrrev_b32 v145, 16, v145
    v_mul_u32_u24 v146, 20, v145
    v_sub_u32 v146, v143, v146
    v_cmp_eq_u32 vcc, v144, v145
    s_nop 0
    s_mov_b64 s[88:89], vcc
    v_cmp_gt_u32 vcc, 80, v143
    s_nop 0
    s_and_b64 s[88:89], s[88:89], vcc
    s_cmp_lt_u32 s44, 5
    s_cselect_b64 s[88:89], s[88:89], s[86:87]
    s_cselect_b64 s[90:91], 0, -1
    v_cndmask_b32 v146, v146, 20, s[90:91]
    v_cmp_gt_u32 vcc, 80, v142
    s_nop 0
    s_and_b64 vcc, vcc, s[88:89]
    v_lshlrev_b32 v146, 2, v146
    v_mad_u32_u24 v146, v142, s60, v146
    v_add_u32 v146, 40960, v146
    v_cndmask_b32 v8, v148, v146, vcc
    s_lshl_b32 s57, s44, 1
    s_add_u32 s57, s57, -8
    s_cmp_lt_u32 s44, 5
    s_cselect_b32 s58, s44, s57
    s_add_u32 s59, s44, 1
    s_lshl_b32 s57, s58, 4
    v_add_u32 v142, s57, v141
    s_lshl_b32 s57, s59, 4
    v_add_u32 v143, s57, v140
    v_mul_u32_u24 v144, 3277, v142
    v_lshrrev_b32 v144, 16, v144
    v_mul_u32_u24 v145, 3277, v143
    v_lshrrev_b32 v145, 16, v145
    v_mul_u32_u24 v146, 20, v145
    v_sub_u32 v146, v143, v146
    v_cmp_eq_u32 vcc, v144, v145
    s_nop 0
    s_mov_b64 s[88:89], vcc
    v_cmp_gt_u32 vcc, 80, v143
    s_nop 0
    s_and_b64 s[88:89], s[88:89], vcc
    s_cmp_lt_u32 s44, 5
    s_cselect_b64 s[88:89], s[88:89], 0
    s_cselect_b64 s[90:91], 0, -1
    v_cndmask_b32 v146, v146, 20, s[90:91]
    v_cmp_gt_u32 vcc, 80, v142
    s_nop 0
    s_and_b64 vcc, vcc, s[88:89]
    v_lshlrev_b32 v146, 2, v146
    v_mad_u32_u24 v146, v142, s60, v146
    v_add_u32 v146, 40960, v146
    v_cndmask_b32 v9, v148, v146, vcc
    v_mov_b32 v148, 32
    s_cmp_eq_u32 s45, 3
    s_cselect_b32 exec_lo, 1, 0
    s_mov_b32 exec_hi, 0
    global_load_dword v148, v2, s[22:23] sc1
    s_mov_b64 exec, -1
    v_add_u32 v192, 0, v194
    v_add_u32 v195, 0, v197
    v_xor_b32 v193, 64, v192
    v_xor_b32 v196, 32, v195
    s_barrier
    ds_read_b128 v[152:155], v192 offset:0
    ds_read_b128 v[156:159], v192 offset:2048
    ds_read_b64_tr_b16 v[168:169], v195 offset:768
    ds_read_b64_tr_b16 v[170:171], v195 offset:2816
    ds_read_b64_tr_b16 v[172:173], v196 offset:768
    ds_read_b64_tr_b16 v[174:175], v196 offset:2816
    ds_read_b64_tr_b16 v[176:177], v195 offset:1024
    ds_read_b64_tr_b16 v[178:179], v195 offset:3072
    ds_read_b64_tr_b16 v[180:181], v196 offset:1024
    ds_read_b64_tr_b16 v[182:183], v196 offset:3072
    ds_read_b64_tr_b16 v[184:185], v195 offset:1280
    ds_read_b64_tr_b16 v[186:187], v195 offset:3328
    s_waitcnt lgkmcnt(8)
    v_mfma_f32_16x16x32_bf16 v[24:27], v[152:155], v[168:171], 0
    ds_read_b128 v[160:163], v193 offset:0
    v_mfma_f32_16x16x32_bf16 v[28:31], v[156:159], v[168:171], 0
    v_mfma_f32_4x4x4_16b_bf16 v[120:123], v[152:153], v[152:153], 0
    v_mfma_f32_4x4x4_16b_bf16 v[128:131], v[136:137], v[152:153], 0
    ds_read_b128 v[164:167], v193 offset:2048
    ds_read_b64_tr_b16 v[104:105], v226 offset:0
    ds_read_b64_tr_b16 v[106:107], v226 offset:2048
    ds_read_b64_tr_b16 v[108:109], v226 offset:16384
    s_waitcnt lgkmcnt(11)
    v_mfma_f32_16x16x32_bf16 v[32:35], v[152:155], v[172:175], 0
    ds_read_b64_tr_b16 v[188:189], v196 offset:1280
    v_mfma_f32_16x16x32_bf16 v[36:39], v[156:159], v[172:175], 0
    v_mfma_f32_4x4x4_16b_bf16 v[120:123], v[154:155], v[154:155], v[120:123]
    v_mfma_f32_4x4x4_16b_bf16 v[128:131], v[136:137], v[154:155], v[128:131]
    ds_read_b64_tr_b16 v[190:191], v196 offset:3328
    ds_read_b64_tr_b16 v[110:111], v226 offset:18432
    ds_read_b64_tr_b16 v[112:113], v227 offset:0
    ds_read_b64_tr_b16 v[114:115], v227 offset:2048
    s_waitcnt lgkmcnt(14)
    v_mfma_f32_16x16x32_bf16 v[40:43], v[152:155], v[176:179], 0
    ds_read_b64_tr_b16 v[168:169], v195 offset:1536
    v_mfma_f32_16x16x32_bf16 v[44:47], v[156:159], v[176:179], 0
    v_mfma_f32_4x4x4_16b_bf16 v[124:127], v[156:157], v[156:157], 0
    v_mfma_f32_4x4x4_16b_bf16 v[132:135], v[136:137], v[156:157], 0
    ds_read_b64_tr_b16 v[170:171], v195 offset:3584
    ds_read_b64_tr_b16 v[116:117], v227 offset:16384
    ds_read_b64_tr_b16 v[118:119], v227 offset:18432
    s_waitcnt lgkmcnt(10)
    v_mfma_f32_16x16x32_bf16 v[48:51], v[152:155], v[180:183], 0
    ds_read_b64_tr_b16 v[172:173], v196 offset:1536
    v_mfma_f32_16x16x32_bf16 v[52:55], v[156:159], v[180:183], 0
    v_mfma_f32_4x4x4_16b_bf16 v[124:127], v[158:159], v[158:159], v[124:127]
    v_mfma_f32_4x4x4_16b_bf16 v[132:135], v[136:137], v[158:159], v[132:135]
    ds_read_b64_tr_b16 v[174:175], v196 offset:3584
    v_mfma_f32_16x16x32_bf16 v[208:211], v[136:139], v[104:107], 0
    s_waitcnt lgkmcnt(8)
    v_mfma_f32_16x16x32_bf16 v[208:211], v[136:139], v[108:111], v[208:211]
    v_mfma_f32_16x16x32_bf16 v[56:59], v[152:155], v[184:187], 0
    ds_read_b64_tr_b16 v[176:177], v195 offset:1792
    v_mfma_f32_16x16x32_bf16 v[60:63], v[156:159], v[184:187], 0
    ds_read_b64_tr_b16 v[178:179], v195 offset:3840
    s_waitcnt lgkmcnt(8)
    v_mfma_f32_16x16x32_bf16 v[212:215], v[136:139], v[112:115], 0
    s_waitcnt lgkmcnt(4)
    v_mfma_f32_16x16x32_bf16 v[64:67], v[152:155], v[188:191], 0
    ds_read_b64_tr_b16 v[180:181], v196 offset:1792
    v_mfma_f32_16x16x32_bf16 v[68:71], v[156:159], v[188:191], 0
    ds_read_b64_tr_b16 v[182:183], v196 offset:3840
    v_mfma_f32_16x16x32_bf16 v[212:215], v[136:139], v[116:119], v[212:215]
    v_mfma_f32_16x16x32_bf16 v[72:75], v[152:155], v[168:171], 0
    ds_read_b64_tr_b16 v[184:185], v195 offset:17152
    v_mfma_f32_16x16x32_bf16 v[76:79], v[156:159], v[168:171], 0
    ds_read_b64_tr_b16 v[186:187], v195 offset:19200
    s_waitcnt lgkmcnt(6)
    v_mfma_f32_16x16x32_bf16 v[80:83], v[152:155], v[172:175], 0
    ds_read_b64_tr_b16 v[188:189], v196 offset:17152
    v_mfma_f32_16x16x32_bf16 v[84:87], v[156:159], v[172:175], 0
    ds_read_b64_tr_b16 v[190:191], v196 offset:19200
    s_waitcnt lgkmcnt(6)
    v_mfma_f32_16x16x32_bf16 v[88:91], v[152:155], v[176:179], 0
    ds_read_b64_tr_b16 v[168:169], v195 offset:17408
    v_mfma_f32_16x16x32_bf16 v[92:95], v[156:159], v[176:179], 0
    ds_read_b64_tr_b16 v[170:171], v195 offset:19456
    s_waitcnt lgkmcnt(6)
    v_mfma_f32_16x16x32_bf16 v[96:99], v[152:155], v[180:183], 0
    ds_read_b64_tr_b16 v[172:173], v196 offset:17408
    v_mfma_f32_16x16x32_bf16 v[100:103], v[156:159], v[180:183], 0
    ds_read_b64_tr_b16 v[174:175], v196 offset:19456
    s_waitcnt lgkmcnt(6)
    v_mfma_f32_16x16x32_bf16 v[24:27], v[160:163], v[184:187], v[24:27]
    ds_read_b64_tr_b16 v[176:177], v195 offset:17664
    v_mfma_f32_16x16x32_bf16 v[28:31], v[164:167], v[184:187], v[28:31]
    v_mfma_f32_4x4x4_16b_bf16 v[120:123], v[160:161], v[160:161], v[120:123]
    v_mfma_f32_4x4x4_16b_bf16 v[128:131], v[136:137], v[160:161], v[128:131]
    ds_read_b64_tr_b16 v[178:179], v195 offset:19712
    s_waitcnt vmcnt(0)
    ds_read_b64_tr_b16 v[104:105], v218 offset:0
    ds_read_b64_tr_b16 v[106:107], v218 offset:2048
    s_waitcnt lgkmcnt(8)
    v_mfma_f32_16x16x32_bf16 v[32:35], v[160:163], v[188:191], v[32:35]
    ds_read_b64_tr_b16 v[180:181], v196 offset:17664
    v_mfma_f32_16x16x32_bf16 v[36:39], v[164:167], v[188:191], v[36:39]
    v_mfma_f32_4x4x4_16b_bf16 v[120:123], v[162:163], v[162:163], v[120:123]
    v_mfma_f32_4x4x4_16b_bf16 v[128:131], v[136:137], v[162:163], v[128:131]
    ds_read_b64_tr_b16 v[182:183], v196 offset:19712
    ds_read_b64_tr_b16 v[108:109], v218 offset:32
    ds_read_b64_tr_b16 v[110:111], v218 offset:2080
    ds_read_b64_tr_b16 v[112:113], v218 offset:64
    s_waitcnt lgkmcnt(11)
    v_mfma_f32_16x16x32_bf16 v[40:43], v[160:163], v[168:171], v[40:43]
    ds_read_b64_tr_b16 v[184:185], v195 offset:17920
    v_mfma_f32_16x16x32_bf16 v[44:47], v[164:167], v[168:171], v[44:47]
    v_mfma_f32_4x4x4_16b_bf16 v[124:127], v[164:165], v[164:165], v[124:127]
    v_mfma_f32_4x4x4_16b_bf16 v[132:135], v[136:137], v[164:165], v[132:135]
    ds_read_b64_tr_b16 v[186:187], v195 offset:19968
    ds_read_b64_tr_b16 v[114:115], v218 offset:2112
    ds_read_b64_tr_b16 v[116:117], v218 offset:96
    ds_read_b64_tr_b16 v[118:119], v218 offset:2144
    s_waitcnt lgkmcnt(14)
    v_mfma_f32_16x16x32_bf16 v[48:51], v[160:163], v[172:175], v[48:51]
    ds_read_b64_tr_b16 v[188:189], v196 offset:17920
    v_mfma_f32_16x16x32_bf16 v[52:55], v[164:167], v[172:175], v[52:55]
    v_mfma_f32_4x4x4_16b_bf16 v[124:127], v[166:167], v[166:167], v[124:127]
    v_mfma_f32_4x4x4_16b_bf16 v[132:135], v[136:137], v[166:167], v[132:135]
    ds_read_b64_tr_b16 v[190:191], v196 offset:19968
    s_waitcnt lgkmcnt(12)
    buffer_store_dwordx4 v[104:107], v6, s[36:39], s80 offen sc1
    s_waitcnt lgkmcnt(8)
    v_mfma_f32_16x16x32_bf16 v[56:59], v[160:163], v[176:179], v[56:59]
    ds_read_b64_tr_b16 v[168:169], v195 offset:18176
    v_mfma_f32_16x16x32_bf16 v[60:63], v[164:167], v[176:179], v[60:63]
    ds_read_b64_tr_b16 v[170:171], v195 offset:20224
    buffer_store_dwordx4 v[108:111], v6, s[36:39], s81 offen sc1
    s_waitcnt lgkmcnt(6)
    buffer_store_dwordx4 v[112:115], v6, s[36:39], s82 offen sc1
    v_mfma_f32_16x16x32_bf16 v[64:67], v[160:163], v[180:183], v[64:67]
    ds_read_b64_tr_b16 v[172:173], v196 offset:18176
    v_mfma_f32_16x16x32_bf16 v[68:71], v[164:167], v[180:183], v[68:71]
    ds_read_b64_tr_b16 v[174:175], v196 offset:20224
    v_add_u32 v192, 49152, v194
    v_add_u32 v195, 49152, v197
    v_xor_b32 v193, 64, v192
    v_xor_b32 v196, 32, v195
    s_waitcnt lgkmcnt(6)
    buffer_store_dwordx4 v[116:119], v6, s[36:39], s83 offen sc1
    s_waitcnt vmcnt(4)
    v_mfma_f32_16x16x32_bf16 v[72:75], v[160:163], v[184:187], v[72:75]
    v_mfma_f32_16x16x32_bf16 v[76:79], v[164:167], v[184:187], v[76:79]
    v_readfirstlane_b32 s65, v148
    s_nop 0
    s_cmp_ge_u32 s65, 32
    s_cbranch_scc0 PL_14
PB_15:
    s_waitcnt lgkmcnt(0)
    s_barrier
    ds_read_b128 v[152:155], v192 offset:0
    ds_read_b128 v[156:159], v192 offset:2048
    ds_read_b64_tr_b16 v[176:177], v195 offset:768
    ds_read_b64_tr_b16 v[178:179], v195 offset:2816
    ds_read_b64_tr_b16 v[180:181], v196 offset:768
    ds_read_b64_tr_b16 v[182:183], v196 offset:2816
    v_mfma_f32_16x16x32_bf16 v[80:83], v[160:163], v[188:191], v[80:83]
    v_mfma_f32_16x16x32_bf16 v[84:87], v[164:167], v[188:191], v[84:87]
    v_mfma_f32_16x16x32_bf16 v[88:91], v[160:163], v[168:171], v[88:91]
    ds_read_b64_tr_b16 v[184:185], v195 offset:1024
    v_mfma_f32_16x16x32_bf16 v[92:95], v[164:167], v[168:171], v[92:95]
    ds_read_b64_tr_b16 v[186:187], v195 offset:3072
    v_mfma_f32_16x16x32_bf16 v[96:99], v[160:163], v[172:175], v[96:99]
    ds_read_b64_tr_b16 v[188:189], v196 offset:1024
    v_mfma_f32_16x16x32_bf16 v[100:103], v[164:167], v[172:175], v[100:103]
    ds_read_b64_tr_b16 v[190:191], v196 offset:3072
    s_waitcnt lgkmcnt(6)
    v_mfma_f32_16x16x32_bf16 v[24:27], v[152:155], v[176:179], v[24:27]
    ds_read_b128 v[160:163], v193 offset:0
    v_mfma_f32_16x16x32_bf16 v[28:31], v[156:159], v[176:179], v[28:31]
    ds_read_b128 v[164:167], v193 offset:2048
    ds_read_b64_tr_b16 v[168:169], v195 offset:1280
    ds_read_b64_tr_b16 v[170:171], v195 offset:3328
    s_lshl_b32 s65, s44, 5
    v_add_u32 v140, s65, v1
    s_mov_b32 s90, 0xffff0000
    s_waitcnt lgkmcnt(8)
    v_mfma_f32_16x16x32_bf16 v[32:35], v[152:155], v[180:183], v[32:35]
    ds_read_b64_tr_b16 v[172:173], v196 offset:1280
    v_mfma_f32_16x16x32_bf16 v[36:39], v[156:159], v[180:183], v[36:39]
    ds_read_b64_tr_b16 v[174:175], v196 offset:3328
    s_mov_b32 s91, 0
    v_cndmask_b32 v208, v208, v212, s[90:91]
    s_mov_b32 s90, -1
    s_waitcnt lgkmcnt(8)
    v_mfma_f32_16x16x32_bf16 v[40:43], v[152:155], v[184:187], v[40:43]
    ds_read_b64_tr_b16 v[176:177], v195 offset:1536
    v_mfma_f32_16x16x32_bf16 v[44:47], v[156:159], v[184:187], v[44:47]
    ds_read_b64_tr_b16 v[178:179], v195 offset:3584
    s_cmp_eq_u32 s44, 2
    s_cselect_b32 s90, 0xffff, s90
    v_mov_b32 v141, 0
    v_mov_b32 v142, -16
    s_waitcnt lgkmcnt(8)
    v_mfma_f32_16x16x32_bf16 v[48:51], v[152:155], v[188:191], v[48:51]
    ds_read_b64_tr_b16 v[180:181], v196 offset:1536
    v_mfma_f32_16x16x32_bf16 v[52:55], v[156:159], v[188:191], v[52:55]
    ds_read_b64_tr_b16 v[182:183], v196 offset:3584
    v_cmp_le_u32 vcc, 80, v140
    s_nop 1
    v_cndmask_b32 v141, v141, v142, vcc
    v_mov_b32 v142, 544
    s_waitcnt lgkmcnt(6)
    v_mfma_f32_16x16x32_bf16 v[56:59], v[152:155], v[168:171], v[56:59]
    ds_read_b64_tr_b16 v[184:185], v195 offset:1792
    v_mfma_f32_16x16x32_bf16 v[60:63], v[156:159], v[168:171], v[60:63]
    ds_read_b64_tr_b16 v[186:187], v195 offset:3840
    v_cmp_le_u32 vcc, 96, v140
    s_nop 1
    v_cndmask_b32 v141, v141, v142, vcc
    v_mov_b32 v142, 1104
    s_waitcnt lgkmcnt(6)
    v_mfma_f32_16x16x32_bf16 v[64:67], v[152:155], v[172:175], v[64:67]
    ds_read_b64_tr_b16 v[188:189], v196 offset:1792
    v_mfma_f32_16x16x32_bf16 v[68:71], v[156:159], v[172:175], v[68:71]
    ds_read_b64_tr_b16 v[190:191], v196 offset:3840
    v_cmp_le_u32 vcc, 176, v140
    s_nop 1
    v_cndmask_b32 v141, v141, v142, vcc
    v_add_u32 v140, v140, v141
    s_waitcnt lgkmcnt(6)
    v_mfma_f32_16x16x32_bf16 v[72:75], v[152:155], v[176:179], v[72:75]
    ds_read_b64_tr_b16 v[168:169], v195 offset:17152
    v_mfma_f32_16x16x32_bf16 v[76:79], v[156:159], v[176:179], v[76:79]
    ds_read_b64_tr_b16 v[170:171], v195 offset:19200
    s_lshl_b32 s65, s49, 2
    s_add_u32 s65, s65, 12795904
    s_cmp_ge_u32 s46, 10
    s_cselect_b32 s65, 2130706432, s65
    s_waitcnt lgkmcnt(6)
    v_mfma_f32_16x16x32_bf16 v[80:83], v[152:155], v[180:183], v[80:83]
    ds_read_b64_tr_b16 v[172:173], v196 offset:17152
    v_mfma_f32_16x16x32_bf16 v[84:87], v[156:159], v[180:183], v[84:87]
    ds_read_b64_tr_b16 v[174:175], v196 offset:19200
    v_lshlrev_b32 v140, 2, v140
    v_mov_b32 v141, 2130706432
    v_cndmask_b32 v140, v141, v140, s[90:91]
    s_waitcnt lgkmcnt(6)
    v_mfma_f32_16x16x32_bf16 v[88:91], v[152:155], v[184:187], v[88:91]
    ds_read_b64_tr_b16 v[176:177], v195 offset:17408
    v_mfma_f32_16x16x32_bf16 v[92:95], v[156:159], v[184:187], v[92:95]
    ds_read_b64_tr_b16 v[178:179], v195 offset:19456
    buffer_atomic_add_f32 v208, v140, s[36:39], s65 offen
    s_mov_b32 s88, 0xaaaaaaaa
    s_mov_b32 s89, 0xaaaaaaaa
    s_waitcnt lgkmcnt(6)
    v_mfma_f32_16x16x32_bf16 v[96:99], v[152:155], v[188:191], v[96:99]
    ds_read_b64_tr_b16 v[180:181], v196 offset:17408
    v_mfma_f32_16x16x32_bf16 v[100:103], v[156:159], v[188:191], v[100:103]
    ds_read_b64_tr_b16 v[182:183], v196 offset:19456
    s_mov_b32 s90, 0xcccccccc
    s_mov_b32 s91, 0xcccccccc
    v_cndmask_b32 v120, v120, v121, s[88:89]
    s_waitcnt lgkmcnt(6)
    v_mfma_f32_16x16x32_bf16 v[24:27], v[160:163], v[168:171], v[24:27]
    ds_read_b64_tr_b16 v[184:185], v195 offset:17664
    v_mfma_f32_16x16x32_bf16 v[28:31], v[164:167], v[168:171], v[28:31]
    ds_read_b64_tr_b16 v[186:187], v195 offset:19712
    v_cndmask_b32 v122, v122, v123, s[88:89]
    v_cndmask_b32 v120, v120, v122, s[90:91]
    v_cndmask_b32 v124, v124, v125, s[88:89]
    s_waitcnt lgkmcnt(6)
    v_mfma_f32_16x16x32_bf16 v[32:35], v[160:163], v[172:175], v[32:35]
    ds_read_b64_tr_b16 v[188:189], v196 offset:17664
    v_mfma_f32_16x16x32_bf16 v[36:39], v[164:167], v[172:175], v[36:39]
    ds_read_b64_tr_b16 v[190:191], v196 offset:19712
    v_cndmask_b32 v126, v126, v127, s[88:89]
    v_cndmask_b32 v124, v124, v126, s[90:91]
    s_lshl_b32 s65, s46, 2
    s_waitcnt lgkmcnt(6)
    v_mfma_f32_16x16x32_bf16 v[40:43], v[160:163], v[176:179], v[40:43]
    ds_read_b64_tr_b16 v[168:169], v195 offset:17920
    v_mfma_f32_16x16x32_bf16 v[44:47], v[164:167], v[176:179], v[44:47]
    ds_read_b64_tr_b16 v[170:171], v195 offset:19968
    s_add_u32 s65, s65, s45
    s_lshl_b32 s65, s65, 7
    s_add_u32 s65, s65, 12850176
    s_waitcnt lgkmcnt(6)
    v_mfma_f32_16x16x32_bf16 v[48:51], v[160:163], v[180:183], v[48:51]
    ds_read_b64_tr_b16 v[172:173], v196 offset:17920
    v_mfma_f32_16x16x32_bf16 v[52:55], v[164:167], v[180:183], v[52:55]
    ds_read_b64_tr_b16 v[174:175], v196 offset:19968
    s_lshl_b32 s66, s47, 1
    s_add_u32 s66, s66, s48
    s_cmp_ge_u32 s66, 10
    s_cselect_b32 s65, 2130706432, s65
    s_waitcnt lgkmcnt(6)
    v_mfma_f32_16x16x32_bf16 v[56:59], v[160:163], v[184:187], v[56:59]
    ds_read_b64_tr_b16 v[176:177], v195 offset:18176
    v_mfma_f32_16x16x32_bf16 v[60:63], v[164:167], v[184:187], v[60:63]
    ds_read_b64_tr_b16 v[178:179], v195 offset:20224
    v_permlane32_swap_b32 v128, v120
    v_permlane32_swap_b32 v132, v124
    v_and_b32 v144, 31, v1
    s_waitcnt lgkmcnt(6)
    v_mfma_f32_16x16x32_bf16 v[64:67], v[160:163], v[188:191], v[64:67]
    ds_read_b64_tr_b16 v[180:181], v196 offset:18176
    v_mfma_f32_16x16x32_bf16 v[68:71], v[164:167], v[188:191], v[68:71]
    ds_read_b64_tr_b16 v[182:183], v196 offset:20224
    v_add_u32 v192, 98304, v194
    v_add_u32 v195, 98304, v197
    v_xor_b32 v193, 64, v192
    v_xor_b32 v196, 32, v195
    v_lshrrev_b32 v145, 5, v1
    v_add_f32 v128, v128, v120
    v_add_f32 v132, v132, v124
    s_waitcnt lgkmcnt(6)
    v_mfma_f32_16x16x32_bf16 v[72:75], v[160:163], v[168:171], v[72:75]
    v_mfma_f32_16x16x32_bf16 v[76:79], v[164:167], v[168:171], v[76:79]
    v_lshlrev_b32 v145, 13, v145
    v_lshl_add_u32 v144, v144, 2, v145
    v_permlane16_swap_b32 v128, v132
    v_add_f32 v128, v128, v132
    buffer_atomic_add_f32 v128, v144, s[36:39], s65 offen
    s_waitcnt lgkmcnt(0)
    s_barrier
    ds_read_b128 v[152:155], v192 offset:0
    ds_read_b128 v[156:159], v192 offset:2048
    ds_read_b64_tr_b16 v[184:185], v195 offset:768
    ds_read_b64_tr_b16 v[186:187], v195 offset:2816
    ds_read_b64_tr_b16 v[188:189], v196 offset:768
    ds_read_b64_tr_b16 v[190:191], v196 offset:2816
    v_mfma_f32_16x16x32_bf16 v[80:83], v[160:163], v[172:175], v[80:83]
    v_mfma_f32_16x16x32_bf16 v[84:87], v[164:167], v[172:175], v[84:87]
    v_mfma_f32_16x16x32_bf16 v[88:91], v[160:163], v[176:179], v[88:91]
    ds_read_b64_tr_b16 v[168:169], v195 offset:1024
    v_mfma_f32_16x16x32_bf16 v[92:95], v[164:167], v[176:179], v[92:95]
    ds_read_b64_tr_b16 v[170:171], v195 offset:3072
    v_mfma_f32_16x16x32_bf16 v[96:99], v[160:163], v[180:183], v[96:99]
    ds_read_b64_tr_b16 v[172:173], v196 offset:1024
    v_mfma_f32_16x16x32_bf16 v[100:103], v[164:167], v[180:183], v[100:103]
    ds_read_b64_tr_b16 v[174:175], v196 offset:3072
    s_waitcnt lgkmcnt(6)
    v_mfma_f32_16x16x32_bf16 v[24:27], v[152:155], v[184:187], v[24:27]
    ds_read_b128 v[160:163], v193 offset:0
    v_mfma_f32_16x16x32_bf16 v[28:31], v[156:159], v[184:187], v[28:31]
    ds_read_b128 v[164:167], v193 offset:2048
    ds_read_b64_tr_b16 v[176:177], v195 offset:1280
    ds_read_b64_tr_b16 v[178:179], v195 offset:3328
    s_waitcnt lgkmcnt(8)
    v_mfma_f32_16x16x32_bf16 v[32:35], v[152:155], v[188:191], v[32:35]
    ds_read_b64_tr_b16 v[180:181], v196 offset:1280
    v_mfma_f32_16x16x32_bf16 v[36:39], v[156:159], v[188:191], v[36:39]
    ds_read_b64_tr_b16 v[182:183], v196 offset:3328
    s_waitcnt lgkmcnt(8)
    v_mfma_f32_16x16x32_bf16 v[40:43], v[152:155], v[168:171], v[40:43]
    ds_read_b64_tr_b16 v[184:185], v195 offset:1536
    v_mfma_f32_16x16x32_bf16 v[44:47], v[156:159], v[168:171], v[44:47]
    ds_read_b64_tr_b16 v[186:187], v195 offset:3584
    s_waitcnt lgkmcnt(8)
    v_mfma_f32_16x16x32_bf16 v[48:51], v[152:155], v[172:175], v[48:51]
    ds_read_b64_tr_b16 v[188:189], v196 offset:1536
    v_mfma_f32_16x16x32_bf16 v[52:55], v[156:159], v[172:175], v[52:55]
    ds_read_b64_tr_b16 v[190:191], v196 offset:3584
    s_waitcnt lgkmcnt(6)
    v_mfma_f32_16x16x32_bf16 v[56:59], v[152:155], v[176:179], v[56:59]
    ds_read_b64_tr_b16 v[168:169], v195 offset:1792
    v_mfma_f32_16x16x32_bf16 v[60:63], v[156:159], v[176:179], v[60:63]
    ds_read_b64_tr_b16 v[170:171], v195 offset:3840
    s_waitcnt lgkmcnt(6)
    v_mfma_f32_16x16x32_bf16 v[64:67], v[152:155], v[180:183], v[64:67]
    ds_read_b64_tr_b16 v[172:173], v196 offset:1792
    v_mfma_f32_16x16x32_bf16 v[68:71], v[156:159], v[180:183], v[68:71]
    ds_read_b64_tr_b16 v[174:175], v196 offset:3840
    s_waitcnt lgkmcnt(6)
    v_mfma_f32_16x16x32_bf16 v[72:75], v[152:155], v[184:187], v[72:75]
    ds_read_b64_tr_b16 v[176:177], v195 offset:17152
    v_mfma_f32_16x16x32_bf16 v[76:79], v[156:159], v[184:187], v[76:79]
    ds_read_b64_tr_b16 v[178:179], v195 offset:19200
    s_waitcnt lgkmcnt(6)
    v_mfma_f32_16x16x32_bf16 v[80:83], v[152:155], v[188:191], v[80:83]
    ds_read_b64_tr_b16 v[180:181], v196 offset:17152
    v_mfma_f32_16x16x32_bf16 v[84:87], v[156:159], v[188:191], v[84:87]
    ds_read_b64_tr_b16 v[182:183], v196 offset:19200
    s_waitcnt lgkmcnt(6)
    v_mfma_f32_16x16x32_bf16 v[88:91], v[152:155], v[168:171], v[88:91]
    ds_read_b64_tr_b16 v[184:185], v195 offset:17408
    v_mfma_f32_16x16x32_bf16 v[92:95], v[156:159], v[168:171], v[92:95]
    ds_read_b64_tr_b16 v[186:187], v195 offset:19456
    s_waitcnt lgkmcnt(6)
    v_mfma_f32_16x16x32_bf16 v[96:99], v[152:155], v[172:175], v[96:99]
    ds_read_b64_tr_b16 v[188:189], v196 offset:17408
    v_mfma_f32_16x16x32_bf16 v[100:103], v[156:159], v[172:175], v[100:103]
    ds_read_b64_tr_b16 v[190:191], v196 offset:19456
    s_waitcnt lgkmcnt(6)
    v_mfma_f32_16x16x32_bf16 v[24:27], v[160:163], v[176:179], v[24:27]
    ds_read_b64_tr_b16 v[168:169], v195 offset:17664
    v_mfma_f32_16x16x32_bf16 v[28:31], v[164:167], v[176:179], v[28:31]
    ds_read_b64_tr_b16 v[170:171], v195 offset:19712
    s_waitcnt lgkmcnt(6)
    v_mfma_f32_16x16x32_bf16 v[32:35], v[160:163], v[180:183], v[32:35]
    ds_read_b64_tr_b16 v[172:173], v196 offset:17664
    v_mfma_f32_16x16x32_bf16 v[36:39], v[164:167], v[180:183], v[36:39]
    ds_read_b64_tr_b16 v[174:175], v196 offset:19712
    s_waitcnt lgkmcnt(6)
    v_mfma_f32_16x16x32_bf16 v[40:43], v[160:163], v[184:187], v[40:43]
    ds_read_b64_tr_b16 v[176:177], v195 offset:17920
    v_mfma_f32_16x16x32_bf16 v[44:47], v[164:167], v[184:187], v[44:47]
    ds_read_b64_tr_b16 v[178:179], v195 offset:19968
    s_waitcnt lgkmcnt(6)
    v_mfma_f32_16x16x32_bf16 v[48:51], v[160:163], v[188:191], v[48:51]
    ds_read_b64_tr_b16 v[180:181], v196 offset:17920
    v_mfma_f32_16x16x32_bf16 v[52:55], v[164:167], v[188:191], v[52:55]
    ds_read_b64_tr_b16 v[182:183], v196 offset:19968
    s_waitcnt lgkmcnt(6)
    v_mfma_f32_16x16x32_bf16 v[56:59], v[160:163], v[168:171], v[56:59]
    ds_read_b64_tr_b16 v[184:185], v195 offset:18176
    v_mfma_f32_16x16x32_bf16 v[60:63], v[164:167], v[168:171], v[60:63]
    ds_read_b64_tr_b16 v[186:187], v195 offset:20224
    s_waitcnt lgkmcnt(6)
    v_mfma_f32_16x16x32_bf16 v[64:67], v[160:163], v[172:175], v[64:67]
    ds_read_b64_tr_b16 v[188:189], v196 offset:18176
    v_mfma_f32_16x16x32_bf16 v[68:71], v[164:167], v[172:175], v[68:71]
    ds_read_b64_tr_b16 v[190:191], v196 offset:20224
    v_add_u32 v192, 0, v194
    v_add_u32 v195, 0, v197
    v_xor_b32 v193, 64, v192
    v_xor_b32 v196, 32, v195
    s_waitcnt vmcnt(0)
    s_waitcnt lgkmcnt(6)
    v_mfma_f32_16x16x32_bf16 v[72:75], v[160:163], v[176:179], v[72:75]
    v_mfma_f32_16x16x32_bf16 v[76:79], v[164:167], v[176:179], v[76:79]
    s_waitcnt lgkmcnt(0)
    s_barrier
    ds_read_b128 v[152:155], v192 offset:0
    ds_read_b128 v[156:159], v192 offset:2048
    ds_read_b64_tr_b16 v[168:169], v195 offset:768
    ds_read_b64_tr_b16 v[170:171], v195 offset:2816
    ds_read_b64_tr_b16 v[172:173], v196 offset:768
    ds_read_b64_tr_b16 v[174:175], v196 offset:2816
    v_mfma_f32_16x16x32_bf16 v[80:83], v[160:163], v[180:183], v[80:83]
    v_mfma_f32_16x16x32_bf16 v[84:87], v[164:167], v[180:183], v[84:87]
    v_mfma_f32_16x16x32_bf16 v[88:91], v[160:163], v[184:187], v[88:91]
    ds_read_b64_tr_b16 v[176:177], v195 offset:1024
    v_mfma_f32_16x16x32_bf16 v[92:95], v[164:167], v[184:187], v[92:95]
    ds_read_b64_tr_b16 v[178:179], v195 offset:3072
    v_mfma_f32_16x16x32_bf16 v[96:99], v[160:163], v[188:191], v[96:99]
    ds_read_b64_tr_b16 v[180:181], v196 offset:1024
    v_mfma_f32_16x16x32_bf16 v[100:103], v[164:167], v[188:191], v[100:103]
    ds_read_b64_tr_b16 v[182:183], v196 offset:3072
    s_waitcnt lgkmcnt(6)
    v_mfma_f32_16x16x32_bf16 v[24:27], v[152:155], v[168:171], v[24:27]
    ds_read_b128 v[160:163], v193 offset:0
    v_mfma_f32_16x16x32_bf16 v[28:31], v[156:159], v[168:171], v[28:31]
    ds_read_b128 v[164:167], v193 offset:2048
    ds_read_b64_tr_b16 v[184:185], v195 offset:1280
    ds_read_b64_tr_b16 v[186:187], v195 offset:3328
    s_and_b32 s65, s2, 31
    s_add_u32 s65, s65, 264
    s_lshl_b32 s65, s65, 7
    s_waitcnt lgkmcnt(8)
    v_mfma_f32_16x16x32_bf16 v[32:35], v[152:155], v[172:175], v[32:35]
    ds_read_b64_tr_b16 v[188:189], v196 offset:1280
    v_mfma_f32_16x16x32_bf16 v[36:39], v[156:159], v[172:175], v[36:39]
    ds_read_b64_tr_b16 v[190:191], v196 offset:3328
    v_mov_b32 v216, s65
    v_mov_b32 v217, 1
    s_cmp_eq_u32 s44, 0
    s_cselect_b32 exec_lo, 1, 0
    s_mov_b32 exec_hi, 0
    global_atomic_add v216, v217, s[10:11]
    s_mov_b64 exec, -1
    s_waitcnt lgkmcnt(8)
    v_mfma_f32_16x16x32_bf16 v[40:43], v[152:155], v[176:179], v[40:43]
    ds_read_b64_tr_b16 v[168:169], v195 offset:1536
    v_mfma_f32_16x16x32_bf16 v[44:47], v[156:159], v[176:179], v[44:47]
    ds_read_b64_tr_b16 v[170:171], v195 offset:3584
    s_waitcnt lgkmcnt(8)
    v_mfma_f32_16x16x32_bf16 v[48:51], v[152:155], v[180:183], v[48:51]
    ds_read_b64_tr_b16 v[172:173], v196 offset:1536
    v_mfma_f32_16x16x32_bf16 v[52:55], v[156:159], v[180:183], v[52:55]
    ds_read_b64_tr_b16 v[174:175], v196 offset:3584
    s_waitcnt lgkmcnt(6)
    v_mfma_f32_16x16x32_bf16 v[56:59], v[152:155], v[184:187], v[56:59]
    ds_read_b64_tr_b16 v[176:177], v195 offset:1792
    v_mfma_f32_16x16x32_bf16 v[60:63], v[156:159], v[184:187], v[60:63]
    ds_read_b64_tr_b16 v[178:179], v195 offset:3840
    s_waitcnt lgkmcnt(6)
    v_mfma_f32_16x16x32_bf16 v[64:67], v[152:155], v[188:191], v[64:67]
    ds_read_b64_tr_b16 v[180:181], v196 offset:1792
    v_mfma_f32_16x16x32_bf16 v[68:71], v[156:159], v[188:191], v[68:71]
    ds_read_b64_tr_b16 v[182:183], v196 offset:3840
    s_waitcnt lgkmcnt(6)
    v_mfma_f32_16x16x32_bf16 v[72:75], v[152:155], v[168:171], v[72:75]
    ds_read_b64_tr_b16 v[184:185], v195 offset:17152
    v_mfma_f32_16x16x32_bf16 v[76:79], v[156:159], v[168:171], v[76:79]
    ds_read_b64_tr_b16 v[186:187], v195 offset:19200
    s_waitcnt lgkmcnt(6)
    v_mfma_f32_16x16x32_bf16 v[80:83], v[152:155], v[172:175], v[80:83]
    ds_read_b64_tr_b16 v[188:189], v196 offset:17152
    v_mfma_f32_16x16x32_bf16 v[84:87], v[156:159], v[172:175], v[84:87]
    ds_read_b64_tr_b16 v[190:191], v196 offset:19200
    s_waitcnt lgkmcnt(6)
    v_mfma_f32_16x16x32_bf16 v[88:91], v[152:155], v[176:179], v[88:91]
    ds_read_b64_tr_b16 v[168:169], v195 offset:17408
    v_mfma_f32_16x16x32_bf16 v[92:95], v[156:159], v[176:179], v[92:95]
    ds_read_b64_tr_b16 v[170:171], v195 offset:19456
    s_waitcnt lgkmcnt(6)
    v_mfma_f32_16x16x32_bf16 v[96:99], v[152:155], v[180:183], v[96:99]
    ds_read_b64_tr_b16 v[172:173], v196 offset:17408
    v_mfma_f32_16x16x32_bf16 v[100:103], v[156:159], v[180:183], v[100:103]
    ds_read_b64_tr_b16 v[174:175], v196 offset:19456
    s_waitcnt lgkmcnt(6)
    v_mfma_f32_16x16x32_bf16 v[24:27], v[160:163], v[184:187], v[24:27]
    ds_read_b64_tr_b16 v[176:177], v195 offset:17664
    v_mfma_f32_16x16x32_bf16 v[28:31], v[164:167], v[184:187], v[28:31]
    ds_read_b64_tr_b16 v[178:179], v195 offset:19712
    s_waitcnt lgkmcnt(6)
    v_mfma_f32_16x16x32_bf16 v[32:35], v[160:163], v[188:191], v[32:35]
    ds_read_b64_tr_b16 v[180:181], v196 offset:17664
    v_mfma_f32_16x16x32_bf16 v[36:39], v[164:167], v[188:191], v[36:39]
    ds_read_b64_tr_b16 v[182:183], v196 offset:19712
    s_waitcnt lgkmcnt(6)
    v_mfma_f32_16x16x32_bf16 v[40:43], v[160:163], v[168:171], v[40:43]
    ds_read_b64_tr_b16 v[184:185], v195 offset:17920
    v_mfma_f32_16x16x32_bf16 v[44:47], v[164:167], v[168:171], v[44:47]
    ds_read_b64_tr_b16 v[186:187], v195 offset:19968
    s_waitcnt lgkmcnt(6)
    v_mfma_f32_16x16x32_bf16 v[48:51], v[160:163], v[172:175], v[48:51]
    ds_read_b64_tr_b16 v[188:189], v196 offset:17920
    v_mfma_f32_16x16x32_bf16 v[52:55], v[164:167], v[172:175], v[52:55]
    ds_read_b64_tr_b16 v[190:191], v196 offset:19968
    s_waitcnt lgkmcnt(6)
    v_mfma_f32_16x16x32_bf16 v[56:59], v[160:163], v[176:179], v[56:59]
    ds_read_b64_tr_b16 v[168:169], v195 offset:18176
    v_mfma_f32_16x16x32_bf16 v[60:63], v[164:167], v[176:179], v[60:63]
    ds_read_b64_tr_b16 v[170:171], v195 offset:20224
    s_waitcnt lgkmcnt(6)
    v_mfma_f32_16x16x32_bf16 v[64:67], v[160:163], v[180:183], v[64:67]
    ds_read_b64_tr_b16 v[172:173], v196 offset:18176
    v_mfma_f32_16x16x32_bf16 v[68:71], v[164:167], v[180:183], v[68:71]
    ds_read_b64_tr_b16 v[174:175], v196 offset:20224
    v_add_u32 v192, 49152, v194
    v_add_u32 v195, 49152, v197
    v_xor_b32 v193, 64, v192
    v_xor_b32 v196, 32, v195
    s_waitcnt lgkmcnt(6)
    v_mfma_f32_16x16x32_bf16 v[72:75], v[160:163], v[184:187], v[72:75]
    v_mfma_f32_16x16x32_bf16 v[76:79], v[164:167], v[184:187], v[76:79]
    s_waitcnt lgkmcnt(0)
    s_barrier
    ds_read_b128 v[152:155], v192 offset:0
    ds_read_b128 v[156:159], v192 offset:2048
    ds_read_b64_tr_b16 v[176:177], v195 offset:768
    ds_read_b64_tr_b16 v[178:179], v195 offset:2816
    ds_read_b64_tr_b16 v[180:181], v196 offset:768
    ds_read_b64_tr_b16 v[182:183], v196 offset:2816
    v_mfma_f32_16x16x32_bf16 v[80:83], v[160:163], v[188:191], v[80:83]
    v_mfma_f32_16x16x32_bf16 v[84:87], v[164:167], v[188:191], v[84:87]
    v_mfma_f32_16x16x32_bf16 v[88:91], v[160:163], v[168:171], v[88:91]
    ds_read_b64_tr_b16 v[184:185], v195 offset:1024
    v_mfma_f32_16x16x32_bf16 v[92:95], v[164:167], v[168:171], v[92:95]
    ds_read_b64_tr_b16 v[186:187], v195 offset:3072
    v_mfma_f32_16x16x32_bf16 v[96:99], v[160:163], v[172:175], v[96:99]
    ds_read_b64_tr_b16 v[188:189], v196 offset:1024
    v_mfma_f32_16x16x32_bf16 v[100:103], v[164:167], v[172:175], v[100:103]
    ds_read_b64_tr_b16 v[190:191], v196 offset:3072
    s_waitcnt lgkmcnt(6)
    v_mfma_f32_16x16x32_bf16 v[24:27], v[152:155], v[176:179], v[24:27]
    ds_read_b128 v[160:163], v193 offset:0
    v_mfma_f32_16x16x32_bf16 v[28:31], v[156:159], v[176:179], v[28:31]
    ds_read_b128 v[164:167], v193 offset:2048
    ds_read_b64_tr_b16 v[168:169], v195 offset:1280
    ds_read_b64_tr_b16 v[170:171], v195 offset:3328
    s_waitcnt lgkmcnt(8)
    v_mfma_f32_16x16x32_bf16 v[32:35], v[152:155], v[180:183], v[32:35]
    ds_read_b64_tr_b16 v[172:173], v196 offset:1280
    v_mfma_f32_16x16x32_bf16 v[36:39], v[156:159], v[180:183], v[36:39]
    ds_read_b64_tr_b16 v[174:175], v196 offset:3328
    s_waitcnt lgkmcnt(8)
    v_mfma_f32_16x16x32_bf16 v[40:43], v[152:155], v[184:187], v[40:43]
    ds_read_b64_tr_b16 v[176:177], v195 offset:1536
    v_mfma_f32_16x16x32_bf16 v[44:47], v[156:159], v[184:187], v[44:47]
    ds_read_b64_tr_b16 v[178:179], v195 offset:3584
    s_waitcnt lgkmcnt(8)
    v_mfma_f32_16x16x32_bf16 v[48:51], v[152:155], v[188:191], v[48:51]
    ds_read_b64_tr_b16 v[180:181], v196 offset:1536
    v_mfma_f32_16x16x32_bf16 v[52:55], v[156:159], v[188:191], v[52:55]
    ds_read_b64_tr_b16 v[182:183], v196 offset:3584
    s_waitcnt lgkmcnt(6)
    v_mfma_f32_16x16x32_bf16 v[56:59], v[152:155], v[168:171], v[56:59]
    ds_read_b64_tr_b16 v[184:185], v195 offset:1792
    v_mfma_f32_16x16x32_bf16 v[60:63], v[156:159], v[168:171], v[60:63]
    ds_read_b64_tr_b16 v[186:187], v195 offset:3840
    s_waitcnt lgkmcnt(6)
    v_mfma_f32_16x16x32_bf16 v[64:67], v[152:155], v[172:175], v[64:67]
    ds_read_b64_tr_b16 v[188:189], v196 offset:1792
    v_mfma_f32_16x16x32_bf16 v[68:71], v[156:159], v[172:175], v[68:71]
    ds_read_b64_tr_b16 v[190:191], v196 offset:3840
    s_waitcnt lgkmcnt(6)
    v_mfma_f32_16x16x32_bf16 v[72:75], v[152:155], v[176:179], v[72:75]
    ds_read_b64_tr_b16 v[168:169], v195 offset:17152
    v_mfma_f32_16x16x32_bf16 v[76:79], v[156:159], v[176:179], v[76:79]
    ds_read_b64_tr_b16 v[170:171], v195 offset:19200
    s_waitcnt lgkmcnt(6)
    v_mfma_f32_16x16x32_bf16 v[80:83], v[152:155], v[180:183], v[80:83]
    ds_read_b64_tr_b16 v[172:173], v196 offset:17152
    v_mfma_f32_16x16x32_bf16 v[84:87], v[156:159], v[180:183], v[84:87]
    ds_read_b64_tr_b16 v[174:175], v196 offset:19200
    s_waitcnt lgkmcnt(6)
    v_mfma_f32_16x16x32_bf16 v[88:91], v[152:155], v[184:187], v[88:91]
    ds_read_b64_tr_b16 v[176:177], v195 offset:17408
    v_mfma_f32_16x16x32_bf16 v[92:95], v[156:159], v[184:187], v[92:95]
    ds_read_b64_tr_b16 v[178:179], v195 offset:19456
    s_waitcnt lgkmcnt(6)
    v_mfma_f32_16x16x32_bf16 v[96:99], v[152:155], v[188:191], v[96:99]
    ds_read_b64_tr_b16 v[180:181], v196 offset:17408
    v_mfma_f32_16x16x32_bf16 v[100:103], v[156:159], v[188:191], v[100:103]
    ds_read_b64_tr_b16 v[182:183], v196 offset:19456
    s_waitcnt lgkmcnt(6)
    v_mfma_f32_16x16x32_bf16 v[24:27], v[160:163], v[168:171], v[24:27]
    ds_read_b64_tr_b16 v[184:185], v195 offset:17664
    v_mfma_f32_16x16x32_bf16 v[28:31], v[164:167], v[168:171], v[28:31]
    ds_read_b64_tr_b16 v[186:187], v195 offset:19712
    s_waitcnt lgkmcnt(6)
    v_mfma_f32_16x16x32_bf16 v[32:35], v[160:163], v[172:175], v[32:35]
    ds_read_b64_tr_b16 v[188:189], v196 offset:17664
    v_mfma_f32_16x16x32_bf16 v[36:39], v[164:167], v[172:175], v[36:39]
    ds_read_b64_tr_b16 v[190:191], v196 offset:19712
    s_waitcnt lgkmcnt(6)
    v_mfma_f32_16x16x32_bf16 v[40:43], v[160:163], v[176:179], v[40:43]
    ds_read_b64_tr_b16 v[168:169], v195 offset:17920
    v_mfma_f32_16x16x32_bf16 v[44:47], v[164:167], v[176:179], v[44:47]
    ds_read_b64_tr_b16 v[170:171], v195 offset:19968
    s_waitcnt lgkmcnt(6)
    v_mfma_f32_16x16x32_bf16 v[48:51], v[160:163], v[180:183], v[48:51]
    ds_read_b64_tr_b16 v[172:173], v196 offset:17920
    v_mfma_f32_16x16x32_bf16 v[52:55], v[164:167], v[180:183], v[52:55]
    ds_read_b64_tr_b16 v[174:175], v196 offset:19968
    s_waitcnt lgkmcnt(6)
    v_mfma_f32_16x16x32_bf16 v[56:59], v[160:163], v[184:187], v[56:59]
    ds_read_b64_tr_b16 v[176:177], v195 offset:18176
    v_mfma_f32_16x16x32_bf16 v[60:63], v[164:167], v[184:187], v[60:63]
    ds_read_b64_tr_b16 v[178:179], v195 offset:20224
    s_waitcnt lgkmcnt(6)
    v_mfma_f32_16x16x32_bf16 v[64:67], v[160:163], v[188:191], v[64:67]
    ds_read_b64_tr_b16 v[180:181], v196 offset:18176
    v_mfma_f32_16x16x32_bf16 v[68:71], v[164:167], v[188:191], v[68:71]
    ds_read_b64_tr_b16 v[182:183], v196 offset:20224
    v_add_u32 v192, 98304, v194
    v_add_u32 v195, 98304, v197
    v_xor_b32 v193, 64, v192
    v_xor_b32 v196, 32, v195
    s_waitcnt lgkmcnt(6)
    v_mfma_f32_16x16x32_bf16 v[72:75], v[160:163], v[168:171], v[72:75]
    v_mfma_f32_16x16x32_bf16 v[76:79], v[164:167], v[168:171], v[76:79]
    s_waitcnt lgkmcnt(0)
    s_barrier
    ds_read_b128 v[152:155], v192 offset:0
    ds_read_b128 v[156:159], v192 offset:2048
    ds_read_b64_tr_b16 v[184:185], v195 offset:768
    ds_read_b64_tr_b16 v[186:187], v195 offset:2816
    ds_read_b64_tr_b16 v[188:189], v196 offset:768
    ds_read_b64_tr_b16 v[190:191], v196 offset:2816
    v_mfma_f32_16x16x32_bf16 v[80:83], v[160:163], v[172:175], v[80:83]
    v_mfma_f32_16x16x32_bf16 v[84:87], v[164:167], v[172:175], v[84:87]
    v_mfma_f32_16x16x32_bf16 v[88:91], v[160:163], v[176:179], v[88:91]
    ds_read_b64_tr_b16 v[168:169], v195 offset:1024
    v_mfma_f32_16x16x32_bf16 v[92:95], v[164:167], v[176:179], v[92:95]
    ds_read_b64_tr_b16 v[170:171], v195 offset:3072
    v_mfma_f32_16x16x32_bf16 v[96:99], v[160:163], v[180:183], v[96:99]
    ds_read_b64_tr_b16 v[172:173], v196 offset:1024
    v_mfma_f32_16x16x32_bf16 v[100:103], v[164:167], v[180:183], v[100:103]
    ds_read_b64_tr_b16 v[174:175], v196 offset:3072
    s_waitcnt lgkmcnt(6)
    v_mfma_f32_16x16x32_bf16 v[24:27], v[152:155], v[184:187], v[24:27]
    ds_read_b128 v[160:163], v193 offset:0
    v_mfma_f32_16x16x32_bf16 v[28:31], v[156:159], v[184:187], v[28:31]
    ds_read_b128 v[164:167], v193 offset:2048
    ds_read_b64_tr_b16 v[176:177], v195 offset:1280
    ds_read_b64_tr_b16 v[178:179], v195 offset:3328
    s_waitcnt lgkmcnt(8)
    v_mfma_f32_16x16x32_bf16 v[32:35], v[152:155], v[188:191], v[32:35]
    ds_read_b64_tr_b16 v[180:181], v196 offset:1280
    v_mfma_f32_16x16x32_bf16 v[36:39], v[156:159], v[188:191], v[36:39]
    ds_read_b64_tr_b16 v[182:183], v196 offset:3328
    s_waitcnt lgkmcnt(8)
    v_mfma_f32_16x16x32_bf16 v[40:43], v[152:155], v[168:171], v[40:43]
    ds_read_b64_tr_b16 v[184:185], v195 offset:1536
    v_mfma_f32_16x16x32_bf16 v[44:47], v[156:159], v[168:171], v[44:47]
    ds_read_b64_tr_b16 v[186:187], v195 offset:3584
    s_waitcnt lgkmcnt(8)
    v_mfma_f32_16x16x32_bf16 v[48:51], v[152:155], v[172:175], v[48:51]
    ds_read_b64_tr_b16 v[188:189], v196 offset:1536
    v_mfma_f32_16x16x32_bf16 v[52:55], v[156:159], v[172:175], v[52:55]
    ds_read_b64_tr_b16 v[190:191], v196 offset:3584
    s_waitcnt lgkmcnt(6)
    v_mfma_f32_16x16x32_bf16 v[56:59], v[152:155], v[176:179], v[56:59]
    ds_read_b64_tr_b16 v[168:169], v195 offset:1792
    v_mfma_f32_16x16x32_bf16 v[60:63], v[156:159], v[176:179], v[60:63]
    ds_read_b64_tr_b16 v[170:171], v195 offset:3840
    s_waitcnt lgkmcnt(6)
    v_mfma_f32_16x16x32_bf16 v[64:67], v[152:155], v[180:183], v[64:67]
    ds_read_b64_tr_b16 v[172:173], v196 offset:1792
    v_mfma_f32_16x16x32_bf16 v[68:71], v[156:159], v[180:183], v[68:71]
    ds_read_b64_tr_b16 v[174:175], v196 offset:3840
    s_waitcnt lgkmcnt(6)
    v_mfma_f32_16x16x32_bf16 v[72:75], v[152:155], v[184:187], v[72:75]
    ds_read_b64_tr_b16 v[176:177], v195 offset:17152
    v_mfma_f32_16x16x32_bf16 v[76:79], v[156:159], v[184:187], v[76:79]
    ds_read_b64_tr_b16 v[178:179], v195 offset:19200
    s_waitcnt lgkmcnt(6)
    v_mfma_f32_16x16x32_bf16 v[80:83], v[152:155], v[188:191], v[80:83]
    ds_read_b64_tr_b16 v[180:181], v196 offset:17152
    v_mfma_f32_16x16x32_bf16 v[84:87], v[156:159], v[188:191], v[84:87]
    ds_read_b64_tr_b16 v[182:183], v196 offset:19200
    s_waitcnt lgkmcnt(6)
    v_mfma_f32_16x16x32_bf16 v[88:91], v[152:155], v[168:171], v[88:91]
    ds_read_b64_tr_b16 v[184:185], v195 offset:17408
    v_mfma_f32_16x16x32_bf16 v[92:95], v[156:159], v[168:171], v[92:95]
    ds_read_b64_tr_b16 v[186:187], v195 offset:19456
    s_waitcnt lgkmcnt(6)
    v_mfma_f32_16x16x32_bf16 v[96:99], v[152:155], v[172:175], v[96:99]
    ds_read_b64_tr_b16 v[188:189], v196 offset:17408
    v_mfma_f32_16x16x32_bf16 v[100:103], v[156:159], v[172:175], v[100:103]
    ds_read_b64_tr_b16 v[190:191], v196 offset:19456
    s_waitcnt lgkmcnt(6)
    v_mfma_f32_16x16x32_bf16 v[24:27], v[160:163], v[176:179], v[24:27]
    ds_read_b64_tr_b16 v[168:169], v195 offset:17664
    v_mfma_f32_16x16x32_bf16 v[28:31], v[164:167], v[176:179], v[28:31]
    ds_read_b64_tr_b16 v[170:171], v195 offset:19712
    s_waitcnt lgkmcnt(6)
    v_mfma_f32_16x16x32_bf16 v[32:35], v[160:163], v[180:183], v[32:35]
    ds_read_b64_tr_b16 v[172:173], v196 offset:17664
    v_mfma_f32_16x16x32_bf16 v[36:39], v[164:167], v[180:183], v[36:39]
    ds_read_b64_tr_b16 v[174:175], v196 offset:19712
    s_waitcnt lgkmcnt(6)
    v_mfma_f32_16x16x32_bf16 v[40:43], v[160:163], v[184:187], v[40:43]
    ds_read_b64_tr_b16 v[176:177], v195 offset:17920
    v_mfma_f32_16x16x32_bf16 v[44:47], v[164:167], v[184:187], v[44:47]
    ds_read_b64_tr_b16 v[178:179], v195 offset:19968
    s_waitcnt lgkmcnt(6)
    v_mfma_f32_16x16x32_bf16 v[48:51], v[160:163], v[188:191], v[48:51]
    ds_read_b64_tr_b16 v[180:181], v196 offset:17920
    v_mfma_f32_16x16x32_bf16 v[52:55], v[164:167], v[188:191], v[52:55]
    ds_read_b64_tr_b16 v[182:183], v196 offset:19968
    s_waitcnt lgkmcnt(6)
    v_mfma_f32_16x16x32_bf16 v[56:59], v[160:163], v[168:171], v[56:59]
    ds_read_b64_tr_b16 v[184:185], v195 offset:18176
    v_mfma_f32_16x16x32_bf16 v[60:63], v[164:167], v[168:171], v[60:63]
    ds_read_b64_tr_b16 v[186:187], v195 offset:20224
    s_waitcnt lgkmcnt(6)
    v_mfma_f32_16x16x32_bf16 v[64:67], v[160:163], v[172:175], v[64:67]
    ds_read_b64_tr_b16 v[188:189], v196 offset:18176
    v_mfma_f32_16x16x32_bf16 v[68:71], v[164:167], v[172:175], v[68:71]
    ds_read_b64_tr_b16 v[190:191], v196 offset:20224
    v_add_u32 v192, 0, v194
    v_add_u32 v195, 0, v197
    v_xor_b32 v193, 64, v192
    v_xor_b32 v196, 32, v195
    s_waitcnt lgkmcnt(6)
    v_mfma_f32_16x16x32_bf16 v[72:75], v[160:163], v[176:179], v[72:75]
    v_mfma_f32_16x16x32_bf16 v[76:79], v[164:167], v[176:179], v[76:79]
    s_waitcnt lgkmcnt(0)
    s_barrier
    ds_read_b128 v[152:155], v192 offset:0
    ds_read_b128 v[156:159], v192 offset:2048
    ds_read_b64_tr_b16 v[168:169], v195 offset:768
    ds_read_b64_tr_b16 v[170:171], v195 offset:2816
    ds_read_b64_tr_b16 v[172:173], v196 offset:768
    ds_read_b64_tr_b16 v[174:175], v196 offset:2816
    v_mfma_f32_16x16x32_bf16 v[80:83], v[160:163], v[180:183], v[80:83]
    v_mfma_f32_16x16x32_bf16 v[84:87], v[164:167], v[180:183], v[84:87]
    v_mfma_f32_16x16x32_bf16 v[88:91], v[160:163], v[184:187], v[88:91]
    ds_read_b64_tr_b16 v[176:177], v195 offset:1024
    v_mfma_f32_16x16x32_bf16 v[92:95], v[164:167], v[184:187], v[92:95]
    ds_read_b64_tr_b16 v[178:179], v195 offset:3072
    v_mfma_f32_16x16x32_bf16 v[96:99], v[160:163], v[188:191], v[96:99]
    ds_read_b64_tr_b16 v[180:181], v196 offset:1024
    v_mfma_f32_16x16x32_bf16 v[100:103], v[164:167], v[188:191], v[100:103]
    ds_read_b64_tr_b16 v[182:183], v196 offset:3072
    s_waitcnt lgkmcnt(6)
    v_mfma_f32_16x16x32_bf16 v[24:27], v[152:155], v[168:171], v[24:27]
    ds_read_b128 v[160:163], v193 offset:0
    v_mfma_f32_16x16x32_bf16 v[28:31], v[156:159], v[168:171], v[28:31]
    ds_read_b128 v[164:167], v193 offset:2048
    ds_read_b64_tr_b16 v[184:185], v195 offset:1280
    ds_read_b64_tr_b16 v[186:187], v195 offset:3328
    s_waitcnt lgkmcnt(8)
    v_mfma_f32_16x16x32_bf16 v[32:35], v[152:155], v[172:175], v[32:35]
    ds_read_b64_tr_b16 v[188:189], v196 offset:1280
    v_mfma_f32_16x16x32_bf16 v[36:39], v[156:159], v[172:175], v[36:39]
    ds_read_b64_tr_b16 v[190:191], v196 offset:3328
    s_waitcnt lgkmcnt(8)
    v_mfma_f32_16x16x32_bf16 v[40:43], v[152:155], v[176:179], v[40:43]
    ds_read_b64_tr_b16 v[168:169], v195 offset:1536
    v_mfma_f32_16x16x32_bf16 v[44:47], v[156:159], v[176:179], v[44:47]
    ds_read_b64_tr_b16 v[170:171], v195 offset:3584
    s_waitcnt lgkmcnt(8)
    v_mfma_f32_16x16x32_bf16 v[48:51], v[152:155], v[180:183], v[48:51]
    ds_read_b64_tr_b16 v[172:173], v196 offset:1536
    v_mfma_f32_16x16x32_bf16 v[52:55], v[156:159], v[180:183], v[52:55]
    ds_read_b64_tr_b16 v[174:175], v196 offset:3584
    s_waitcnt lgkmcnt(6)
    v_mfma_f32_16x16x32_bf16 v[56:59], v[152:155], v[184:187], v[56:59]
    ds_read_b64_tr_b16 v[176:177], v195 offset:1792
    v_mfma_f32_16x16x32_bf16 v[60:63], v[156:159], v[184:187], v[60:63]
    ds_read_b64_tr_b16 v[178:179], v195 offset:3840
    s_waitcnt lgkmcnt(6)
    v_mfma_f32_16x16x32_bf16 v[64:67], v[152:155], v[188:191], v[64:67]
    ds_read_b64_tr_b16 v[180:181], v196 offset:1792
    v_mfma_f32_16x16x32_bf16 v[68:71], v[156:159], v[188:191], v[68:71]
    ds_read_b64_tr_b16 v[182:183], v196 offset:3840
    s_waitcnt lgkmcnt(6)
    v_mfma_f32_16x16x32_bf16 v[72:75], v[152:155], v[168:171], v[72:75]
    ds_read_b64_tr_b16 v[184:185], v195 offset:17152
    v_mfma_f32_16x16x32_bf16 v[76:79], v[156:159], v[168:171], v[76:79]
    ds_read_b64_tr_b16 v[186:187], v195 offset:19200
    s_waitcnt lgkmcnt(6)
    v_mfma_f32_16x16x32_bf16 v[80:83], v[152:155], v[172:175], v[80:83]
    ds_read_b64_tr_b16 v[188:189], v196 offset:17152
    v_mfma_f32_16x16x32_bf16 v[84:87], v[156:159], v[172:175], v[84:87]
    ds_read_b64_tr_b16 v[190:191], v196 offset:19200
    s_waitcnt lgkmcnt(6)
    v_mfma_f32_16x16x32_bf16 v[88:91], v[152:155], v[176:179], v[88:91]
    ds_read_b64_tr_b16 v[168:169], v195 offset:17408
    v_mfma_f32_16x16x32_bf16 v[92:95], v[156:159], v[176:179], v[92:95]
    ds_read_b64_tr_b16 v[170:171], v195 offset:19456
    s_waitcnt lgkmcnt(6)
    v_mfma_f32_16x16x32_bf16 v[96:99], v[152:155], v[180:183], v[96:99]
    ds_read_b64_tr_b16 v[172:173], v196 offset:17408
    v_mfma_f32_16x16x32_bf16 v[100:103], v[156:159], v[180:183], v[100:103]
    ds_read_b64_tr_b16 v[174:175], v196 offset:19456
    s_waitcnt lgkmcnt(6)
    v_mfma_f32_16x16x32_bf16 v[24:27], v[160:163], v[184:187], v[24:27]
    ds_read_b64_tr_b16 v[176:177], v195 offset:17664
    v_mfma_f32_16x16x32_bf16 v[28:31], v[164:167], v[184:187], v[28:31]
    ds_read_b64_tr_b16 v[178:179], v195 offset:19712
    v_lshlrev_b32 v216, 7, v1
    v_add_u32 v216, 33792, v216
    v_mov_b32 v217, 8
    s_waitcnt lgkmcnt(6)
    v_mfma_f32_16x16x32_bf16 v[32:35], v[160:163], v[188:191], v[32:35]
    ds_read_b64_tr_b16 v[180:181], v196 offset:17664
    v_mfma_f32_16x16x32_bf16 v[36:39], v[164:167], v[188:191], v[36:39]
    ds_read_b64_tr_b16 v[182:183], v196 offset:19712
    s_cmp_eq_u32 s44, 0
    s_cselect_b32 exec_lo, -1, 0
    s_mov_b32 exec_hi, 0
    global_load_dword v217, v216, s[10:11] sc1
    s_mov_b64 exec, -1
    s_waitcnt lgkmcnt(6)
    v_mfma_f32_16x16x32_bf16 v[40:43], v[160:163], v[168:171], v[40:43]
    ds_read_b64_tr_b16 v[184:185], v195 offset:17920
    v_mfma_f32_16x16x32_bf16 v[44:47], v[164:167], v[168:171], v[44:47]
    ds_read_b64_tr_b16 v[186:187], v195 offset:19968
    s_waitcnt lgkmcnt(6)
    v_mfma_f32_16x16x32_bf16 v[48:51], v[160:163], v[172:175], v[48:51]
    ds_read_b64_tr_b16 v[188:189], v196 offset:17920
    v_mfma_f32_16x16x32_bf16 v[52:55], v[164:167], v[172:175], v[52:55]
    ds_read_b64_tr_b16 v[190:191], v196 offset:19968
    s_waitcnt lgkmcnt(6)
    v_mfma_f32_16x16x32_bf16 v[56:59], v[160:163], v[176:179], v[56:59]
    ds_read_b64_tr_b16 v[168:169], v195 offset:18176
    v_mfma_f32_16x16x32_bf16 v[60:63], v[164:167], v[176:179], v[60:63]
    ds_read_b64_tr_b16 v[170:171], v195 offset:20224
    s_waitcnt lgkmcnt(6)
    v_mfma_f32_16x16x32_bf16 v[64:67], v[160:163], v[180:183], v[64:67]
    ds_read_b64_tr_b16 v[172:173], v196 offset:18176
    v_mfma_f32_16x16x32_bf16 v[68:71], v[164:167], v[180:183], v[68:71]
    ds_read_b64_tr_b16 v[174:175], v196 offset:20224
    v_add_u32 v192, 49152, v194
    v_add_u32 v195, 49152, v197
    v_xor_b32 v193, 64, v192
    v_xor_b32 v196, 32, v195
    s_waitcnt lgkmcnt(6)
    v_mfma_f32_16x16x32_bf16 v[72:75], v[160:163], v[184:187], v[72:75]
    v_mfma_f32_16x16x32_bf16 v[76:79], v[164:167], v[184:187], v[76:79]
    s_waitcnt lgkmcnt(0)
    s_barrier
    ds_read_b128 v[152:155], v192 offset:0
    ds_read_b128 v[156:159], v192 offset:2048
    ds_read_b64_tr_b16 v[176:177], v195 offset:768
    ds_read_b64_tr_b16 v[178:179], v195 offset:2816
    ds_read_b64_tr_b16 v[180:181], v196 offset:768
    ds_read_b64_tr_b16 v[182:183], v196 offset:2816
    v_mfma_f32_16x16x32_bf16 v[80:83], v[160:163], v[188:191], v[80:83]
    v_mfma_f32_16x16x32_bf16 v[84:87], v[164:167], v[188:191], v[84:87]
    v_mfma_f32_16x16x32_bf16 v[88:91], v[160:163], v[168:171], v[88:91]
    ds_read_b64_tr_b16 v[184:185], v195 offset:1024
    v_mfma_f32_16x16x32_bf16 v[92:95], v[164:167], v[168:171], v[92:95]
    ds_read_b64_tr_b16 v[186:187], v195 offset:3072
    v_mfma_f32_16x16x32_bf16 v[96:99], v[160:163], v[172:175], v[96:99]
    ds_read_b64_tr_b16 v[188:189], v196 offset:1024
    v_mfma_f32_16x16x32_bf16 v[100:103], v[164:167], v[172:175], v[100:103]
    ds_read_b64_tr_b16 v[190:191], v196 offset:3072
    s_waitcnt lgkmcnt(6)
    v_mfma_f32_16x16x32_bf16 v[24:27], v[152:155], v[176:179], v[24:27]
    ds_read_b128 v[160:163], v193 offset:0
    v_mfma_f32_16x16x32_bf16 v[28:31], v[156:159], v[176:179], v[28:31]
    ds_read_b128 v[164:167], v193 offset:2048
    ds_read_b64_tr_b16 v[168:169], v195 offset:1280
    ds_read_b64_tr_b16 v[170:171], v195 offset:3328
    s_waitcnt lgkmcnt(8)
    v_mfma_f32_16x16x32_bf16 v[32:35], v[152:155], v[180:183], v[32:35]
    ds_read_b64_tr_b16 v[172:173], v196 offset:1280
    v_mfma_f32_16x16x32_bf16 v[36:39], v[156:159], v[180:183], v[36:39]
    ds_read_b64_tr_b16 v[174:175], v196 offset:3328
    s_waitcnt lgkmcnt(8)
    v_mfma_f32_16x16x32_bf16 v[40:43], v[152:155], v[184:187], v[40:43]
    ds_read_b64_tr_b16 v[176:177], v195 offset:1536
    v_mfma_f32_16x16x32_bf16 v[44:47], v[156:159], v[184:187], v[44:47]
    ds_read_b64_tr_b16 v[178:179], v195 offset:3584
    s_waitcnt lgkmcnt(8)
    v_mfma_f32_16x16x32_bf16 v[48:51], v[152:155], v[188:191], v[48:51]
    ds_read_b64_tr_b16 v[180:181], v196 offset:1536
    v_mfma_f32_16x16x32_bf16 v[52:55], v[156:159], v[188:191], v[52:55]
    ds_read_b64_tr_b16 v[182:183], v196 offset:3584
    s_waitcnt lgkmcnt(6)
    v_mfma_f32_16x16x32_bf16 v[56:59], v[152:155], v[168:171], v[56:59]
    ds_read_b64_tr_b16 v[184:185], v195 offset:1792
    v_mfma_f32_16x16x32_bf16 v[60:63], v[156:159], v[168:171], v[60:63]
    ds_read_b64_tr_b16 v[186:187], v195 offset:3840
    s_waitcnt lgkmcnt(6)
    v_mfma_f32_16x16x32_bf16 v[64:67], v[152:155], v[172:175], v[64:67]
    ds_read_b64_tr_b16 v[188:189], v196 offset:1792
    v_mfma_f32_16x16x32_bf16 v[68:71], v[156:159], v[172:175], v[68:71]
    ds_read_b64_tr_b16 v[190:191], v196 offset:3840
    s_waitcnt lgkmcnt(6)
    v_mfma_f32_16x16x32_bf16 v[72:75], v[152:155], v[176:179], v[72:75]
    ds_read_b64_tr_b16 v[168:169], v195 offset:17152
    v_mfma_f32_16x16x32_bf16 v[76:79], v[156:159], v[176:179], v[76:79]
    ds_read_b64_tr_b16 v[170:171], v195 offset:19200
    s_waitcnt lgkmcnt(6)
    v_mfma_f32_16x16x32_bf16 v[80:83], v[152:155], v[180:183], v[80:83]
    ds_read_b64_tr_b16 v[172:173], v196 offset:17152
    v_mfma_f32_16x16x32_bf16 v[84:87], v[156:159], v[180:183], v[84:87]
    ds_read_b64_tr_b16 v[174:175], v196 offset:19200
    s_waitcnt lgkmcnt(6)
    v_mfma_f32_16x16x32_bf16 v[88:91], v[152:155], v[184:187], v[88:91]
    ds_read_b64_tr_b16 v[176:177], v195 offset:17408
    v_mfma_f32_16x16x32_bf16 v[92:95], v[156:159], v[184:187], v[92:95]
    ds_read_b64_tr_b16 v[178:179], v195 offset:19456
    s_waitcnt lgkmcnt(6)
    v_mfma_f32_16x16x32_bf16 v[96:99], v[152:155], v[188:191], v[96:99]
    ds_read_b64_tr_b16 v[180:181], v196 offset:17408
    v_mfma_f32_16x16x32_bf16 v[100:103], v[156:159], v[188:191], v[100:103]
    ds_read_b64_tr_b16 v[182:183], v196 offset:19456
    s_waitcnt lgkmcnt(6)
    v_mfma_f32_16x16x32_bf16 v[24:27], v[160:163], v[168:171], v[24:27]
    ds_read_b64_tr_b16 v[184:185], v195 offset:17664
    v_mfma_f32_16x16x32_bf16 v[28:31], v[164:167], v[168:171], v[28:31]
    ds_read_b64_tr_b16 v[186:187], v195 offset:19712
    s_waitcnt lgkmcnt(6)
    v_mfma_f32_16x16x32_bf16 v[32:35], v[160:163], v[172:175], v[32:35]
    ds_read_b64_tr_b16 v[188:189], v196 offset:17664
    v_mfma_f32_16x16x32_bf16 v[36:39], v[164:167], v[172:175], v[36:39]
    ds_read_b64_tr_b16 v[190:191], v196 offset:19712
    s_waitcnt lgkmcnt(6)
    v_mfma_f32_16x16x32_bf16 v[40:43], v[160:163], v[176:179], v[40:43]
    ds_read_b64_tr_b16 v[168:169], v195 offset:17920
    v_mfma_f32_16x16x32_bf16 v[44:47], v[164:167], v[176:179], v[44:47]
    ds_read_b64_tr_b16 v[170:171], v195 offset:19968
    s_waitcnt lgkmcnt(6)
    v_mfma_f32_16x16x32_bf16 v[48:51], v[160:163], v[180:183], v[48:51]
    ds_read_b64_tr_b16 v[172:173], v196 offset:17920
    v_mfma_f32_16x16x32_bf16 v[52:55], v[164:167], v[180:183], v[52:55]
    ds_read_b64_tr_b16 v[174:175], v196 offset:19968
    s_waitcnt lgkmcnt(6)
    v_mfma_f32_16x16x32_bf16 v[56:59], v[160:163], v[184:187], v[56:59]
    ds_read_b64_tr_b16 v[176:177], v195 offset:18176
    v_mfma_f32_16x16x32_bf16 v[60:63], v[164:167], v[184:187], v[60:63]
    ds_read_b64_tr_b16 v[178:179], v195 offset:20224
    s_waitcnt lgkmcnt(6)
    v_mfma_f32_16x16x32_bf16 v[64:67], v[160:163], v[188:191], v[64:67]
    ds_read_b64_tr_b16 v[180:181], v196 offset:18176
    v_mfma_f32_16x16x32_bf16 v[68:71], v[164:167], v[188:191], v[68:71]
    ds_read_b64_tr_b16 v[182:183], v196 offset:20224
    v_add_u32 v192, 98304, v194
    v_add_u32 v195, 98304, v197
    v_xor_b32 v193, 64, v192
    v_xor_b32 v196, 32, v195
    s_waitcnt vmcnt(0)
    v_cmp_gt_u32 vcc, 8, v217
    s_nop 0
    s_cmp_eq_u64 vcc, 0
    s_cbranch_scc0 PL_16
PB_17:
    s_waitcnt lgkmcnt(6)
    v_mfma_f32_16x16x32_bf16 v[72:75], v[160:163], v[168:171], v[72:75]
    v_mfma_f32_16x16x32_bf16 v[76:79], v[164:167], v[168:171], v[76:79]
    s_waitcnt lgkmcnt(0)
    s_barrier
    ds_read_b128 v[152:155], v192 offset:0
    ds_read_b128 v[156:159], v192 offset:2048
    ds_read_b64_tr_b16 v[184:185], v195 offset:768
    ds_read_b64_tr_b16 v[186:187], v195 offset:2816
    ds_read_b64_tr_b16 v[188:189], v196 offset:768
    ds_read_b64_tr_b16 v[190:191], v196 offset:2816
    v_mfma_f32_16x16x32_bf16 v[80:83], v[160:163], v[172:175], v[80:83]
    v_mfma_f32_16x16x32_bf16 v[84:87], v[164:167], v[172:175], v[84:87]
    v_mfma_f32_16x16x32_bf16 v[88:91], v[160:163], v[176:179], v[88:91]
    ds_read_b64_tr_b16 v[168:169], v195 offset:1024
    v_mfma_f32_16x16x32_bf16 v[92:95], v[164:167], v[176:179], v[92:95]
    ds_read_b64_tr_b16 v[170:171], v195 offset:3072
    v_mfma_f32_16x16x32_bf16 v[96:99], v[160:163], v[180:183], v[96:99]
    ds_read_b64_tr_b16 v[172:173], v196 offset:1024
    v_mfma_f32_16x16x32_bf16 v[100:103], v[164:167], v[180:183], v[100:103]
    ds_read_b64_tr_b16 v[174:175], v196 offset:3072
    s_waitcnt lgkmcnt(6)
    v_mfma_f32_16x16x32_bf16 v[24:27], v[152:155], v[184:187], v[24:27]
    ds_read_b128 v[160:163], v193 offset:0
    v_mfma_f32_16x16x32_bf16 v[28:31], v[156:159], v[184:187], v[28:31]
    ds_read_b128 v[164:167], v193 offset:2048
    ds_read_b64_tr_b16 v[176:177], v195 offset:1280
    ds_read_b64_tr_b16 v[178:179], v195 offset:3328
    v_and_b32 v142, 31, v1
    s_lshl_b32 s65, s46, 2
    s_add_u32 s65, s65, s45
    s_waitcnt lgkmcnt(8)
    v_mfma_f32_16x16x32_bf16 v[32:35], v[152:155], v[188:191], v[32:35]
    ds_read_b64_tr_b16 v[180:181], v196 offset:1280
    v_mfma_f32_16x16x32_bf16 v[36:39], v[156:159], v[188:191], v[36:39]
    ds_read_b64_tr_b16 v[182:183], v196 offset:3328
    s_lshl_b32 s65, s65, 7
    s_add_u32 s65, s65, 12850176
    s_add_u32 s66, s65, 8192
    s_waitcnt lgkmcnt(8)
    v_mfma_f32_16x16x32_bf16 v[40:43], v[152:155], v[168:171], v[40:43]
    ds_read_b64_tr_b16 v[184:185], v195 offset:1536
    v_mfma_f32_16x16x32_bf16 v[44:47], v[156:159], v[168:171], v[44:47]
    ds_read_b64_tr_b16 v[186:187], v195 offset:3584
    v_lshlrev_b32 v143, 2, v142
    buffer_load_dword v144, v143, s[36:39], s65 offen sc1
    buffer_load_dword v145, v143, s[36:39], s66 offen sc1
    s_waitcnt lgkmcnt(8)
    v_mfma_f32_16x16x32_bf16 v[48:51], v[152:155], v[172:175], v[48:51]
    ds_read_b64_tr_b16 v[188:189], v196 offset:1536
    v_mfma_f32_16x16x32_bf16 v[52:55], v[156:159], v[172:175], v[52:55]
    ds_read_b64_tr_b16 v[190:191], v196 offset:3584
    s_lshl_b32 s65, s45, 6
    v_add_u32 v143, s65, v1
    v_mov_b32 v146, 0
    s_waitcnt lgkmcnt(6)
    v_mfma_f32_16x16x32_bf16 v[56:59], v[152:155], v[176:179], v[56:59]
    ds_read_b64_tr_b16 v[168:169], v195 offset:1792
    v_mfma_f32_16x16x32_bf16 v[60:63], v[156:159], v[176:179], v[60:63]
    ds_read_b64_tr_b16 v[170:171], v195 offset:3840
    v_mov_b32 v147, -16
    v_cmp_le_u32 vcc, 80, v143
    s_nop 1
    v_cndmask_b32 v146, v146, v147, vcc
    s_waitcnt lgkmcnt(6)
    v_mfma_f32_16x16x32_bf16 v[64:67], v[152:155], v[180:183], v[64:67]
    ds_read_b64_tr_b16 v[172:173], v196 offset:1792
    v_mfma_f32_16x16x32_bf16 v[68:71], v[156:159], v[180:183], v[68:71]
    ds_read_b64_tr_b16 v[174:175], v196 offset:3840
    v_mov_b32 v147, 544
    v_cmp_le_u32 vcc, 96, v143
    s_nop 1
    v_cndmask_b32 v146, v146, v147, vcc
    s_waitcnt lgkmcnt(6)
    v_mfma_f32_16x16x32_bf16 v[72:75], v[152:155], v[184:187], v[72:75]
    ds_read_b64_tr_b16 v[176:177], v195 offset:17152
    v_mfma_f32_16x16x32_bf16 v[76:79], v[156:159], v[184:187], v[76:79]
    ds_read_b64_tr_b16 v[178:179], v195 offset:19200
    v_mov_b32 v147, 1104
    v_cmp_le_u32 vcc, 176, v143
    s_nop 1
    v_cndmask_b32 v146, v146, v147, vcc
    s_waitcnt lgkmcnt(6)
    v_mfma_f32_16x16x32_bf16 v[80:83], v[152:155], v[188:191], v[80:83]
    ds_read_b64_tr_b16 v[180:181], v196 offset:17152
    v_mfma_f32_16x16x32_bf16 v[84:87], v[156:159], v[188:191], v[84:87]
    ds_read_b64_tr_b16 v[182:183], v196 offset:19200
    v_add_u32 v143, v143, v146
    s_lshl_b32 s65, s49, 2
    s_add_u32 s65, s65, 12795904
    s_waitcnt lgkmcnt(6)
    v_mfma_f32_16x16x32_bf16 v[88:91], v[152:155], v[168:171], v[88:91]
    ds_read_b64_tr_b16 v[184:185], v195 offset:17408
    v_mfma_f32_16x16x32_bf16 v[92:95], v[156:159], v[168:171], v[92:95]
    ds_read_b64_tr_b16 v[186:187], v195 offset:19456
    v_lshlrev_b32 v143, 2, v143
    buffer_load_dword v146, v143, s[36:39], s65 offen sc1
    s_and_b32 s65, s67, 7
    s_waitcnt lgkmcnt(6)
    v_mfma_f32_16x16x32_bf16 v[96:99], v[152:155], v[172:175], v[96:99]
    ds_read_b64_tr_b16 v[188:189], v196 offset:17408
    v_mfma_f32_16x16x32_bf16 v[100:103], v[156:159], v[172:175], v[100:103]
    ds_read_b64_tr_b16 v[190:191], v196 offset:19456
    s_mul_i32 s65, s65, 47360
    s_mul_i32 s66, s45, 12288
    s_add_u32 s65, s65, s66
    s_waitcnt lgkmcnt(6)
    v_mfma_f32_16x16x32_bf16 v[24:27], v[160:163], v[176:179], v[24:27]
    ds_read_b64_tr_b16 v[168:169], v195 offset:17664
    v_mfma_f32_16x16x32_bf16 v[28:31], v[164:167], v[176:179], v[28:31]
    ds_read_b64_tr_b16 v[170:171], v195 offset:19712
    s_add_u32 s65, s65, s78
    v_lshlrev_b32 v217, 7, v1
    buffer_load_dword v216, v217, s[36:39], s65 offen sc1
    s_add_u32 s65, s65, 8192
    s_waitcnt lgkmcnt(6)
    v_mfma_f32_16x16x32_bf16 v[32:35], v[160:163], v[180:183], v[32:35]
    ds_read_b64_tr_b16 v[172:173], v196 offset:17664
    v_mfma_f32_16x16x32_bf16 v[36:39], v[164:167], v[180:183], v[36:39]
    ds_read_b64_tr_b16 v[174:175], v196 offset:19712
    s_mov_b32 exec_hi, 0
    buffer_load_dword v216, v217, s[36:39], s65 offen sc1
    s_mov_b32 exec_hi, -1
    s_add_u32 s65, s65, 8192
    s_waitcnt lgkmcnt(6)
    v_mfma_f32_16x16x32_bf16 v[40:43], v[160:163], v[184:187], v[40:43]
    ds_read_b64_tr_b16 v[176:177], v195 offset:17920
    v_mfma_f32_16x16x32_bf16 v[44:47], v[164:167], v[184:187], v[44:47]
    ds_read_b64_tr_b16 v[178:179], v195 offset:19968
    s_waitcnt lgkmcnt(6)
    v_mfma_f32_16x16x32_bf16 v[48:51], v[160:163], v[188:191], v[48:51]
    ds_read_b64_tr_b16 v[180:181], v196 offset:17920
    v_mfma_f32_16x16x32_bf16 v[52:55], v[164:167], v[188:191], v[52:55]
    ds_read_b64_tr_b16 v[182:183], v196 offset:19968
    s_waitcnt lgkmcnt(6)
    v_mfma_f32_16x16x32_bf16 v[56:59], v[160:163], v[168:171], v[56:59]
    ds_read_b64_tr_b16 v[184:185], v195 offset:18176
    v_mfma_f32_16x16x32_bf16 v[60:63], v[164:167], v[168:171], v[60:63]
    ds_read_b64_tr_b16 v[186:187], v195 offset:20224
    s_waitcnt lgkmcnt(6)
    v_mfma_f32_16x16x32_bf16 v[64:67], v[160:163], v[172:175], v[64:67]
    ds_read_b64_tr_b16 v[188:189], v196 offset:18176
    v_mfma_f32_16x16x32_bf16 v[68:71], v[164:167], v[172:175], v[68:71]
    ds_read_b64_tr_b16 v[190:191], v196 offset:20224
    v_add_u32 v192, 0, v194
    v_add_u32 v195, 0, v197
    v_xor_b32 v193, 64, v192
    v_xor_b32 v196, 32, v195
    v_and_b32 v147, 31, v1
    s_lshl_b32 s65, s45, 5
    v_add_lshl_u32 v147, v147, s65, 2
    s_waitcnt lgkmcnt(6)
    v_mfma_f32_16x16x32_bf16 v[72:75], v[160:163], v[176:179], v[72:75]
    v_mfma_f32_16x16x32_bf16 v[76:79], v[164:167], v[176:179], v[76:79]
    v_add_u32 v147, 147456, v147
    s_lshl_b32 s65, s45, 8
    s_add_u32 s65, s65, 161792
    v_lshl_add_u32 v148, v1, 2, s65
    s_waitcnt vmcnt(2)
    v_mul_f32 v144, 0x3acccccd, v144
    v_mul_f32 v145, 0x3acccccd, v145
    v_fma_f32 v145, -v144, v144, v145
    v_max_f32 v145, 0, v145
    v_cvt_pk_bf16_f32 v142, v145, v145
    v_and_b32 v142, 0xffff0000, v142
    v_add_f32 v142, 0x3727c5ac, v142
    v_cvt_pk_bf16_f32 v142, v142, v142
    v_and_b32 v142, 0xffff0000, v142
    v_sqrt_f32 v143, v142
    s_nop 0
    v_cvt_pk_bf16_f32 v143, v143, v143
    v_and_b32 v143, 0xffff0000, v143
    v_cvt_pk_bf16_f32 v144, v144, v144
    v_and_b32 v144, 0xffff0000, v144
    v_rcp_f32 v142, v143
    ds_write_b32 v147, v144 offset:12288
    ds_write_b32 v147, v142 offset:12800
    ds_write_b32 v147, v143 offset:13312
    ds_write_b32 v148, v146
    s_waitcnt lgkmcnt(0)
    s_barrier
    ds_read_b128 v[152:155], v192 offset:0
    ds_read_b128 v[156:159], v192 offset:2048
    ds_read_b64_tr_b16 v[168:169], v195 offset:768
    ds_read_b64_tr_b16 v[170:171], v195 offset:2816
    ds_read_b64_tr_b16 v[172:173], v196 offset:768
    ds_read_b64_tr_b16 v[174:175], v196 offset:2816
    v_mfma_f32_16x16x32_bf16 v[80:83], v[160:163], v[180:183], v[80:83]
    v_mfma_f32_16x16x32_bf16 v[84:87], v[164:167], v[180:183], v[84:87]
    v_mfma_f32_16x16x32_bf16 v[88:91], v[160:163], v[184:187], v[88:91]
    ds_read_b64_tr_b16 v[176:177], v195 offset:1024
    v_mfma_f32_16x16x32_bf16 v[92:95], v[164:167], v[184:187], v[92:95]
    ds_read_b64_tr_b16 v[178:179], v195 offset:3072
    v_mfma_f32_16x16x32_bf16 v[96:99], v[160:163], v[188:191], v[96:99]
    ds_read_b64_tr_b16 v[180:181], v196 offset:1024
    v_mfma_f32_16x16x32_bf16 v[100:103], v[164:167], v[188:191], v[100:103]
    ds_read_b64_tr_b16 v[182:183], v196 offset:3072
    s_waitcnt lgkmcnt(6)
    v_mfma_f32_16x16x32_bf16 v[24:27], v[152:155], v[168:171], v[24:27]
    ds_read_b128 v[160:163], v193 offset:0
    v_mfma_f32_16x16x32_bf16 v[28:31], v[156:159], v[168:171], v[28:31]
    ds_read_b128 v[164:167], v193 offset:2048
    ds_read_b64_tr_b16 v[184:185], v195 offset:1280
    ds_read_b64_tr_b16 v[186:187], v195 offset:3328
    v_and_b32 v208, 15, v1
    s_lshl_b32 s65, s45, 5
    v_add_lshl_u32 v209, v208, s65, 2
    s_waitcnt lgkmcnt(8)
    v_mfma_f32_16x16x32_bf16 v[32:35], v[152:155], v[172:175], v[32:35]
    ds_read_b64_tr_b16 v[188:189], v196 offset:1280
    v_mfma_f32_16x16x32_bf16 v[36:39], v[156:159], v[172:175], v[36:39]
    ds_read_b64_tr_b16 v[190:191], v196 offset:3328
    v_add_u32 v209, 147456, v209
    s_lshl_b32 s65, s79, 7
    s_add_u32 s65, s65, 161792
    s_waitcnt lgkmcnt(8)
    v_mfma_f32_16x16x32_bf16 v[40:43], v[152:155], v[176:179], v[40:43]
    ds_read_b64_tr_b16 v[168:169], v195 offset:1536
    v_mfma_f32_16x16x32_bf16 v[44:47], v[156:159], v[176:179], v[44:47]
    ds_read_b64_tr_b16 v[170:171], v195 offset:3584
    v_lshl_add_u32 v208, v208, 2, s65
    ds_read_b32 v210, v209 offset:12288
    ds_read_b32 v4, v209 offset:12800
    s_waitcnt lgkmcnt(10)
    v_mfma_f32_16x16x32_bf16 v[48:51], v[152:155], v[180:183], v[48:51]
    ds_read_b64_tr_b16 v[172:173], v196 offset:1536
    v_mfma_f32_16x16x32_bf16 v[52:55], v[156:159], v[180:183], v[52:55]
    ds_read_b64_tr_b16 v[174:175], v196 offset:3584
    ds_read_b32 v5, v209 offset:13312
    ds_read_b32 v211, v209 offset:12352
    ds_read_b32 v252, v209 offset:12864
    s_waitcnt lgkmcnt(11)
    v_mfma_f32_16x16x32_bf16 v[56:59], v[152:155], v[184:187], v[56:59]
    ds_read_b64_tr_b16 v[176:177], v195 offset:1792
    v_mfma_f32_16x16x32_bf16 v[60:63], v[156:159], v[184:187], v[60:63]
    ds_read_b64_tr_b16 v[178:179], v195 offset:3840
    ds_read_b32 v253, v209 offset:13376
    ds_read_b32 v107, v208 offset:384
    ds_read_b32 v111, v208 offset:448
    s_waitcnt lgkmcnt(14)
    v_mfma_f32_16x16x32_bf16 v[64:67], v[152:155], v[188:191], v[64:67]
    ds_read_b64_tr_b16 v[180:181], v196 offset:1792
    v_mfma_f32_16x16x32_bf16 v[68:71], v[156:159], v[188:191], v[68:71]
    ds_read_b64_tr_b16 v[182:183], v196 offset:3840
    ds_read_b32 v115, v208 offset:512
    ds_read_b32 v119, v208 offset:576
    ds_read_b32 v123, v208 offset:640
    s_waitcnt lgkmcnt(15)
    v_mfma_f32_16x16x32_bf16 v[72:75], v[152:155], v[168:171], v[72:75]
    ds_read_b64_tr_b16 v[184:185], v195 offset:17152
    v_mfma_f32_16x16x32_bf16 v[76:79], v[156:159], v[168:171], v[76:79]
    ds_read_b64_tr_b16 v[186:187], v195 offset:19200
    ds_read_b32 v127, v208 offset:704
    ds_read_b32 v131, v208 offset:768
    s_waitcnt lgkmcnt(0)
    v_mfma_f32_16x16x32_bf16 v[80:83], v[152:155], v[172:175], v[80:83]
    ds_read_b64_tr_b16 v[188:189], v196 offset:17152
    v_mfma_f32_16x16x32_bf16 v[84:87], v[156:159], v[172:175], v[84:87]
    ds_read_b64_tr_b16 v[190:191], v196 offset:19200
    ds_read_b32 v135, v208 offset:832
    ds_read_b32 v139, v208 offset:896
    ds_read_b32 v143, v208 offset:960
    v_mfma_f32_16x16x32_bf16 v[88:91], v[152:155], v[176:179], v[88:91]
    ds_read_b64_tr_b16 v[168:169], v195 offset:17408
    v_mfma_f32_16x16x32_bf16 v[92:95], v[156:159], v[176:179], v[92:95]
    ds_read_b64_tr_b16 v[170:171], v195 offset:19456
    s_mov_b32 s88, 0xffff
    s_mov_b32 s89, 0
    s_waitcnt lgkmcnt(2)
    v_mfma_f32_16x16x32_bf16 v[96:99], v[152:155], v[180:183], v[96:99]
    ds_read_b64_tr_b16 v[172:173], v196 offset:17408
    v_mfma_f32_16x16x32_bf16 v[100:103], v[156:159], v[180:183], v[100:103]
    ds_read_b64_tr_b16 v[174:175], v196 offset:19456
    v_sub_f32 v210, 0, v210
    v_cvt_pk_bf16_f32 v212, v210, v5
    v_lshlrev_b32 v213, 16, v212
    v_mfma_f32_16x16x32_bf16 v[24:27], v[160:163], v[184:187], v[24:27]
    ds_read_b64_tr_b16 v[176:177], v195 offset:17664
    v_mfma_f32_16x16x32_bf16 v[28:31], v[164:167], v[184:187], v[28:31]
    ds_read_b64_tr_b16 v[178:179], v195 offset:19712
    v_and_b32 v214, 0xffff0000, v212
    v_sub_f32 v213, v210, v213
    v_sub_f32 v214, v5, v214
    v_mfma_f32_16x16x32_bf16 v[32:35], v[160:163], v[188:191], v[32:35]
    ds_read_b64_tr_b16 v[180:181], v196 offset:17664
    v_mfma_f32_16x16x32_bf16 v[36:39], v[164:167], v[188:191], v[36:39]
    ds_read_b64_tr_b16 v[182:183], v196 offset:19712
    v_cvt_pk_bf16_f32 v213, v210, v213
    v_cvt_pk_bf16_f32 v214, v214, v2
    v_cndmask_b32 v144, 0, v213, s[88:89]
    s_waitcnt lgkmcnt(6)
    v_mfma_f32_16x16x32_bf16 v[40:43], v[160:163], v[168:171], v[40:43]
    ds_read_b64_tr_b16 v[184:185], v195 offset:17920
    v_mfma_f32_16x16x32_bf16 v[44:47], v[164:167], v[168:171], v[44:47]
    ds_read_b64_tr_b16 v[186:187], v195 offset:19968
    v_cndmask_b32 v145, 0, v212, s[88:89]
    v_cndmask_b32 v146, 0, v214, s[88:89]
    v_mov_b32 v147, 0
    s_waitcnt lgkmcnt(6)
    v_mfma_f32_16x16x32_bf16 v[48:51], v[160:163], v[172:175], v[48:51]
    ds_read_b64_tr_b16 v[188:189], v196 offset:17920
    v_mfma_f32_16x16x32_bf16 v[52:55], v[164:167], v[172:175], v[52:55]
    ds_read_b64_tr_b16 v[190:191], v196 offset:19968
    v_sub_f32 v211, 0, v211
    v_cvt_pk_bf16_f32 v212, v211, v253
    v_lshlrev_b32 v213, 16, v212
    s_waitcnt lgkmcnt(6)
    v_mfma_f32_16x16x32_bf16 v[56:59], v[160:163], v[176:179], v[56:59]
    ds_read_b64_tr_b16 v[168:169], v195 offset:18176
    v_mfma_f32_16x16x32_bf16 v[60:63], v[164:167], v[176:179], v[60:63]
    ds_read_b64_tr_b16 v[170:171], v195 offset:20224
    v_and_b32 v214, 0xffff0000, v212
    v_sub_f32 v213, v211, v213
    v_sub_f32 v214, v253, v214
    s_waitcnt lgkmcnt(6)
    v_mfma_f32_16x16x32_bf16 v[64:67], v[160:163], v[180:183], v[64:67]
    ds_read_b64_tr_b16 v[172:173], v196 offset:18176
    v_mfma_f32_16x16x32_bf16 v[68:71], v[164:167], v[180:183], v[68:71]
    ds_read_b64_tr_b16 v[174:175], v196 offset:20224
    v_cvt_pk_bf16_f32 v213, v211, v213
    v_cvt_pk_bf16_f32 v214, v214, v2
    v_cndmask_b32 v148, 0, v213, s[88:89]
    s_waitcnt lgkmcnt(6)
    v_mfma_f32_16x16x32_bf16 v[72:75], v[160:163], v[184:187], v[72:75]
    v_mfma_f32_16x16x32_bf16 v[76:79], v[164:167], v[184:187], v[76:79]
    v_cndmask_b32 v149, 0, v212, s[88:89]
    v_cndmask_b32 v150, 0, v214, s[88:89]
    v_mov_b32 v151, 0
    s_waitcnt lgkmcnt(0)
    s_barrier
    v_mfma_f32_16x16x32_bf16 v[80:83], v[160:163], v[188:191], v[80:83]
    v_mfma_f32_16x16x32_bf16 v[84:87], v[164:167], v[188:191], v[84:87]
    v_cvt_pk_bf16_f32 v104, v107, v107
    v_and_b32 v105, 0xffff0000, v104
    v_sub_f32 v105, v107, v105
    v_mfma_f32_16x16x32_bf16 v[88:91], v[160:163], v[168:171], v[88:91]
    v_mfma_f32_16x16x32_bf16 v[92:95], v[164:167], v[168:171], v[92:95]
    v_cvt_pk_bf16_f32 v105, v105, v2
    v_lshl_or_b32 v105, v198, 16, v105
    v_mov_b32 v106, v198
    v_mfma_f32_16x16x32_bf16 v[96:99], v[160:163], v[172:175], v[96:99]
    v_mfma_f32_16x16x32_bf16 v[100:103], v[164:167], v[172:175], v[100:103]
    v_mov_b32 v107, 0
    v_cvt_pk_bf16_f32 v108, v111, v111
    v_and_b32 v109, 0xffff0000, v108
    v_sub_f32 v109, v111, v109
    v_cvt_pk_bf16_f32 v109, v109, v2
    v_lshl_or_b32 v109, v198, 16, v109
    v_mov_b32 v110, v198
    v_mov_b32 v111, 0
    v_cvt_pk_bf16_f32 v112, v115, v115
    v_and_b32 v113, 0xffff0000, v112
    v_sub_f32 v113, v115, v113
    v_cvt_pk_bf16_f32 v113, v113, v2
    v_lshl_or_b32 v113, v198, 16, v113
    v_mov_b32 v114, v198
    v_mov_b32 v115, 0
    v_cvt_pk_bf16_f32 v116, v119, v119
    v_and_b32 v117, 0xffff0000, v116
    v_sub_f32 v117, v119, v117
    v_cvt_pk_bf16_f32 v117, v117, v2
    v_lshl_or_b32 v117, v198, 16, v117
    v_mov_b32 v118, v198
    v_mov_b32 v119, 0
    v_cvt_pk_bf16_f32 v120, v123, v123
    v_and_b32 v121, 0xffff0000, v120
    v_sub_f32 v121, v123, v121
    v_cvt_pk_bf16_f32 v121, v121, v2
    v_lshl_or_b32 v121, v198, 16, v121
    v_mov_b32 v122, v198
    v_mov_b32 v123, 0
    v_cvt_pk_bf16_f32 v124, v127, v127
    v_and_b32 v125, 0xffff0000, v124
    v_sub_f32 v125, v127, v125
    v_cvt_pk_bf16_f32 v125, v125, v2
    v_lshl_or_b32 v125, v2, 16, v125
    v_mov_b32 v126, v2
    v_mov_b32 v127, 0
    v_cvt_pk_bf16_f32 v128, v131, v131
    v_and_b32 v129, 0xffff0000, v128
    v_sub_f32 v129, v131, v129
    v_cvt_pk_bf16_f32 v129, v129, v2
    v_lshl_or_b32 v129, v2, 16, v129
    v_mov_b32 v130, v2
    v_mov_b32 v131, 0
    v_cvt_pk_bf16_f32 v132, v135, v135
    v_and_b32 v133, 0xffff0000, v132
    v_sub_f32 v133, v135, v133
    v_cvt_pk_bf16_f32 v133, v133, v2
    v_lshl_or_b32 v133, v2, 16, v133
    v_mov_b32 v134, v2
    v_mov_b32 v135, 0
    v_cvt_pk_bf16_f32 v136, v139, v139
    v_and_b32 v137, 0xffff0000, v136
    v_sub_f32 v137, v139, v137
    v_cvt_pk_bf16_f32 v137, v137, v2
    v_lshl_or_b32 v137, v2, 16, v137
    v_mov_b32 v138, v2
    v_mov_b32 v139, 0
    v_cvt_pk_bf16_f32 v140, v143, v143
    v_and_b32 v141, 0xffff0000, v140
    v_sub_f32 v141, v143, v141
    v_cvt_pk_bf16_f32 v141, v141, v2
    v_lshl_or_b32 v141, v2, 16, v141
    v_mov_b32 v142, v2
    v_mov_b32 v143, 0
    v_mfma_f32_16x16x32_bf16 v[24:27], v[144:147], v[104:107], v[24:27]
    v_mfma_f32_16x16x32_bf16 v[28:31], v[148:151], v[104:107], v[28:31]
    v_mfma_f32_16x16x32_bf16 v[32:35], v[144:147], v[108:111], v[32:35]
    v_mfma_f32_16x16x32_bf16 v[36:39], v[148:151], v[108:111], v[36:39]
    v_mfma_f32_16x16x32_bf16 v[40:43], v[144:147], v[112:115], v[40:43]
    v_mfma_f32_16x16x32_bf16 v[44:47], v[148:151], v[112:115], v[44:47]
    v_mfma_f32_16x16x32_bf16 v[48:51], v[144:147], v[116:119], v[48:51]
    v_mfma_f32_16x16x32_bf16 v[52:55], v[148:151], v[116:119], v[52:55]
    v_mfma_f32_16x16x32_bf16 v[56:59], v[144:147], v[120:123], v[56:59]
    v_mfma_f32_16x16x32_bf16 v[60:63], v[148:151], v[120:123], v[60:63]
    v_mfma_f32_16x16x32_bf16 v[64:67], v[144:147], v[124:127], v[64:67]
    v_mfma_f32_16x16x32_bf16 v[68:71], v[148:151], v[124:127], v[68:71]
    v_mfma_f32_16x16x32_bf16 v[72:75], v[144:147], v[128:131], v[72:75]
    v_mfma_f32_16x16x32_bf16 v[76:79], v[148:151], v[128:131], v[76:79]
    v_mfma_f32_16x16x32_bf16 v[80:83], v[144:147], v[132:135], v[80:83]
    v_mfma_f32_16x16x32_bf16 v[84:87], v[148:151], v[132:135], v[84:87]
    v_mfma_f32_16x16x32_bf16 v[88:91], v[144:147], v[136:139], v[88:91]
    v_mfma_f32_16x16x32_bf16 v[92:95], v[148:151], v[136:139], v[92:95]
    v_mfma_f32_16x16x32_bf16 v[96:99], v[144:147], v[140:143], v[96:99]
    v_mfma_f32_16x16x32_bf16 v[100:103], v[148:151], v[140:143], v[100:103]
    s_waitcnt vmcnt(0)
    s_setprio 3
    v_lshrrev_b32 v128, 4, v1
    v_lshlrev_b32 v128, 4, v128
    s_lshl_b32 s57, s45, 7
    s_add_u32 s57, s57, 160256
    v_add_u32 v128, s57, v128
    ds_read_b128 v[104:107], v128
    ds_read_b128 v[108:111], v128 offset:64
    s_mul_i32 s57, s45, 10240
    v_add_u32 v129, s57, v6
    v_mov_b32 v130, 0x3fb8aa3b
    v_mov_b32 v131, 0x35860000
    s_waitcnt lgkmcnt(0)
    v_pk_mul_f32 v[112:113], v[104:105], v[130:131] op_sel_hi:[1,0]
    v_pk_mul_f32 v[114:115], v[106:107], v[130:131] op_sel_hi:[1,0]
    v_pk_mul_f32 v[116:117], v[108:109], v[130:131] op_sel_hi:[1,0]
    v_pk_mul_f32 v[118:119], v[110:111], v[130:131] op_sel_hi:[1,0]
    v_pk_mul_f32 v[96:97], v[96:97], v[104:105]
    v_pk_mul_f32 v[98:99], v[98:99], v[106:107]
    v_pk_mul_f32 v[100:101], v[100:101], v[108:109]
    v_pk_mul_f32 v[102:103], v[102:103], v[110:111]
    v_cvt_pk_bf16_f32 v96, v96, v97
    v_cvt_pk_bf16_f32 v97, v98, v99
    v_cvt_pk_bf16_f32 v98, v100, v101
    v_cvt_pk_bf16_f32 v99, v102, v103
    ds_write_b128 v129, v[96:99] offset:9216
    v_pk_mul_f32 v[88:89], v[88:89], v[104:105]
    v_pk_mul_f32 v[90:91], v[90:91], v[106:107]
    v_pk_mul_f32 v[92:93], v[92:93], v[108:109]
    v_pk_mul_f32 v[94:95], v[94:95], v[110:111]
    v_cvt_pk_bf16_f32 v88, v88, v89
    v_cvt_pk_bf16_f32 v89, v90, v91
    v_cvt_pk_bf16_f32 v90, v92, v93
    v_cvt_pk_bf16_f32 v91, v94, v95
    ds_write_b128 v129, v[88:91] offset:8192
    v_pk_mul_f32 v[80:81], v[80:81], v[104:105]
    v_pk_mul_f32 v[82:83], v[82:83], v[106:107]
    v_pk_mul_f32 v[84:85], v[84:85], v[108:109]
    v_pk_mul_f32 v[86:87], v[86:87], v[110:111]
    v_cvt_pk_bf16_f32 v80, v80, v81
    v_cvt_pk_bf16_f32 v81, v82, v83
    v_cvt_pk_bf16_f32 v82, v84, v85
    v_cvt_pk_bf16_f32 v83, v86, v87
    ds_write_b128 v129, v[80:83] offset:7168
    v_pk_mul_f32 v[72:73], v[72:73], v[104:105]
    v_pk_mul_f32 v[74:75], v[74:75], v[106:107]
    v_pk_mul_f32 v[76:77], v[76:77], v[108:109]
    v_pk_mul_f32 v[78:79], v[78:79], v[110:111]
    v_cvt_pk_bf16_f32 v72, v72, v73
    v_cvt_pk_bf16_f32 v73, v74, v75
    v_cvt_pk_bf16_f32 v74, v76, v77
    v_cvt_pk_bf16_f32 v75, v78, v79
    ds_write_b128 v129, v[72:75] offset:6144
    v_pk_mul_f32 v[64:65], v[64:65], v[104:105]
    v_pk_mul_f32 v[66:67], v[66:67], v[106:107]
    v_pk_mul_f32 v[68:69], v[68:69], v[108:109]
    v_pk_mul_f32 v[70:71], v[70:71], v[110:111]
    v_cvt_pk_bf16_f32 v64, v64, v65
    v_cvt_pk_bf16_f32 v65, v66, v67
    v_cvt_pk_bf16_f32 v66, v68, v69
    v_cvt_pk_bf16_f32 v67, v70, v71
    ds_write_b128 v129, v[64:67] offset:5120
    v_pk_mul_f32 v[120:121], v[56:57], v[112:113]
    v_pk_mul_f32 v[122:123], v[58:59], v[114:115]
    v_pk_mul_f32 v[124:125], v[60:61], v[116:117]
    v_pk_mul_f32 v[126:127], v[62:63], v[118:119]
    v_pk_mul_f32 v[56:57], v[56:57], v[104:105]
    v_pk_mul_f32 v[58:59], v[58:59], v[106:107]
    v_pk_mul_f32 v[60:61], v[60:61], v[108:109]
    v_pk_mul_f32 v[62:63], v[62:63], v[110:111]
    v_exp_f32 v120, v120 clamp
    v_exp_f32 v121, v121 clamp
    v_exp_f32 v122, v122 clamp
    v_exp_f32 v123, v123 clamp
    v_exp_f32 v124, v124 clamp
    v_exp_f32 v125, v125 clamp
    v_exp_f32 v126, v126 clamp
    v_exp_f32 v127, v127 clamp
    v_max_f32 v56, v131, v56
    v_max_f32 v57, v131, v57
    v_max_f32 v58, v131, v58
    v_max_f32 v59, v131, v59
    v_max_f32 v60, v131, v60
    v_max_f32 v61, v131, v61
    v_max_f32 v62, v131, v62
    v_max_f32 v63, v131, v63
    v_pk_add_f32 v[56:57], v[56:57], v[120:121]
    v_pk_add_f32 v[58:59], v[58:59], v[122:123]
    v_pk_add_f32 v[60:61], v[60:61], v[124:125]
    v_pk_add_f32 v[62:63], v[62:63], v[126:127]
    v_cvt_pk_bf16_f32 v56, v56, v57
    v_cvt_pk_bf16_f32 v57, v58, v59
    v_cvt_pk_bf16_f32 v58, v60, v61
    v_cvt_pk_bf16_f32 v59, v62, v63
    ds_write_b128 v129, v[56:59] offset:4096
    v_pk_mul_f32 v[120:121], v[48:49], v[112:113]
    v_pk_mul_f32 v[122:123], v[50:51], v[114:115]
    v_pk_mul_f32 v[124:125], v[52:53], v[116:117]
    v_pk_mul_f32 v[126:127], v[54:55], v[118:119]
    v_pk_mul_f32 v[48:49], v[48:49], v[104:105]
    v_pk_mul_f32 v[50:51], v[50:51], v[106:107]
    v_pk_mul_f32 v[52:53], v[52:53], v[108:109]
    v_pk_mul_f32 v[54:55], v[54:55], v[110:111]
    v_exp_f32 v120, v120 clamp
    v_exp_f32 v121, v121 clamp
    v_exp_f32 v122, v122 clamp
    v_exp_f32 v123, v123 clamp
    v_exp_f32 v124, v124 clamp
    v_exp_f32 v125, v125 clamp
    v_exp_f32 v126, v126 clamp
    v_exp_f32 v127, v127 clamp
    v_max_f32 v48, v131, v48
    v_max_f32 v49, v131, v49
    v_max_f32 v50, v131, v50
    v_max_f32 v51, v131, v51
    v_max_f32 v52, v131, v52
    v_max_f32 v53, v131, v53
    v_max_f32 v54, v131, v54
    v_max_f32 v55, v131, v55
    v_pk_add_f32 v[48:49], v[48:49], v[120:121]
    v_pk_add_f32 v[50:51], v[50:51], v[122:123]
    v_pk_add_f32 v[52:53], v[52:53], v[124:125]
    v_pk_add_f32 v[54:55], v[54:55], v[126:127]
    v_cvt_pk_bf16_f32 v48, v48, v49
    v_cvt_pk_bf16_f32 v49, v50, v51
    v_cvt_pk_bf16_f32 v50, v52, v53
    v_cvt_pk_bf16_f32 v51, v54, v55
    ds_write_b128 v129, v[48:51] offset:3072
    v_pk_mul_f32 v[120:121], v[40:41], v[112:113]
    v_pk_mul_f32 v[122:123], v[42:43], v[114:115]
    v_pk_mul_f32 v[124:125], v[44:45], v[116:117]
    v_pk_mul_f32 v[126:127], v[46:47], v[118:119]
    v_pk_mul_f32 v[40:41], v[40:41], v[104:105]
    v_pk_mul_f32 v[42:43], v[42:43], v[106:107]
    v_pk_mul_f32 v[44:45], v[44:45], v[108:109]
    v_pk_mul_f32 v[46:47], v[46:47], v[110:111]
    v_exp_f32 v120, v120 clamp
    v_exp_f32 v121, v121 clamp
    v_exp_f32 v122, v122 clamp
    v_exp_f32 v123, v123 clamp
    v_exp_f32 v124, v124 clamp
    v_exp_f32 v125, v125 clamp
    v_exp_f32 v126, v126 clamp
    v_exp_f32 v127, v127 clamp
    v_max_f32 v40, v131, v40
    v_max_f32 v41, v131, v41
    v_max_f32 v42, v131, v42
    v_max_f32 v43, v131, v43
    v_max_f32 v44, v131, v44
    v_max_f32 v45, v131, v45
    v_max_f32 v46, v131, v46
    v_max_f32 v47, v131, v47
    v_pk_add_f32 v[40:41], v[40:41], v[120:121]
    v_pk_add_f32 v[42:43], v[42:43], v[122:123]
    v_pk_add_f32 v[44:45], v[44:45], v[124:125]
    v_pk_add_f32 v[46:47], v[46:47], v[126:127]
    v_cvt_pk_bf16_f32 v40, v40, v41
    v_cvt_pk_bf16_f32 v41, v42, v43
    v_cvt_pk_bf16_f32 v42, v44, v45
    v_cvt_pk_bf16_f32 v43, v46, v47
    ds_write_b128 v129, v[40:43] offset:2048
    v_pk_mul_f32 v[120:121], v[32:33], v[112:113]
    v_pk_mul_f32 v[122:123], v[34:35], v[114:115]
    v_pk_mul_f32 v[124:125], v[36:37], v[116:117]
    v_pk_mul_f32 v[126:127], v[38:39], v[118:119]
    v_pk_mul_f32 v[32:33], v[32:33], v[104:105]
    v_pk_mul_f32 v[34:35], v[34:35], v[106:107]
    v_pk_mul_f32 v[36:37], v[36:37], v[108:109]
    v_pk_mul_f32 v[38:39], v[38:39], v[110:111]
    v_exp_f32 v120, v120 clamp
    v_exp_f32 v121, v121 clamp
    v_exp_f32 v122, v122 clamp
    v_exp_f32 v123, v123 clamp
    v_exp_f32 v124, v124 clamp
    v_exp_f32 v125, v125 clamp
    v_exp_f32 v126, v126 clamp
    v_exp_f32 v127, v127 clamp
    v_max_f32 v32, v131, v32
    v_max_f32 v33, v131, v33
    v_max_f32 v34, v131, v34
    v_max_f32 v35, v131, v35
    v_max_f32 v36, v131, v36
    v_max_f32 v37, v131, v37
    v_max_f32 v38, v131, v38
    v_max_f32 v39, v131, v39
    v_pk_add_f32 v[32:33], v[32:33], v[120:121]
    v_pk_add_f32 v[34:35], v[34:35], v[122:123]
    v_pk_add_f32 v[36:37], v[36:37], v[124:125]
    v_pk_add_f32 v[38:39], v[38:39], v[126:127]
    v_cvt_pk_bf16_f32 v32, v32, v33
    v_cvt_pk_bf16_f32 v33, v34, v35
    v_cvt_pk_bf16_f32 v34, v36, v37
    v_cvt_pk_bf16_f32 v35, v38, v39
    ds_write_b128 v129, v[32:35] offset:1024
    v_pk_mul_f32 v[120:121], v[24:25], v[112:113]
    v_pk_mul_f32 v[122:123], v[26:27], v[114:115]
    v_pk_mul_f32 v[124:125], v[28:29], v[116:117]
    v_pk_mul_f32 v[126:127], v[30:31], v[118:119]
    v_pk_mul_f32 v[24:25], v[24:25], v[104:105]
    v_pk_mul_f32 v[26:27], v[26:27], v[106:107]
    v_pk_mul_f32 v[28:29], v[28:29], v[108:109]
    v_pk_mul_f32 v[30:31], v[30:31], v[110:111]
    v_exp_f32 v120, v120 clamp
    v_exp_f32 v121, v121 clamp
    v_exp_f32 v122, v122 clamp
    v_exp_f32 v123, v123 clamp
    v_exp_f32 v124, v124 clamp
    v_exp_f32 v125, v125 clamp
    v_exp_f32 v126, v126 clamp
    v_exp_f32 v127, v127 clamp
    v_max_f32 v24, v131, v24
    v_max_f32 v25, v131, v25
    v_max_f32 v26, v131, v26
    v_max_f32 v27, v131, v27
    v_max_f32 v28, v131, v28
    v_max_f32 v29, v131, v29
    v_max_f32 v30, v131, v30
    v_max_f32 v31, v131, v31
    v_pk_add_f32 v[24:25], v[24:25], v[120:121]
    v_pk_add_f32 v[26:27], v[26:27], v[122:123]
    v_pk_add_f32 v[28:29], v[28:29], v[124:125]
    v_pk_add_f32 v[30:31], v[30:31], v[126:127]
    v_cvt_pk_bf16_f32 v24, v24, v25
    v_cvt_pk_bf16_f32 v25, v26, v27
    v_cvt_pk_bf16_f32 v26, v28, v29
    v_cvt_pk_bf16_f32 v27, v30, v31
    ds_write_b128 v129, v[24:27] offset:0
    s_lshl_b32 s57, s44, 1
    s_sub_u32 s57, s57, 10
    s_cmp_lt_u32 s44, 5
    s_cselect_b32 s57, s44, s57
    s_lshl_b32 s57, s57, 10
    v_add_u32 v144, s57, v6
    s_max_u32 s58, s44, 1
    s_add_u32 s58, s58, 4
    s_lshl_b32 s58, s58, 10
    v_add_u32 v145, s58, v6
    s_min_u32 s58, s44, 3
    s_add_u32 s58, s58, 6
    s_lshl_b32 s58, s58, 10
    v_add_u32 v147, s58, v6
    v_add_u32 v146, 5120, v144
    s_waitcnt lgkmcnt(0)
    s_barrier
    ds_read_b128 v[104:107], v144 offset:0
    ds_read_b128 v[108:111], v144 offset:10240
    ds_read_b128 v[112:115], v144 offset:20480
    ds_read_b128 v[116:119], v144 offset:30720
    ds_read_b128 v[40:43], v145 offset:0
    ds_read_b128 v[44:47], v146 offset:0
    ds_read_b128 v[48:51], v147 offset:0
    ds_read_b128 v[52:55], v145 offset:10240
    ds_read_b128 v[56:59], v146 offset:10240
    ds_read_b128 v[60:63], v147 offset:10240
    ds_read_b128 v[64:67], v145 offset:20480
    ds_read_b128 v[68:71], v146 offset:20480
    ds_read_b128 v[72:75], v147 offset:20480
    ds_read_b128 v[76:79], v145 offset:30720
    ds_read_b128 v[80:83], v146 offset:30720
    s_waitcnt lgkmcnt(10)
    v_mfma_f32_16x16x32_bf16 v[24:27], v[104:107], v[40:43], 0
    ds_read_b128 v[84:87], v147 offset:30720
    s_waitcnt lgkmcnt(10)
    v_mfma_f32_16x16x32_bf16 v[28:31], v[104:107], v[44:47], 0
    s_waitcnt lgkmcnt(9)
    v_mfma_f32_16x16x32_bf16 v[32:35], v[104:107], v[48:51], 0
    s_waitcnt lgkmcnt(8)
    v_mfma_f32_16x16x32_bf16 v[24:27], v[108:111], v[52:55], v[24:27]
    s_waitcnt lgkmcnt(7)
    v_mfma_f32_16x16x32_bf16 v[28:31], v[108:111], v[56:59], v[28:31]
    s_waitcnt lgkmcnt(6)
    v_mfma_f32_16x16x32_bf16 v[32:35], v[108:111], v[60:63], v[32:35]
    s_waitcnt lgkmcnt(5)
    v_mfma_f32_16x16x32_bf16 v[24:27], v[112:115], v[64:67], v[24:27]
    s_waitcnt lgkmcnt(4)
    v_mfma_f32_16x16x32_bf16 v[28:31], v[112:115], v[68:71], v[28:31]
    s_waitcnt lgkmcnt(3)
    v_mfma_f32_16x16x32_bf16 v[32:35], v[112:115], v[72:75], v[32:35]
    s_waitcnt lgkmcnt(2)
    v_mfma_f32_16x16x32_bf16 v[24:27], v[116:119], v[76:79], v[24:27]
    s_waitcnt lgkmcnt(1)
    v_mfma_f32_16x16x32_bf16 v[28:31], v[116:119], v[80:83], v[28:31]
    s_waitcnt lgkmcnt(0)
    v_mfma_f32_16x16x32_bf16 v[32:35], v[116:119], v[84:87], v[32:35]
    s_lshl_b32 s57, s47, 13
    s_add_u32 s96, s24, s57
    s_addc_u32 s97, s25, 0
    s_add_u32 s96, s96, 12730368
    s_addc_u32 s97, s97, 0
    v_lshlrev_b32 v144, 2, v0
    v_add_u32 v145, 4096, v144
    v_add_u32 v146, 40960, v144
    v_cmp_gt_u32 vcc, 144, v0
    ds_write_b32 v7, v24 offset:0
    ds_write_b32 v7, v25 offset:84
    ds_write_b32 v7, v26 offset:168
    ds_write_b32 v7, v27 offset:252
    ds_write_b32 v8, v28 offset:0
    ds_write_b32 v8, v29 offset:84
    ds_write_b32 v8, v30 offset:168
    ds_write_b32 v8, v31 offset:252
    ds_write_b32 v9, v32 offset:0
    ds_write_b32 v9, v33 offset:84
    ds_write_b32 v9, v34 offset:168
    ds_write_b32 v9, v35 offset:252
    s_waitcnt lgkmcnt(0)
    s_barrier
    ds_read_b32 v136, v146 offset:0
    ds_read_b32 v137, v146 offset:2048
    ds_read_b32 v138, v146 offset:4096
    ds_read_b32 v139, v146 offset:6144
    s_waitcnt lgkmcnt(3)
    global_atomic_add_f32 v144, v136, s[96:97] offset:0
    s_waitcnt lgkmcnt(2)
    global_atomic_add_f32 v144, v137, s[96:97] offset:2048
    s_waitcnt lgkmcnt(1)
    global_atomic_add_f32 v145, v138, s[96:97] offset:0
    s_waitcnt lgkmcnt(0)
    s_mov_b64 exec, vcc
    global_atomic_add_f32 v145, v139, s[96:97] offset:2048
    s_mov_b64 exec, -1
    s_waitcnt vmcnt(0)
    s_barrier
    s_add_u32 s57, s47, 0
    s_lshl_b32 s57, s57, 7
    v_mov_b32 v150, s57
    v_mov_b32 v151, 1
    s_cmp_eq_u32 s44, 0
    s_cselect_b32 exec_lo, 1, 0
    s_mov_b32 exec_hi, 0
    global_atomic_add v150, v151, s[10:11]
    s_mov_b64 exec, -1
    s_setprio 0
    s_add_u32 s65, s75, 0
    s_cmp_ge_u32 s65, s73
    s_cselect_b32 s61, s73, 0
    s_sub_u32 s65, s65, s61
    s_add_u32 s65, s65, s69
    s_mul_i32 s65, s65, 5120
    s_add_u32 s65, s65, s78
    buffer_load_dwordx4 v[152:155], v6, s[36:39], s65 offen offset:0 sc1
    buffer_load_dwordx4 v[156:159], v6, s[36:39], s65 offen offset:1024 sc1
    buffer_load_dwordx4 v[160:163], v6, s[36:39], s65 offen offset:2048 sc1
    buffer_load_dwordx4 v[164:167], v6, s[36:39], s65 offen offset:3072 sc1
    s_add_u32 s65, s65, 4096
    buffer_load_dwordx4 v[168:171], v6, s[36:39], s65 offen offset:0 sc1
    s_add_u32 s65, s75, 1
    s_cmp_ge_u32 s65, s73
    s_cselect_b32 s61, s73, 0
    s_sub_u32 s65, s65, s61
    s_add_u32 s65, s65, s69
    s_mul_i32 s65, s65, 5120
    s_add_u32 s65, s65, s78
    buffer_load_dwordx4 v[172:175], v6, s[36:39], s65 offen offset:0 sc1
    buffer_load_dwordx4 v[176:179], v6, s[36:39], s65 offen offset:1024 sc1
    buffer_load_dwordx4 v[180:183], v6, s[36:39], s65 offen offset:2048 sc1
    buffer_load_dwordx4 v[184:187], v6, s[36:39], s65 offen offset:3072 sc1
    s_add_u32 s65, s65, 4096
    buffer_load_dwordx4 v[188:191], v6, s[36:39], s65 offen offset:0 sc1
    s_add_u32 s65, s75, 2
    s_cmp_ge_u32 s65, s73
    s_cselect_b32 s61, s73, 0
    s_sub_u32 s65, s65, s61
    s_add_u32 s65, s65, s69
    s_mul_i32 s65, s65, 5120
    s_add_u32 s65, s65, s78
    buffer_load_dwordx4 v[192:195], v6, s[36:39], s65 offen offset:0 sc1
    buffer_load_dwordx4 v[196:199], v6, s[36:39], s65 offen offset:1024 sc1
    buffer_load_dwordx4 v[200:203], v6, s[36:39], s65 offen offset:2048 sc1
    buffer_load_dwordx4 v[204:207], v6, s[36:39], s65 offen offset:3072 sc1
    s_add_u32 s65, s65, 4096
    buffer_load_dwordx4 v[208:211], v6, s[36:39], s65 offen offset:0 sc1
    s_add_u32 s65, s75, 3
    s_cmp_ge_u32 s65, s73
    s_cselect_b32 s61, s73, 0
    s_sub_u32 s65, s65, s61
    s_add_u32 s65, s65, s69
    s_mul_i32 s65, s65, 5120
    s_add_u32 s65, s65, s78
    buffer_load_dwordx4 v[212:215], v6, s[36:39], s65 offen offset:0 sc1
    buffer_load_dwordx4 v[216:219], v6, s[36:39], s65 offen offset:1024 sc1
    buffer_load_dwordx4 v[220:223], v6, s[36:39], s65 offen offset:2048 sc1
    buffer_load_dwordx4 v[224:227], v6, s[36:39], s65 offen offset:3072 sc1
    s_add_u32 s65, s65, 4096
    buffer_load_dwordx4 v[228:231], v6, s[36:39], s65 offen offset:0 sc1
    s_add_u32 s65, s75, 4
    s_cmp_ge_u32 s65, s73
    s_cselect_b32 s61, s73, 0
    s_sub_u32 s65, s65, s61
    s_add_u32 s65, s65, s69
    s_mul_i32 s65, s65, 5120
    s_add_u32 s65, s65, s78
    buffer_load_dwordx4 v[232:235], v6, s[36:39], s65 offen offset:0 sc1
    buffer_load_dwordx4 v[236:239], v6, s[36:39], s65 offen offset:1024 sc1
    buffer_load_dwordx4 v[240:243], v6, s[36:39], s65 offen offset:2048 sc1
    buffer_load_dwordx4 v[244:247], v6, s[36:39], s65 offen offset:3072 sc1
    s_add_u32 s65, s65, 4096
    buffer_load_dwordx4 v[248:251], v6, s[36:39], s65 offen offset:0 sc1
    s_add_u32 s65, s76, 0
    s_cmp_ge_u32 s65, s74
    s_cselect_b32 s61, s74, 0
    s_sub_u32 s65, s65, s61
    s_add_u32 s65, s65, s72
    s_mul_i32 s65, s65, 5120
    s_add_u32 s65, s65, s78
    s_mul_i32 s66, s44, 20480
    s_add_u32 m0, s66, 0
    s_nop 0
    buffer_load_dwordx4 v6, s[36:39], s65 offen sc1 lds
    s_add_u32 s65, s65, 1024
    s_add_u32 m0, s66, 1024
    s_nop 0
    buffer_load_dwordx4 v6, s[36:39], s65 offen sc1 lds
    s_add_u32 s65, s65, 1024
    s_add_u32 m0, s66, 2048
    s_nop 0
    buffer_load_dwordx4 v6, s[36:39], s65 offen sc1 lds
    s_add_u32 s65, s65, 1024
    s_add_u32 m0, s66, 3072
    s_nop 0
    buffer_load_dwordx4 v6, s[36:39], s65 offen sc1 lds
    s_add_u32 s65, s65, 1024
    s_add_u32 m0, s66, 4096
    s_nop 0
    buffer_load_dwordx4 v6, s[36:39], s65 offen sc1 lds
    s_add_u32 s65, s76, 1
    s_cmp_ge_u32 s65, s74
    s_cselect_b32 s61, s74, 0
    s_sub_u32 s65, s65, s61
    s_add_u32 s65, s65, s72
    s_mul_i32 s65, s65, 5120
    s_add_u32 s65, s65, s78
    s_mul_i32 s66, s44, 20480
    s_add_u32 m0, s66, 5120
    s_nop 0
    buffer_load_dwordx4 v6, s[36:39], s65 offen sc1 lds
    s_add_u32 s65, s65, 1024
    s_add_u32 m0, s66, 6144
    s_nop 0
    buffer_load_dwordx4 v6, s[36:39], s65 offen sc1 lds
    s_add_u32 s65, s65, 1024
    s_add_u32 m0, s66, 7168
    s_nop 0
    buffer_load_dwordx4 v6, s[36:39], s65 offen sc1 lds
    s_add_u32 s65, s65, 1024
    s_add_u32 m0, s66, 8192
    s_nop 0
    buffer_load_dwordx4 v6, s[36:39], s65 offen sc1 lds
    s_add_u32 s65, s65, 1024
    s_add_u32 m0, s66, 9216
    s_nop 0
    buffer_load_dwordx4 v6, s[36:39], s65 offen sc1 lds
    s_add_u32 s65, s76, 2
    s_cmp_ge_u32 s65, s74
    s_cselect_b32 s61, s74, 0
    s_sub_u32 s65, s65, s61
    s_add_u32 s65, s65, s72
    s_mul_i32 s65, s65, 5120
    s_add_u32 s65, s65, s78
    s_cmp_gt_u32 s74, 2
    s_cselect_b32 s65, s65, 2130706432
    s_mul_i32 s66, s44, 20480
    s_add_u32 m0, s66, 10240
    s_nop 0
    buffer_load_dwordx4 v6, s[36:39], s65 offen sc1 lds
    s_add_u32 s65, s65, 1024
    s_add_u32 m0, s66, 11264
    s_nop 0
    buffer_load_dwordx4 v6, s[36:39], s65 offen sc1 lds
    s_add_u32 s65, s65, 1024
    s_add_u32 m0, s66, 12288
    s_nop 0
    buffer_load_dwordx4 v6, s[36:39], s65 offen sc1 lds
    s_add_u32 s65, s65, 1024
    s_add_u32 m0, s66, 13312
    s_nop 0
    buffer_load_dwordx4 v6, s[36:39], s65 offen sc1 lds
    s_add_u32 s65, s65, 1024
    s_add_u32 m0, s66, 14336
    s_nop 0
    buffer_load_dwordx4 v6, s[36:39], s65 offen sc1 lds
    s_branch PHASE2
ROLE_H0:
    s_mov_b32 s79, 0
    s_waitcnt lgkmcnt(0)
    s_mov_b32 s28, s4
    s_mov_b32 s29, s5
    s_mov_b32 s30, 2621440
    s_mov_b32 s31, 0x20000
    s_mov_b32 s36, s24
    s_mov_b32 s37, s25
    s_mov_b32 s38, 12866560
    s_mov_b32 s39, 0x20000
    s_add_u32 s10, s24, 12812288
    s_addc_u32 s11, s25, 0
    v_mov_b32 v112, 0
    v_mov_b32 v113, 0
    v_mov_b32 v114, 0
    v_mov_b32 v115, 0
    v_mov_b32 v117, 162816
    ds_write_b128 v117, v[112:115]
    ds_write_b128 v117, v[112:115] offset:16
    s_cmp_lg_u32 s45, 3
    s_cbranch_scc1 NI_20
    s_and_b32 s57, s2, 196
    s_cbranch_scc1 NI_20
    v_mov_b32 v112, 0
    v_mov_b32 v113, 0
    v_mov_b32 v114, 0
    v_mov_b32 v115, 0
    s_lshr_b32 s57, s2, 3
    s_lshl_b32 s57, s57, 2
    s_and_b32 s58, s2, 3
    s_add_u32 s57, s57, s58
    s_mul_i32 s57, s57, 4256
    s_add_u32 s57, s57, 12730368
    buffer_store_dwordx4 v[112:115], v6, s[36:39], s57 offen sc1
    buffer_store_dwordx4 v[112:115], v6, s[36:39], s57 offen offset:1024 sc1
    buffer_store_dwordx4 v[112:115], v6, s[36:39], s57 offen offset:2048 sc1
    buffer_store_dwordx4 v[112:115], v6, s[36:39], s57 offen offset:3072 sc1
    buffer_store_dwordx4 v[112:115], v6, s[36:39], s57 offen offset:3232 sc1
    v_mov_b32 v116, 1
    s_waitcnt vmcnt(0)
    s_mov_b64 exec, 1
    global_atomic_add v2, v116, s[22:23]
    s_mov_b64 exec, -1
NI_20:
    s_getpc_b64 s[26:27]
PC_21:
    s_sub_u32 s26, s26, PC_21-parallel_sum__linear_attn_block__mixer_channel_mlp__prompt_kernel
    s_subb_u32 s27, s27, 0
    s_bfe_u32 s57, s2, 0x20003
    s_lshl_b32 s57, s57, 14
    v_lshlrev_b32 v106, 6, v0
    v_add_u32 v106, s57, v106
    v_min_u32 v106, CODE_END-parallel_sum__linear_attn_block__mixer_channel_mlp__prompt_kernel-4, v106
    v_mov_b32 v107, s27
    v_add_co_u32 v106, vcc, s26, v106
    s_nop 1
    v_addc_co_u32 v107, vcc, 0, v107, vcc
    s_mov_b32 exec_lo, 0x55555555
    s_mov_b32 exec_hi, 0x55555555
    global_load_dword v4, v[106:107], off
    s_mov_b64 exec, -1
    s_lshl_b32 s57, s45, 8
    s_add_u32 s60, s57, s2
    s_mul_i32 s59, s60, 6554
    s_lshr_b32 s59, s59, 16
    s_mul_i32 s57, s59, 10
    s_sub_u32 s58, s60, s57
    s_min_u32 s53, s45, 2
    s_lshl_b32 s53, s53, 12
    s_add_u32 s63, s53, 147456
    s_cmp_lt_u32 s59, 54
    s_cselect_b32 s40, s16, s8
    s_cselect_b32 s41, s17, s9
    s_mov_b32 s42, 819200
    s_cselect_b32 s42, 2211840, s42
    s_mov_b32 s43, 0x20000
    s_cselect_b32 s57, 0, 54
    s_sub_u32 s57, s59, s57
    s_mul_i32 s57, s57, 40960
    s_lshl_b32 s53, s58, 7
    s_add_u32 s62, s57, s53
    v_lshrrev_b32 v140, 3, v1
    v_mul_u32_u24 v140, 1280, v140
    v_and_b32 v141, 7, v1
    v_lshl_add_u32 v206, v141, 4, v140
    s_cmp_lt_u32 s60, 740
    s_cselect_b32 s64, -1, 0
    s_barrier
    s_mov_b32 exec_lo, s64
    s_mov_b32 exec_hi, s64
    s_add_u32 m0, s63, 0
    s_add_u32 s65, s62, 0
    buffer_load_dwordx4 v206, s[40:43], s65 offen nt lds
    s_add_u32 m0, s63, 1024
    s_add_u32 s65, s62, 10240
    buffer_load_dwordx4 v206, s[40:43], s65 offen nt lds
    s_add_u32 m0, s63, 2048
    s_add_u32 s65, s62, 20480
    buffer_load_dwordx4 v206, s[40:43], s65 offen nt lds
    s_add_u32 m0, s63, 3072
    s_add_u32 s65, s62, 30720
    buffer_load_dwordx4 v206, s[40:43], s65 offen nt lds
    s_mov_b64 exec, -1
    s_lshl_b32 s57, s58, 2
    s_add_u32 s57, s57, 0
    s_mul_i32 s65, s57, 52
    s_lshr_b32 s65, s65, 8
    s_mul_i32 s65, s65, 373760
    s_lshl_b32 s57, s57, 10
    s_add_u32 s57, s57, s65
    s_mul_i32 s65, s59, 5120
    s_add_u32 s57, s57, s65
    s_add_u32 s57, s57, 9699328
    s_cmp_lt_u32 s60, 740
    s_cselect_b32 s80, s57, 2130706432
    s_lshl_b32 s57, s58, 2
    s_add_u32 s57, s57, 1
    s_mul_i32 s65, s57, 52
    s_lshr_b32 s65, s65, 8
    s_mul_i32 s65, s65, 373760
    s_lshl_b32 s57, s57, 10
    s_add_u32 s57, s57, s65
    s_mul_i32 s65, s59, 5120
    s_add_u32 s57, s57, s65
    s_add_u32 s57, s57, 9699328
    s_cmp_lt_u32 s60, 740
    s_cselect_b32 s81, s57, 2130706432
    s_lshl_b32 s57, s58, 2
    s_add_u32 s57, s57, 2
    s_mul_i32 s65, s57, 52
    s_lshr_b32 s65, s65, 8
    s_mul_i32 s65, s65, 373760
    s_lshl_b32 s57, s57, 10
    s_add_u32 s57, s57, s65
    s_mul_i32 s65, s59, 5120
    s_add_u32 s57, s57, s65
    s_add_u32 s57, s57, 9699328
    s_cmp_lt_u32 s60, 740
    s_cselect_b32 s82, s57, 2130706432
    s_lshl_b32 s57, s58, 2
    s_add_u32 s57, s57, 3
    s_mul_i32 s65, s57, 52
    s_lshr_b32 s65, s65, 8
    s_mul_i32 s65, s65, 373760
    s_lshl_b32 s57, s57, 10
    s_add_u32 s57, s57, s65
    s_mul_i32 s65, s59, 5120
    s_add_u32 s57, s57, s65
    s_add_u32 s57, s57, 9699328
    s_cmp_lt_u32 s60, 740
    s_cselect_b32 s83, s57, 2130706432
    v_lshrrev_b32 v140, 2, v1
    v_lshlrev_b32 v140, 7, v140
    v_and_b32 v141, 3, v1
    v_lshl_add_u32 v140, v141, 3, v140
    v_add_u32 v218, s63, v140
    v_and_b32 v140, 15, v1
    s_lshl_b32 s57, s45, 5
    v_add_u32 v140, s57, v140
    v_bfe_u32 v141, v140, 1, 3
    v_lshrrev_b32 v142, 4, v1
    v_xor_b32 v141, v141, v142
    v_lshlrev_b32 v141, 4, v141
    v_lshl_add_u32 v194, v140, 7, v141
    v_mul_u32_u24 v140, 3584, v142
    v_and_b32 v142, 1, v142
    v_lshl_add_u32 v140, v142, 5, v140
    v_bfe_u32 v141, v1, 2, 2
    v_lshl_add_u32 v140, v141, 6, v140
    v_and_b32 v141, 3, v1
    v_lshl_add_u32 v140, v141, 3, v140
    v_add_u32 v197, 16384, v140
    s_min_u32 s57, s44, 6
    s_lshl_b32 s57, s57, 8
    s_add_u32 s57, s57, 16384
    v_add_u32 v226, s57, v140
    v_xor_b32 v227, 32, v226
    v_mov_b32 v136, 0x3f803f80
    v_mov_b32 v137, 0x3f803f80
    v_mov_b32 v138, 0x3f803f80
    v_mov_b32 v139, 0x3f803f80
    s_and_b32 s57, s2, 3
    s_lshl_b32 s57, s57, 3
    s_bfe_u32 s58, s2, 0x30003
    s_add_u32 s67, s57, s58
    s_bfe_u32 s57, s2, 0x10002
    s_lshl_b32 s57, s57, 2
    s_lshr_b32 s58, s2, 6
    s_add_u32 s68, s57, s58
    s_lshl_b32 s57, s45, 3
    s_lshr_b32 s70, 0x302a231c, s57
    s_and_b32 s70, s70, 255
    s_cmp_eq_u32 s48, 0
    s_cselect_b32 s60, 0, 0
    s_mul_i32 s57, s44, 7
    s_add_u32 s58, s70, s60
    s_cmp_lt_u32 s44, 6
    s_cselect_b32 s59, 7, 6
    s_sub_u32 s59, s59, s60
    s_cmp_lt_u32 s44, 4
    s_cselect_b32 s69, s57, s58
    s_cselect_b32 s73, 7, s59
    s_cselect_b32 s71, s60, 0
    s_and_b32 s57, s44, 1
    s_sub_u32 s74, 3, s57
    s_mul_i32 s57, s57, 3
    s_lshr_b32 s58, s44, 1
    s_mul_i32 s58, s58, 5
    s_add_u32 s57, s57, s58
    s_add_u32 s72, s57, 54
    s_and_b32 s57, s68, 3
    s_mul_i32 s75, s57, 2
    s_mul_i32 s76, s57, 1
    s_cmp_ge_u32 s75, s73
    s_cselect_b32 s57, s73, 0
    s_sub_u32 s75, s75, s57
    s_cmp_ge_u32 s75, s73
    s_cselect_b32 s57, s73, 0
    s_sub_u32 s75, s75, s57
    s_cmp_ge_u32 s76, s74
    s_cselect_b32 s57, s74, 0
    s_sub_u32 s76, s76, s57
    s_cmp_ge_u32 s76, s74
    s_cselect_b32 s57, s74, 0
    s_sub_u32 s76, s76, s57
    s_cmp_ge_u32 s76, s74
    s_cselect_b32 s57, s74, 0
    s_sub_u32 s76, s76, s57
    s_mul_i32 s77, s67, 303104
    s_mul_i32 s78, s68, 378880
    s_add_u32 s78, s78, 9699328
    s_mov_b32 s96, s14
    s_mov_b32 s97, s15
    s_mov_b32 s98, 3456
    s_mov_b32 s99, 0x20000
    s_lshl_b32 s57, s79, 5
    s_add_u32 s57, s57, s49
    s_lshl_b32 s57, s57, 1
    v_and_b32 v140, 15, v1
    v_lshlrev_b32 v140, 1, v140
    buffer_load_ushort v198, v140, s[96:99], s57 offen offset:0
    buffer_load_ushort v199, v140, s[96:99], s57 offen offset:32
    buffer_load_ushort v200, v140, s[96:99], s57 offen offset:64
    buffer_load_ushort v201, v140, s[96:99], s57 offen offset:96
    buffer_load_ushort v202, v140, s[96:99], s57 offen offset:128
    buffer_load_ushort v203, v140, s[96:99], s57 offen offset:160
    buffer_load_ushort v204, v140, s[96:99], s57 offen offset:192
    buffer_load_ushort v205, v140, s[96:99], s57 offen offset:224
    v_mov_b32 v148, 32
    s_cmp_eq_u32 s45, 3
    s_cselect_b32 exec_lo, 1, 0
    s_mov_b32 exec_hi, 0
    global_load_dword v148, v2, s[22:23] sc1
    s_mov_b64 exec, -1
    v_add_u32 v192, 0, v194
    v_add_u32 v195, 0, v197
    v_xor_b32 v193, 64, v192
    v_xor_b32 v196, 32, v195
    s_barrier
    ds_read_b128 v[152:155], v192 offset:0
    ds_read_b128 v[156:159], v192 offset:2048
    ds_read_b64_tr_b16 v[168:169], v195 offset:0
    ds_read_b64_tr_b16 v[170:171], v195 offset:1792
    ds_read_b64_tr_b16 v[172:173], v196 offset:0
    ds_read_b64_tr_b16 v[174:175], v196 offset:1792
    ds_read_b64_tr_b16 v[176:177], v195 offset:256
    ds_read_b64_tr_b16 v[178:179], v195 offset:2048
    ds_read_b64_tr_b16 v[180:181], v196 offset:256
    ds_read_b64_tr_b16 v[182:183], v196 offset:2048
    ds_read_b64_tr_b16 v[184:185], v195 offset:512
    ds_read_b64_tr_b16 v[186:187], v195 offset:2304
    s_waitcnt lgkmcnt(8)
    v_mfma_f32_16x16x32_bf16 v[24:27], v[168:171], v[152:155], 0
    ds_read_b128 v[160:163], v193 offset:0
    v_mfma_f32_16x16x32_bf16 v[28:31], v[168:171], v[156:159], 0
    v_mfma_f32_4x4x4_16b_bf16 v[120:123], v[152:153], v[152:153], 0
    v_mfma_f32_4x4x4_16b_bf16 v[128:131], v[136:137], v[152:153], 0
    ds_read_b128 v[164:167], v193 offset:2048
    ds_read_b64_tr_b16 v[104:105], v226 offset:0
    ds_read_b64_tr_b16 v[106:107], v226 offset:1792
    ds_read_b64_tr_b16 v[108:109], v226 offset:14336
    s_waitcnt lgkmcnt(11)
    v_mfma_f32_16x16x32_bf16 v[32:35], v[172:175], v[152:155], 0
    ds_read_b64_tr_b16 v[188:189], v196 offset:512
    v_mfma_f32_16x16x32_bf16 v[36:39], v[172:175], v[156:159], 0
    v_mfma_f32_4x4x4_16b_bf16 v[120:123], v[154:155], v[154:155], v[120:123]
    v_mfma_f32_4x4x4_16b_bf16 v[128:131], v[136:137], v[154:155], v[128:131]
    ds_read_b64_tr_b16 v[190:191], v196 offset:2304
    ds_read_b64_tr_b16 v[110:111], v226 offset:16128
    ds_read_b64_tr_b16 v[112:113], v227 offset:0
    ds_read_b64_tr_b16 v[114:115], v227 offset:1792
    s_waitcnt lgkmcnt(14)
    v_mfma_f32_16x16x32_bf16 v[40:43], v[176:179], v[152:155], 0
    ds_read_b64_tr_b16 v[168:169], v195 offset:768
    v_mfma_f32_16x16x32_bf16 v[44:47], v[176:179], v[156:159], 0
    v_mfma_f32_4x4x4_16b_bf16 v[124:127], v[156:157], v[156:157], 0
    v_mfma_f32_4x4x4_16b_bf16 v[132:135], v[136:137], v[156:157], 0
    ds_read_b64_tr_b16 v[170:171], v195 offset:2560
    ds_read_b64_tr_b16 v[116:117], v227 offset:14336
    ds_read_b64_tr_b16 v[118:119], v227 offset:16128
    s_waitcnt lgkmcnt(10)
    v_mfma_f32_16x16x32_bf16 v[48:51], v[180:183], v[152:155], 0
    ds_read_b64_tr_b16 v[172:173], v196 offset:768
    v_mfma_f32_16x16x32_bf16 v[52:55], v[180:183], v[156:159], 0
    v_mfma_f32_4x4x4_16b_bf16 v[124:127], v[158:159], v[158:159], v[124:127]
    v_mfma_f32_4x4x4_16b_bf16 v[132:135], v[136:137], v[158:159], v[132:135]
    ds_read_b64_tr_b16 v[174:175], v196 offset:2560
    v_mfma_f32_16x16x32_bf16 v[208:211], v[136:139], v[104:107], 0
    s_waitcnt lgkmcnt(8)
    v_mfma_f32_16x16x32_bf16 v[208:211], v[136:139], v[108:111], v[208:211]
    v_mfma_f32_16x16x32_bf16 v[56:59], v[184:187], v[152:155], 0
    ds_read_b64_tr_b16 v[176:177], v195 offset:14336
    v_mfma_f32_16x16x32_bf16 v[60:63], v[184:187], v[156:159], 0
    ds_read_b64_tr_b16 v[178:179], v195 offset:16128
    s_waitcnt lgkmcnt(8)
    v_mfma_f32_16x16x32_bf16 v[212:215], v[136:139], v[112:115], 0
    s_waitcnt lgkmcnt(4)
    v_mfma_f32_16x16x32_bf16 v[64:67], v[188:191], v[152:155], 0
    ds_read_b64_tr_b16 v[180:181], v196 offset:14336
    v_mfma_f32_16x16x32_bf16 v[68:71], v[188:191], v[156:159], 0
    ds_read_b64_tr_b16 v[182:183], v196 offset:16128
    v_mfma_f32_16x16x32_bf16 v[212:215], v[136:139], v[116:119], v[212:215]
    v_mfma_f32_16x16x32_bf16 v[72:75], v[168:171], v[152:155], 0
    ds_read_b64_tr_b16 v[184:185], v195 offset:14592
    v_mfma_f32_16x16x32_bf16 v[76:79], v[168:171], v[156:159], 0
    ds_read_b64_tr_b16 v[186:187], v195 offset:16384
    s_waitcnt lgkmcnt(6)
    v_mfma_f32_16x16x32_bf16 v[80:83], v[172:175], v[152:155], 0
    ds_read_b64_tr_b16 v[188:189], v196 offset:14592
    v_mfma_f32_16x16x32_bf16 v[84:87], v[172:175], v[156:159], 0
    ds_read_b64_tr_b16 v[190:191], v196 offset:16384
    s_waitcnt lgkmcnt(6)
    v_mfma_f32_16x16x32_bf16 v[24:27], v[176:179], v[160:163], v[24:27]
    ds_read_b64_tr_b16 v[168:169], v195 offset:14848
    v_mfma_f32_16x16x32_bf16 v[28:31], v[176:179], v[164:167], v[28:31]
    v_mfma_f32_4x4x4_16b_bf16 v[120:123], v[160:161], v[160:161], v[120:123]
    v_mfma_f32_4x4x4_16b_bf16 v[128:131], v[136:137], v[160:161], v[128:131]
    ds_read_b64_tr_b16 v[170:171], v195 offset:16640
    s_waitcnt vmcnt(8)
    ds_read_b64_tr_b16 v[104:105], v218 offset:0
    ds_read_b64_tr_b16 v[106:107], v218 offset:2048
    s_waitcnt lgkmcnt(8)
    v_mfma_f32_16x16x32_bf16 v[32:35], v[180:183], v[160:163], v[32:35]
    ds_read_b64_tr_b16 v[172:173], v196 offset:14848
    v_mfma_f32_16x16x32_bf16 v[36:39], v[180:183], v[164:167], v[36:39]
    v_mfma_f32_4x4x4_16b_bf16 v[120:123], v[162:163], v[162:163], v[120:123]
    v_mfma_f32_4x4x4_16b_bf16 v[128:131], v[136:137], v[162:163], v[128:131]
    ds_read_b64_tr_b16 v[174:175], v196 offset:16640
    ds_read_b64_tr_b16 v[108:109], v218 offset:32
    ds_read_b64_tr_b16 v[110:111], v218 offset:2080
    ds_read_b64_tr_b16 v[112:113], v218 offset:64
    s_waitcnt lgkmcnt(11)
    v_mfma_f32_16x16x32_bf16 v[40:43], v[184:187], v[160:163], v[40:43]
    ds_read_b64_tr_b16 v[176:177], v195 offset:15104
    v_mfma_f32_16x16x32_bf16 v[44:47], v[184:187], v[164:167], v[44:47]
    v_mfma_f32_4x4x4_16b_bf16 v[124:127], v[164:165], v[164:165], v[124:127]
    v_mfma_f32_4x4x4_16b_bf16 v[132:135], v[136:137], v[164:165], v[132:135]
    ds_read_b64_tr_b16 v[178:179], v195 offset:16896
    ds_read_b64_tr_b16 v[114:115], v218 offset:2112
    ds_read_b64_tr_b16 v[116:117], v218 offset:96
    ds_read_b64_tr_b16 v[118:119], v218 offset:2144
    s_waitcnt lgkmcnt(14)
    v_mfma_f32_16x16x32_bf16 v[48:51], v[188:191], v[160:163], v[48:51]
    ds_read_b64_tr_b16 v[180:181], v196 offset:15104
    v_mfma_f32_16x16x32_bf16 v[52:55], v[188:191], v[164:167], v[52:55]
    v_mfma_f32_4x4x4_16b_bf16 v[124:127], v[166:167], v[166:167], v[124:127]
    v_mfma_f32_4x4x4_16b_bf16 v[132:135], v[136:137], v[166:167], v[132:135]
    ds_read_b64_tr_b16 v[182:183], v196 offset:16896
    v_add_u32 v192, 49152, v194
    v_add_u32 v195, 49152, v197
    v_xor_b32 v193, 64, v192
    v_xor_b32 v196, 32, v195
    s_waitcnt lgkmcnt(12)
    buffer_store_dwordx4 v[104:107], v6, s[36:39], s80 offen sc1
    s_waitcnt lgkmcnt(8)
    v_mfma_f32_16x16x32_bf16 v[56:59], v[168:171], v[160:163], v[56:59]
    v_mfma_f32_16x16x32_bf16 v[60:63], v[168:171], v[164:167], v[60:63]
    buffer_store_dwordx4 v[108:111], v6, s[36:39], s81 offen sc1
    s_waitcnt lgkmcnt(4)
    buffer_store_dwordx4 v[112:115], v6, s[36:39], s82 offen sc1
    s_waitcnt lgkmcnt(2)
    buffer_store_dwordx4 v[116:119], v6, s[36:39], s83 offen sc1
    s_waitcnt vmcnt(4)
    v_readfirstlane_b32 s65, v148
    s_nop 0
    s_cmp_ge_u32 s65, 32
    s_cbranch_scc0 PL_22
PB_23:
    s_waitcnt lgkmcnt(0)
    s_barrier
    ds_read_b128 v[152:155], v192 offset:0
    ds_read_b128 v[156:159], v192 offset:2048
    ds_read_b64_tr_b16 v[184:185], v195 offset:0
    ds_read_b64_tr_b16 v[186:187], v195 offset:1792
    ds_read_b64_tr_b16 v[188:189], v196 offset:0
    ds_read_b64_tr_b16 v[190:191], v196 offset:1792
    v_mfma_f32_16x16x32_bf16 v[64:67], v[172:175], v[160:163], v[64:67]
    v_mfma_f32_16x16x32_bf16 v[68:71], v[172:175], v[164:167], v[68:71]
    v_mfma_f32_16x16x32_bf16 v[72:75], v[176:179], v[160:163], v[72:75]
    ds_read_b64_tr_b16 v[168:169], v195 offset:256
    v_mfma_f32_16x16x32_bf16 v[76:79], v[176:179], v[164:167], v[76:79]
    ds_read_b64_tr_b16 v[170:171], v195 offset:2048
    v_mfma_f32_16x16x32_bf16 v[80:83], v[180:183], v[160:163], v[80:83]
    ds_read_b64_tr_b16 v[172:173], v196 offset:256
    v_mfma_f32_16x16x32_bf16 v[84:87], v[180:183], v[164:167], v[84:87]
    ds_read_b64_tr_b16 v[174:175], v196 offset:2048
    s_waitcnt lgkmcnt(6)
    v_mfma_f32_16x16x32_bf16 v[24:27], v[184:187], v[152:155], v[24:27]
    ds_read_b128 v[160:163], v193 offset:0
    v_mfma_f32_16x16x32_bf16 v[28:31], v[184:187], v[156:159], v[28:31]
    ds_read_b128 v[164:167], v193 offset:2048
    ds_read_b64_tr_b16 v[176:177], v195 offset:512
    ds_read_b64_tr_b16 v[178:179], v195 offset:2304
    s_lshl_b32 s65, s44, 5
    v_add_u32 v140, s65, v1
    s_mov_b32 s90, 0xffff0000
    s_waitcnt lgkmcnt(8)
    v_mfma_f32_16x16x32_bf16 v[32:35], v[188:191], v[152:155], v[32:35]
    ds_read_b64_tr_b16 v[180:181], v196 offset:512
    v_mfma_f32_16x16x32_bf16 v[36:39], v[188:191], v[156:159], v[36:39]
    ds_read_b64_tr_b16 v[182:183], v196 offset:2304
    s_mov_b32 s91, 0
    v_cndmask_b32 v208, v208, v212, s[90:91]
    s_mov_b32 s90, -1
    s_waitcnt lgkmcnt(8)
    v_mfma_f32_16x16x32_bf16 v[40:43], v[168:171], v[152:155], v[40:43]
    ds_read_b64_tr_b16 v[184:185], v195 offset:768
    v_mfma_f32_16x16x32_bf16 v[44:47], v[168:171], v[156:159], v[44:47]
    ds_read_b64_tr_b16 v[186:187], v195 offset:2560
    s_lshl_b32 s65, s49, 2
    s_add_u32 s65, s65, 12803584
    s_lshl_b32 s66, s47, 3
    s_waitcnt lgkmcnt(8)
    v_mfma_f32_16x16x32_bf16 v[48:51], v[172:175], v[152:155], v[48:51]
    ds_read_b64_tr_b16 v[188:189], v196 offset:768
    v_mfma_f32_16x16x32_bf16 v[52:55], v[172:175], v[156:159], v[52:55]
    ds_read_b64_tr_b16 v[190:191], v196 offset:2560
    s_add_u32 s66, s66, s44
    s_sub_u32 s66, s66, 56
    s_cmp_lt_u32 s66, 2
    s_cselect_b32 s65, 2130706432, s65
    s_waitcnt lgkmcnt(6)
    v_mfma_f32_16x16x32_bf16 v[56:59], v[176:179], v[152:155], v[56:59]
    ds_read_b64_tr_b16 v[168:169], v195 offset:14336
    v_mfma_f32_16x16x32_bf16 v[60:63], v[176:179], v[156:159], v[60:63]
    ds_read_b64_tr_b16 v[170:171], v195 offset:16128
    s_cmp_eq_u32 s44, 7
    s_cselect_b32 s65, 2130706432, s65
    s_cmp_ge_u32 s46, 10
    s_cselect_b32 s65, 2130706432, s65
    v_lshlrev_b32 v140, 2, v140
    s_waitcnt lgkmcnt(6)
    v_mfma_f32_16x16x32_bf16 v[64:67], v[180:183], v[152:155], v[64:67]
    ds_read_b64_tr_b16 v[172:173], v196 offset:14336
    v_mfma_f32_16x16x32_bf16 v[68:71], v[180:183], v[156:159], v[68:71]
    ds_read_b64_tr_b16 v[174:175], v196 offset:16128
    v_mov_b32 v141, 2130706432
    v_cndmask_b32 v140, v141, v140, s[90:91]
    buffer_atomic_add_f32 v208, v140, s[36:39], s65 offen
    s_waitcnt lgkmcnt(6)
    v_mfma_f32_16x16x32_bf16 v[72:75], v[184:187], v[152:155], v[72:75]
    ds_read_b64_tr_b16 v[176:177], v195 offset:14592
    v_mfma_f32_16x16x32_bf16 v[76:79], v[184:187], v[156:159], v[76:79]
    ds_read_b64_tr_b16 v[178:179], v195 offset:16384
    s_mov_b32 s88, 0xaaaaaaaa
    s_mov_b32 s89, 0xaaaaaaaa
    s_mov_b32 s90, 0xcccccccc
    s_waitcnt lgkmcnt(6)
    v_mfma_f32_16x16x32_bf16 v[80:83], v[188:191], v[152:155], v[80:83]
    ds_read_b64_tr_b16 v[180:181], v196 offset:14592
    v_mfma_f32_16x16x32_bf16 v[84:87], v[188:191], v[156:159], v[84:87]
    ds_read_b64_tr_b16 v[182:183], v196 offset:16384
    s_mov_b32 s91, 0xcccccccc
    v_cndmask_b32 v120, v120, v121, s[88:89]
    v_cndmask_b32 v122, v122, v123, s[88:89]
    s_waitcnt lgkmcnt(6)
    v_mfma_f32_16x16x32_bf16 v[24:27], v[168:171], v[160:163], v[24:27]
    ds_read_b64_tr_b16 v[184:185], v195 offset:14848
    v_mfma_f32_16x16x32_bf16 v[28:31], v[168:171], v[164:167], v[28:31]
    ds_read_b64_tr_b16 v[186:187], v195 offset:16640
    v_cndmask_b32 v120, v120, v122, s[90:91]
    v_cndmask_b32 v124, v124, v125, s[88:89]
    v_cndmask_b32 v126, v126, v127, s[88:89]
    s_waitcnt lgkmcnt(6)
    v_mfma_f32_16x16x32_bf16 v[32:35], v[172:175], v[160:163], v[32:35]
    ds_read_b64_tr_b16 v[188:189], v196 offset:14848
    v_mfma_f32_16x16x32_bf16 v[36:39], v[172:175], v[164:167], v[36:39]
    ds_read_b64_tr_b16 v[190:191], v196 offset:16640
    v_cndmask_b32 v124, v124, v126, s[90:91]
    s_lshl_b32 s65, s46, 2
    s_add_u32 s65, s65, s45
    s_waitcnt lgkmcnt(6)
    v_mfma_f32_16x16x32_bf16 v[40:43], v[176:179], v[160:163], v[40:43]
    ds_read_b64_tr_b16 v[168:169], v195 offset:15104
    v_mfma_f32_16x16x32_bf16 v[44:47], v[176:179], v[164:167], v[44:47]
    ds_read_b64_tr_b16 v[170:171], v195 offset:16896
    s_lshl_b32 s65, s65, 7
    s_add_u32 s65, s65, 12850176
    s_lshl_b32 s66, s47, 1
    s_waitcnt lgkmcnt(6)
    v_mfma_f32_16x16x32_bf16 v[48:51], v[180:183], v[160:163], v[48:51]
    ds_read_b64_tr_b16 v[172:173], v196 offset:15104
    v_mfma_f32_16x16x32_bf16 v[52:55], v[180:183], v[164:167], v[52:55]
    ds_read_b64_tr_b16 v[174:175], v196 offset:16896
    v_add_u32 v192, 98304, v194
    v_add_u32 v195, 98304, v197
    v_xor_b32 v193, 64, v192
    v_xor_b32 v196, 32, v195
    s_add_u32 s66, s66, s48
    s_cmp_ge_u32 s66, 10
    s_cselect_b32 s65, 2130706432, s65
    v_permlane32_swap_b32 v128, v120
    s_waitcnt lgkmcnt(6)
    v_mfma_f32_16x16x32_bf16 v[56:59], v[184:187], v[160:163], v[56:59]
    v_mfma_f32_16x16x32_bf16 v[60:63], v[184:187], v[164:167], v[60:63]
    v_permlane32_swap_b32 v132, v124
    v_and_b32 v144, 31, v1
    v_lshrrev_b32 v145, 5, v1
    v_add_f32 v128, v128, v120
    v_add_f32 v132, v132, v124
    v_lshlrev_b32 v145, 13, v145
    v_lshl_add_u32 v144, v144, 2, v145
    v_permlane16_swap_b32 v128, v132
    v_add_f32 v128, v128, v132
    buffer_atomic_add_f32 v128, v144, s[36:39], s65 offen
    s_waitcnt lgkmcnt(0)
    s_barrier
    ds_read_b128 v[152:155], v192 offset:0
    ds_read_b128 v[156:159], v192 offset:2048
    ds_read_b64_tr_b16 v[176:177], v195 offset:0
    ds_read_b64_tr_b16 v[178:179], v195 offset:1792
    ds_read_b64_tr_b16 v[180:181], v196 offset:0
    ds_read_b64_tr_b16 v[182:183], v196 offset:1792
    v_mfma_f32_16x16x32_bf16 v[64:67], v[188:191], v[160:163], v[64:67]
    v_mfma_f32_16x16x32_bf16 v[68:71], v[188:191], v[164:167], v[68:71]
    v_mfma_f32_16x16x32_bf16 v[72:75], v[168:171], v[160:163], v[72:75]
    ds_read_b64_tr_b16 v[184:185], v195 offset:256
    v_mfma_f32_16x16x32_bf16 v[76:79], v[168:171], v[164:167], v[76:79]
    ds_read_b64_tr_b16 v[186:187], v195 offset:2048
    v_mfma_f32_16x16x32_bf16 v[80:83], v[172:175], v[160:163], v[80:83]
    ds_read_b64_tr_b16 v[188:189], v196 offset:256
    v_mfma_f32_16x16x32_bf16 v[84:87], v[172:175], v[164:167], v[84:87]
    ds_read_b64_tr_b16 v[190:191], v196 offset:2048
    s_waitcnt lgkmcnt(6)
    v_mfma_f32_16x16x32_bf16 v[24:27], v[176:179], v[152:155], v[24:27]
    ds_read_b128 v[160:163], v193 offset:0
    v_mfma_f32_16x16x32_bf16 v[28:31], v[176:179], v[156:159], v[28:31]
    ds_read_b128 v[164:167], v193 offset:2048
    ds_read_b64_tr_b16 v[168:169], v195 offset:512
    ds_read_b64_tr_b16 v[170:171], v195 offset:2304
    s_waitcnt lgkmcnt(8)
    v_mfma_f32_16x16x32_bf16 v[32:35], v[180:183], v[152:155], v[32:35]
    ds_read_b64_tr_b16 v[172:173], v196 offset:512
    v_mfma_f32_16x16x32_bf16 v[36:39], v[180:183], v[156:159], v[36:39]
    ds_read_b64_tr_b16 v[174:175], v196 offset:2304
    s_waitcnt lgkmcnt(8)
    v_mfma_f32_16x16x32_bf16 v[40:43], v[184:187], v[152:155], v[40:43]
    ds_read_b64_tr_b16 v[176:177], v195 offset:768
    v_mfma_f32_16x16x32_bf16 v[44:47], v[184:187], v[156:159], v[44:47]
    ds_read_b64_tr_b16 v[178:179], v195 offset:2560
    s_waitcnt lgkmcnt(8)
    v_mfma_f32_16x16x32_bf16 v[48:51], v[188:191], v[152:155], v[48:51]
    ds_read_b64_tr_b16 v[180:181], v196 offset:768
    v_mfma_f32_16x16x32_bf16 v[52:55], v[188:191], v[156:159], v[52:55]
    ds_read_b64_tr_b16 v[182:183], v196 offset:2560
    s_waitcnt lgkmcnt(6)
    v_mfma_f32_16x16x32_bf16 v[56:59], v[168:171], v[152:155], v[56:59]
    ds_read_b64_tr_b16 v[184:185], v195 offset:14336
    v_mfma_f32_16x16x32_bf16 v[60:63], v[168:171], v[156:159], v[60:63]
    ds_read_b64_tr_b16 v[186:187], v195 offset:16128
    s_waitcnt lgkmcnt(6)
    v_mfma_f32_16x16x32_bf16 v[64:67], v[172:175], v[152:155], v[64:67]
    ds_read_b64_tr_b16 v[188:189], v196 offset:14336
    v_mfma_f32_16x16x32_bf16 v[68:71], v[172:175], v[156:159], v[68:71]
    ds_read_b64_tr_b16 v[190:191], v196 offset:16128
    s_waitcnt lgkmcnt(6)
    v_mfma_f32_16x16x32_bf16 v[72:75], v[176:179], v[152:155], v[72:75]
    ds_read_b64_tr_b16 v[168:169], v195 offset:14592
    v_mfma_f32_16x16x32_bf16 v[76:79], v[176:179], v[156:159], v[76:79]
    ds_read_b64_tr_b16 v[170:171], v195 offset:16384
    s_waitcnt lgkmcnt(6)
    v_mfma_f32_16x16x32_bf16 v[80:83], v[180:183], v[152:155], v[80:83]
    ds_read_b64_tr_b16 v[172:173], v196 offset:14592
    v_mfma_f32_16x16x32_bf16 v[84:87], v[180:183], v[156:159], v[84:87]
    ds_read_b64_tr_b16 v[174:175], v196 offset:16384
    s_waitcnt lgkmcnt(6)
    v_mfma_f32_16x16x32_bf16 v[24:27], v[184:187], v[160:163], v[24:27]
    ds_read_b64_tr_b16 v[176:177], v195 offset:14848
    v_mfma_f32_16x16x32_bf16 v[28:31], v[184:187], v[164:167], v[28:31]
    ds_read_b64_tr_b16 v[178:179], v195 offset:16640
    s_waitcnt lgkmcnt(6)
    v_mfma_f32_16x16x32_bf16 v[32:35], v[188:191], v[160:163], v[32:35]
    ds_read_b64_tr_b16 v[180:181], v196 offset:14848
    v_mfma_f32_16x16x32_bf16 v[36:39], v[188:191], v[164:167], v[36:39]
    ds_read_b64_tr_b16 v[182:183], v196 offset:16640
    s_waitcnt lgkmcnt(6)
    v_mfma_f32_16x16x32_bf16 v[40:43], v[168:171], v[160:163], v[40:43]
    ds_read_b64_tr_b16 v[184:185], v195 offset:15104
    v_mfma_f32_16x16x32_bf16 v[44:47], v[168:171], v[164:167], v[44:47]
    ds_read_b64_tr_b16 v[186:187], v195 offset:16896
    s_waitcnt lgkmcnt(6)
    v_mfma_f32_16x16x32_bf16 v[48:51], v[172:175], v[160:163], v[48:51]
    ds_read_b64_tr_b16 v[188:189], v196 offset:15104
    v_mfma_f32_16x16x32_bf16 v[52:55], v[172:175], v[164:167], v[52:55]
    ds_read_b64_tr_b16 v[190:191], v196 offset:16896
    v_add_u32 v192, 0, v194
    v_add_u32 v195, 0, v197
    v_xor_b32 v193, 64, v192
    v_xor_b32 v196, 32, v195
    s_waitcnt lgkmcnt(6)
    v_mfma_f32_16x16x32_bf16 v[56:59], v[176:179], v[160:163], v[56:59]
    v_mfma_f32_16x16x32_bf16 v[60:63], v[176:179], v[164:167], v[60:63]
    s_waitcnt vmcnt(0)
    s_waitcnt lgkmcnt(0)
    s_barrier
    ds_read_b128 v[152:155], v192 offset:0
    ds_read_b128 v[156:159], v192 offset:2048
    ds_read_b64_tr_b16 v[168:169], v195 offset:0
    ds_read_b64_tr_b16 v[170:171], v195 offset:1792
    ds_read_b64_tr_b16 v[172:173], v196 offset:0
    ds_read_b64_tr_b16 v[174:175], v196 offset:1792
    v_mfma_f32_16x16x32_bf16 v[64:67], v[180:183], v[160:163], v[64:67]
    v_mfma_f32_16x16x32_bf16 v[68:71], v[180:183], v[164:167], v[68:71]
    v_mfma_f32_16x16x32_bf16 v[72:75], v[184:187], v[160:163], v[72:75]
    ds_read_b64_tr_b16 v[176:177], v195 offset:256
    v_mfma_f32_16x16x32_bf16 v[76:79], v[184:187], v[164:167], v[76:79]
    ds_read_b64_tr_b16 v[178:179], v195 offset:2048
    v_mfma_f32_16x16x32_bf16 v[80:83], v[188:191], v[160:163], v[80:83]
    ds_read_b64_tr_b16 v[180:181], v196 offset:256
    v_mfma_f32_16x16x32_bf16 v[84:87], v[188:191], v[164:167], v[84:87]
    ds_read_b64_tr_b16 v[182:183], v196 offset:2048
    s_waitcnt lgkmcnt(6)
    v_mfma_f32_16x16x32_bf16 v[24:27], v[168:171], v[152:155], v[24:27]
    ds_read_b128 v[160:163], v193 offset:0
    v_mfma_f32_16x16x32_bf16 v[28:31], v[168:171], v[156:159], v[28:31]
    ds_read_b128 v[164:167], v193 offset:2048
    ds_read_b64_tr_b16 v[184:185], v195 offset:512
    ds_read_b64_tr_b16 v[186:187], v195 offset:2304
    s_and_b32 s65, s2, 31
    s_add_u32 s65, s65, 264
    s_lshl_b32 s65, s65, 7
    s_waitcnt lgkmcnt(8)
    v_mfma_f32_16x16x32_bf16 v[32:35], v[172:175], v[152:155], v[32:35]
    ds_read_b64_tr_b16 v[188:189], v196 offset:512
    v_mfma_f32_16x16x32_bf16 v[36:39], v[172:175], v[156:159], v[36:39]
    ds_read_b64_tr_b16 v[190:191], v196 offset:2304
    v_mov_b32 v216, s65
    v_mov_b32 v217, 1
    s_cmp_eq_u32 s44, 0
    s_cselect_b32 exec_lo, 1, 0
    s_mov_b32 exec_hi, 0
    global_atomic_add v216, v217, s[10:11]
    s_mov_b64 exec, -1
    s_waitcnt lgkmcnt(8)
    v_mfma_f32_16x16x32_bf16 v[40:43], v[176:179], v[152:155], v[40:43]
    ds_read_b64_tr_b16 v[168:169], v195 offset:768
    v_mfma_f32_16x16x32_bf16 v[44:47], v[176:179], v[156:159], v[44:47]
    ds_read_b64_tr_b16 v[170:171], v195 offset:2560
    s_waitcnt lgkmcnt(8)
    v_mfma_f32_16x16x32_bf16 v[48:51], v[180:183], v[152:155], v[48:51]
    ds_read_b64_tr_b16 v[172:173], v196 offset:768
    v_mfma_f32_16x16x32_bf16 v[52:55], v[180:183], v[156:159], v[52:55]
    ds_read_b64_tr_b16 v[174:175], v196 offset:2560
    s_waitcnt lgkmcnt(6)
    v_mfma_f32_16x16x32_bf16 v[56:59], v[184:187], v[152:155], v[56:59]
    ds_read_b64_tr_b16 v[176:177], v195 offset:14336
    v_mfma_f32_16x16x32_bf16 v[60:63], v[184:187], v[156:159], v[60:63]
    ds_read_b64_tr_b16 v[178:179], v195 offset:16128
    s_waitcnt lgkmcnt(6)
    v_mfma_f32_16x16x32_bf16 v[64:67], v[188:191], v[152:155], v[64:67]
    ds_read_b64_tr_b16 v[180:181], v196 offset:14336
    v_mfma_f32_16x16x32_bf16 v[68:71], v[188:191], v[156:159], v[68:71]
    ds_read_b64_tr_b16 v[182:183], v196 offset:16128
    s_waitcnt lgkmcnt(6)
    v_mfma_f32_16x16x32_bf16 v[72:75], v[168:171], v[152:155], v[72:75]
    ds_read_b64_tr_b16 v[184:185], v195 offset:14592
    v_mfma_f32_16x16x32_bf16 v[76:79], v[168:171], v[156:159], v[76:79]
    ds_read_b64_tr_b16 v[186:187], v195 offset:16384
    s_waitcnt lgkmcnt(6)
    v_mfma_f32_16x16x32_bf16 v[80:83], v[172:175], v[152:155], v[80:83]
    ds_read_b64_tr_b16 v[188:189], v196 offset:14592
    v_mfma_f32_16x16x32_bf16 v[84:87], v[172:175], v[156:159], v[84:87]
    ds_read_b64_tr_b16 v[190:191], v196 offset:16384
    s_waitcnt lgkmcnt(6)
    v_mfma_f32_16x16x32_bf16 v[24:27], v[176:179], v[160:163], v[24:27]
    ds_read_b64_tr_b16 v[168:169], v195 offset:14848
    v_mfma_f32_16x16x32_bf16 v[28:31], v[176:179], v[164:167], v[28:31]
    ds_read_b64_tr_b16 v[170:171], v195 offset:16640
    s_waitcnt lgkmcnt(6)
    v_mfma_f32_16x16x32_bf16 v[32:35], v[180:183], v[160:163], v[32:35]
    ds_read_b64_tr_b16 v[172:173], v196 offset:14848
    v_mfma_f32_16x16x32_bf16 v[36:39], v[180:183], v[164:167], v[36:39]
    ds_read_b64_tr_b16 v[174:175], v196 offset:16640
    s_waitcnt lgkmcnt(6)
    v_mfma_f32_16x16x32_bf16 v[40:43], v[184:187], v[160:163], v[40:43]
    ds_read_b64_tr_b16 v[176:177], v195 offset:15104
    v_mfma_f32_16x16x32_bf16 v[44:47], v[184:187], v[164:167], v[44:47]
    ds_read_b64_tr_b16 v[178:179], v195 offset:16896
    s_waitcnt lgkmcnt(6)
    v_mfma_f32_16x16x32_bf16 v[48:51], v[188:191], v[160:163], v[48:51]
    ds_read_b64_tr_b16 v[180:181], v196 offset:15104
    v_mfma_f32_16x16x32_bf16 v[52:55], v[188:191], v[164:167], v[52:55]
    ds_read_b64_tr_b16 v[182:183], v196 offset:16896
    v_add_u32 v192, 49152, v194
    v_add_u32 v195, 49152, v197
    v_xor_b32 v193, 64, v192
    v_xor_b32 v196, 32, v195
    s_waitcnt lgkmcnt(6)
    v_mfma_f32_16x16x32_bf16 v[56:59], v[168:171], v[160:163], v[56:59]
    v_mfma_f32_16x16x32_bf16 v[60:63], v[168:171], v[164:167], v[60:63]
    s_waitcnt lgkmcnt(0)
    s_barrier
    ds_read_b128 v[152:155], v192 offset:0
    ds_read_b128 v[156:159], v192 offset:2048
    ds_read_b64_tr_b16 v[184:185], v195 offset:0
    ds_read_b64_tr_b16 v[186:187], v195 offset:1792
    ds_read_b64_tr_b16 v[188:189], v196 offset:0
    ds_read_b64_tr_b16 v[190:191], v196 offset:1792
    v_mfma_f32_16x16x32_bf16 v[64:67], v[172:175], v[160:163], v[64:67]
    v_mfma_f32_16x16x32_bf16 v[68:71], v[172:175], v[164:167], v[68:71]
    v_mfma_f32_16x16x32_bf16 v[72:75], v[176:179], v[160:163], v[72:75]
    ds_read_b64_tr_b16 v[168:169], v195 offset:256
    v_mfma_f32_16x16x32_bf16 v[76:79], v[176:179], v[164:167], v[76:79]
    ds_read_b64_tr_b16 v[170:171], v195 offset:2048
    v_mfma_f32_16x16x32_bf16 v[80:83], v[180:183], v[160:163], v[80:83]
    ds_read_b64_tr_b16 v[172:173], v196 offset:256
    v_mfma_f32_16x16x32_bf16 v[84:87], v[180:183], v[164:167], v[84:87]
    ds_read_b64_tr_b16 v[174:175], v196 offset:2048
    s_waitcnt lgkmcnt(6)
    v_mfma_f32_16x16x32_bf16 v[24:27], v[184:187], v[152:155], v[24:27]
    ds_read_b128 v[160:163], v193 offset:0
    v_mfma_f32_16x16x32_bf16 v[28:31], v[184:187], v[156:159], v[28:31]
    ds_read_b128 v[164:167], v193 offset:2048
    ds_read_b64_tr_b16 v[176:177], v195 offset:512
    ds_read_b64_tr_b16 v[178:179], v195 offset:2304
    s_waitcnt lgkmcnt(8)
    v_mfma_f32_16x16x32_bf16 v[32:35], v[188:191], v[152:155], v[32:35]
    ds_read_b64_tr_b16 v[180:181], v196 offset:512
    v_mfma_f32_16x16x32_bf16 v[36:39], v[188:191], v[156:159], v[36:39]
    ds_read_b64_tr_b16 v[182:183], v196 offset:2304
    s_waitcnt lgkmcnt(8)
    v_mfma_f32_16x16x32_bf16 v[40:43], v[168:171], v[152:155], v[40:43]
    ds_read_b64_tr_b16 v[184:185], v195 offset:768
    v_mfma_f32_16x16x32_bf16 v[44:47], v[168:171], v[156:159], v[44:47]
    ds_read_b64_tr_b16 v[186:187], v195 offset:2560
    s_waitcnt lgkmcnt(8)
    v_mfma_f32_16x16x32_bf16 v[48:51], v[172:175], v[152:155], v[48:51]
    ds_read_b64_tr_b16 v[188:189], v196 offset:768
    v_mfma_f32_16x16x32_bf16 v[52:55], v[172:175], v[156:159], v[52:55]
    ds_read_b64_tr_b16 v[190:191], v196 offset:2560
    s_waitcnt lgkmcnt(6)
    v_mfma_f32_16x16x32_bf16 v[56:59], v[176:179], v[152:155], v[56:59]
    ds_read_b64_tr_b16 v[168:169], v195 offset:14336
    v_mfma_f32_16x16x32_bf16 v[60:63], v[176:179], v[156:159], v[60:63]
    ds_read_b64_tr_b16 v[170:171], v195 offset:16128
    s_waitcnt lgkmcnt(6)
    v_mfma_f32_16x16x32_bf16 v[64:67], v[180:183], v[152:155], v[64:67]
    ds_read_b64_tr_b16 v[172:173], v196 offset:14336
    v_mfma_f32_16x16x32_bf16 v[68:71], v[180:183], v[156:159], v[68:71]
    ds_read_b64_tr_b16 v[174:175], v196 offset:16128
    s_waitcnt lgkmcnt(6)
    v_mfma_f32_16x16x32_bf16 v[72:75], v[184:187], v[152:155], v[72:75]
    ds_read_b64_tr_b16 v[176:177], v195 offset:14592
    v_mfma_f32_16x16x32_bf16 v[76:79], v[184:187], v[156:159], v[76:79]
    ds_read_b64_tr_b16 v[178:179], v195 offset:16384
    s_waitcnt lgkmcnt(6)
    v_mfma_f32_16x16x32_bf16 v[80:83], v[188:191], v[152:155], v[80:83]
    ds_read_b64_tr_b16 v[180:181], v196 offset:14592
    v_mfma_f32_16x16x32_bf16 v[84:87], v[188:191], v[156:159], v[84:87]
    ds_read_b64_tr_b16 v[182:183], v196 offset:16384
    s_waitcnt lgkmcnt(6)
    v_mfma_f32_16x16x32_bf16 v[24:27], v[168:171], v[160:163], v[24:27]
    ds_read_b64_tr_b16 v[184:185], v195 offset:14848
    v_mfma_f32_16x16x32_bf16 v[28:31], v[168:171], v[164:167], v[28:31]
    ds_read_b64_tr_b16 v[186:187], v195 offset:16640
    s_waitcnt lgkmcnt(6)
    v_mfma_f32_16x16x32_bf16 v[32:35], v[172:175], v[160:163], v[32:35]
    ds_read_b64_tr_b16 v[188:189], v196 offset:14848
    v_mfma_f32_16x16x32_bf16 v[36:39], v[172:175], v[164:167], v[36:39]
    ds_read_b64_tr_b16 v[190:191], v196 offset:16640
    s_waitcnt lgkmcnt(6)
    v_mfma_f32_16x16x32_bf16 v[40:43], v[176:179], v[160:163], v[40:43]
    ds_read_b64_tr_b16 v[168:169], v195 offset:15104
    v_mfma_f32_16x16x32_bf16 v[44:47], v[176:179], v[164:167], v[44:47]
    ds_read_b64_tr_b16 v[170:171], v195 offset:16896
    s_waitcnt lgkmcnt(6)
    v_mfma_f32_16x16x32_bf16 v[48:51], v[180:183], v[160:163], v[48:51]
    ds_read_b64_tr_b16 v[172:173], v196 offset:15104
    v_mfma_f32_16x16x32_bf16 v[52:55], v[180:183], v[164:167], v[52:55]
    ds_read_b64_tr_b16 v[174:175], v196 offset:16896
    v_add_u32 v192, 98304, v194
    v_add_u32 v195, 98304, v197
    v_xor_b32 v193, 64, v192
    v_xor_b32 v196, 32, v195
    s_waitcnt lgkmcnt(6)
    v_mfma_f32_16x16x32_bf16 v[56:59], v[184:187], v[160:163], v[56:59]
    v_mfma_f32_16x16x32_bf16 v[60:63], v[184:187], v[164:167], v[60:63]
    s_waitcnt lgkmcnt(0)
    s_barrier
    ds_read_b128 v[152:155], v192 offset:0
    ds_read_b128 v[156:159], v192 offset:2048
    ds_read_b64_tr_b16 v[176:177], v195 offset:0
    ds_read_b64_tr_b16 v[178:179], v195 offset:1792
    ds_read_b64_tr_b16 v[180:181], v196 offset:0
    ds_read_b64_tr_b16 v[182:183], v196 offset:1792
    v_mfma_f32_16x16x32_bf16 v[64:67], v[188:191], v[160:163], v[64:67]
    v_mfma_f32_16x16x32_bf16 v[68:71], v[188:191], v[164:167], v[68:71]
    v_mfma_f32_16x16x32_bf16 v[72:75], v[168:171], v[160:163], v[72:75]
    ds_read_b64_tr_b16 v[184:185], v195 offset:256
    v_mfma_f32_16x16x32_bf16 v[76:79], v[168:171], v[164:167], v[76:79]
    ds_read_b64_tr_b16 v[186:187], v195 offset:2048
    v_mfma_f32_16x16x32_bf16 v[80:83], v[172:175], v[160:163], v[80:83]
    ds_read_b64_tr_b16 v[188:189], v196 offset:256
    v_mfma_f32_16x16x32_bf16 v[84:87], v[172:175], v[164:167], v[84:87]
    ds_read_b64_tr_b16 v[190:191], v196 offset:2048
    s_waitcnt lgkmcnt(6)
    v_mfma_f32_16x16x32_bf16 v[24:27], v[176:179], v[152:155], v[24:27]
    ds_read_b128 v[160:163], v193 offset:0
    v_mfma_f32_16x16x32_bf16 v[28:31], v[176:179], v[156:159], v[28:31]
    ds_read_b128 v[164:167], v193 offset:2048
    ds_read_b64_tr_b16 v[168:169], v195 offset:512
    ds_read_b64_tr_b16 v[170:171], v195 offset:2304
    s_waitcnt lgkmcnt(8)
    v_mfma_f32_16x16x32_bf16 v[32:35], v[180:183], v[152:155], v[32:35]
    ds_read_b64_tr_b16 v[172:173], v196 offset:512
    v_mfma_f32_16x16x32_bf16 v[36:39], v[180:183], v[156:159], v[36:39]
    ds_read_b64_tr_b16 v[174:175], v196 offset:2304
    s_waitcnt lgkmcnt(8)
    v_mfma_f32_16x16x32_bf16 v[40:43], v[184:187], v[152:155], v[40:43]
    ds_read_b64_tr_b16 v[176:177], v195 offset:768
    v_mfma_f32_16x16x32_bf16 v[44:47], v[184:187], v[156:159], v[44:47]
    ds_read_b64_tr_b16 v[178:179], v195 offset:2560
    s_waitcnt lgkmcnt(8)
    v_mfma_f32_16x16x32_bf16 v[48:51], v[188:191], v[152:155], v[48:51]
    ds_read_b64_tr_b16 v[180:181], v196 offset:768
    v_mfma_f32_16x16x32_bf16 v[52:55], v[188:191], v[156:159], v[52:55]
    ds_read_b64_tr_b16 v[182:183], v196 offset:2560
    s_waitcnt lgkmcnt(6)
    v_mfma_f32_16x16x32_bf16 v[56:59], v[168:171], v[152:155], v[56:59]
    ds_read_b64_tr_b16 v[184:185], v195 offset:14336
    v_mfma_f32_16x16x32_bf16 v[60:63], v[168:171], v[156:159], v[60:63]
    ds_read_b64_tr_b16 v[186:187], v195 offset:16128
    s_waitcnt lgkmcnt(6)
    v_mfma_f32_16x16x32_bf16 v[64:67], v[172:175], v[152:155], v[64:67]
    ds_read_b64_tr_b16 v[188:189], v196 offset:14336
    v_mfma_f32_16x16x32_bf16 v[68:71], v[172:175], v[156:159], v[68:71]
    ds_read_b64_tr_b16 v[190:191], v196 offset:16128
    s_waitcnt lgkmcnt(6)
    v_mfma_f32_16x16x32_bf16 v[72:75], v[176:179], v[152:155], v[72:75]
    ds_read_b64_tr_b16 v[168:169], v195 offset:14592
    v_mfma_f32_16x16x32_bf16 v[76:79], v[176:179], v[156:159], v[76:79]
    ds_read_b64_tr_b16 v[170:171], v195 offset:16384
    s_waitcnt lgkmcnt(6)
    v_mfma_f32_16x16x32_bf16 v[80:83], v[180:183], v[152:155], v[80:83]
    ds_read_b64_tr_b16 v[172:173], v196 offset:14592
    v_mfma_f32_16x16x32_bf16 v[84:87], v[180:183], v[156:159], v[84:87]
    ds_read_b64_tr_b16 v[174:175], v196 offset:16384
    s_waitcnt lgkmcnt(6)
    v_mfma_f32_16x16x32_bf16 v[24:27], v[184:187], v[160:163], v[24:27]
    ds_read_b64_tr_b16 v[176:177], v195 offset:14848
    v_mfma_f32_16x16x32_bf16 v[28:31], v[184:187], v[164:167], v[28:31]
    ds_read_b64_tr_b16 v[178:179], v195 offset:16640
    s_waitcnt lgkmcnt(6)
    v_mfma_f32_16x16x32_bf16 v[32:35], v[188:191], v[160:163], v[32:35]
    ds_read_b64_tr_b16 v[180:181], v196 offset:14848
    v_mfma_f32_16x16x32_bf16 v[36:39], v[188:191], v[164:167], v[36:39]
    ds_read_b64_tr_b16 v[182:183], v196 offset:16640
    s_waitcnt lgkmcnt(6)
    v_mfma_f32_16x16x32_bf16 v[40:43], v[168:171], v[160:163], v[40:43]
    ds_read_b64_tr_b16 v[184:185], v195 offset:15104
    v_mfma_f32_16x16x32_bf16 v[44:47], v[168:171], v[164:167], v[44:47]
    ds_read_b64_tr_b16 v[186:187], v195 offset:16896
    s_waitcnt lgkmcnt(6)
    v_mfma_f32_16x16x32_bf16 v[48:51], v[172:175], v[160:163], v[48:51]
    ds_read_b64_tr_b16 v[188:189], v196 offset:15104
    v_mfma_f32_16x16x32_bf16 v[52:55], v[172:175], v[164:167], v[52:55]
    ds_read_b64_tr_b16 v[190:191], v196 offset:16896
    v_add_u32 v192, 0, v194
    v_add_u32 v195, 0, v197
    v_xor_b32 v193, 64, v192
    v_xor_b32 v196, 32, v195
    s_waitcnt lgkmcnt(6)
    v_mfma_f32_16x16x32_bf16 v[56:59], v[176:179], v[160:163], v[56:59]
    v_mfma_f32_16x16x32_bf16 v[60:63], v[176:179], v[164:167], v[60:63]
    s_waitcnt lgkmcnt(0)
    s_barrier
    ds_read_b128 v[152:155], v192 offset:0
    ds_read_b128 v[156:159], v192 offset:2048
    ds_read_b64_tr_b16 v[168:169], v195 offset:0
    ds_read_b64_tr_b16 v[170:171], v195 offset:1792
    ds_read_b64_tr_b16 v[172:173], v196 offset:0
    ds_read_b64_tr_b16 v[174:175], v196 offset:1792
    v_mfma_f32_16x16x32_bf16 v[64:67], v[180:183], v[160:163], v[64:67]
    v_mfma_f32_16x16x32_bf16 v[68:71], v[180:183], v[164:167], v[68:71]
    v_mfma_f32_16x16x32_bf16 v[72:75], v[184:187], v[160:163], v[72:75]
    ds_read_b64_tr_b16 v[176:177], v195 offset:256
    v_mfma_f32_16x16x32_bf16 v[76:79], v[184:187], v[164:167], v[76:79]
    ds_read_b64_tr_b16 v[178:179], v195 offset:2048
    v_mfma_f32_16x16x32_bf16 v[80:83], v[188:191], v[160:163], v[80:83]
    ds_read_b64_tr_b16 v[180:181], v196 offset:256
    v_mfma_f32_16x16x32_bf16 v[84:87], v[188:191], v[164:167], v[84:87]
    ds_read_b64_tr_b16 v[182:183], v196 offset:2048
    s_waitcnt lgkmcnt(6)
    v_mfma_f32_16x16x32_bf16 v[24:27], v[168:171], v[152:155], v[24:27]
    ds_read_b128 v[160:163], v193 offset:0
    v_mfma_f32_16x16x32_bf16 v[28:31], v[168:171], v[156:159], v[28:31]
    ds_read_b128 v[164:167], v193 offset:2048
    ds_read_b64_tr_b16 v[184:185], v195 offset:512
    ds_read_b64_tr_b16 v[186:187], v195 offset:2304
    s_waitcnt lgkmcnt(8)
    v_mfma_f32_16x16x32_bf16 v[32:35], v[172:175], v[152:155], v[32:35]
    ds_read_b64_tr_b16 v[188:189], v196 offset:512
    v_mfma_f32_16x16x32_bf16 v[36:39], v[172:175], v[156:159], v[36:39]
    ds_read_b64_tr_b16 v[190:191], v196 offset:2304
    s_waitcnt lgkmcnt(8)
    v_mfma_f32_16x16x32_bf16 v[40:43], v[176:179], v[152:155], v[40:43]
    ds_read_b64_tr_b16 v[168:169], v195 offset:768
    v_mfma_f32_16x16x32_bf16 v[44:47], v[176:179], v[156:159], v[44:47]
    ds_read_b64_tr_b16 v[170:171], v195 offset:2560
    s_waitcnt lgkmcnt(8)
    v_mfma_f32_16x16x32_bf16 v[48:51], v[180:183], v[152:155], v[48:51]
    ds_read_b64_tr_b16 v[172:173], v196 offset:768
    v_mfma_f32_16x16x32_bf16 v[52:55], v[180:183], v[156:159], v[52:55]
    ds_read_b64_tr_b16 v[174:175], v196 offset:2560
    s_waitcnt lgkmcnt(6)
    v_mfma_f32_16x16x32_bf16 v[56:59], v[184:187], v[152:155], v[56:59]
    ds_read_b64_tr_b16 v[176:177], v195 offset:14336
    v_mfma_f32_16x16x32_bf16 v[60:63], v[184:187], v[156:159], v[60:63]
    ds_read_b64_tr_b16 v[178:179], v195 offset:16128
    s_waitcnt lgkmcnt(6)
    v_mfma_f32_16x16x32_bf16 v[64:67], v[188:191], v[152:155], v[64:67]
    ds_read_b64_tr_b16 v[180:181], v196 offset:14336
    v_mfma_f32_16x16x32_bf16 v[68:71], v[188:191], v[156:159], v[68:71]
    ds_read_b64_tr_b16 v[182:183], v196 offset:16128
    s_waitcnt lgkmcnt(6)
    v_mfma_f32_16x16x32_bf16 v[72:75], v[168:171], v[152:155], v[72:75]
    ds_read_b64_tr_b16 v[184:185], v195 offset:14592
    v_mfma_f32_16x16x32_bf16 v[76:79], v[168:171], v[156:159], v[76:79]
    ds_read_b64_tr_b16 v[186:187], v195 offset:16384
    s_waitcnt lgkmcnt(6)
    v_mfma_f32_16x16x32_bf16 v[80:83], v[172:175], v[152:155], v[80:83]
    ds_read_b64_tr_b16 v[188:189], v196 offset:14592
    v_mfma_f32_16x16x32_bf16 v[84:87], v[172:175], v[156:159], v[84:87]
    ds_read_b64_tr_b16 v[190:191], v196 offset:16384
    s_waitcnt lgkmcnt(6)
    v_mfma_f32_16x16x32_bf16 v[24:27], v[176:179], v[160:163], v[24:27]
    ds_read_b64_tr_b16 v[168:169], v195 offset:14848
    v_mfma_f32_16x16x32_bf16 v[28:31], v[176:179], v[164:167], v[28:31]
    ds_read_b64_tr_b16 v[170:171], v195 offset:16640
    v_lshlrev_b32 v216, 7, v1
    v_add_u32 v216, 33792, v216
    v_mov_b32 v217, 8
    s_waitcnt lgkmcnt(6)
    v_mfma_f32_16x16x32_bf16 v[32:35], v[180:183], v[160:163], v[32:35]
    ds_read_b64_tr_b16 v[172:173], v196 offset:14848
    v_mfma_f32_16x16x32_bf16 v[36:39], v[180:183], v[164:167], v[36:39]
    ds_read_b64_tr_b16 v[174:175], v196 offset:16640
    s_cmp_eq_u32 s44, 0
    s_cselect_b32 exec_lo, -1, 0
    s_mov_b32 exec_hi, 0
    global_load_dword v217, v216, s[10:11] sc1
    s_mov_b64 exec, -1
    s_waitcnt lgkmcnt(6)
    v_mfma_f32_16x16x32_bf16 v[40:43], v[184:187], v[160:163], v[40:43]
    ds_read_b64_tr_b16 v[176:177], v195 offset:15104
    v_mfma_f32_16x16x32_bf16 v[44:47], v[184:187], v[164:167], v[44:47]
    ds_read_b64_tr_b16 v[178:179], v195 offset:16896
    s_waitcnt lgkmcnt(6)
    v_mfma_f32_16x16x32_bf16 v[48:51], v[188:191], v[160:163], v[48:51]
    ds_read_b64_tr_b16 v[180:181], v196 offset:15104
    v_mfma_f32_16x16x32_bf16 v[52:55], v[188:191], v[164:167], v[52:55]
    ds_read_b64_tr_b16 v[182:183], v196 offset:16896
    v_add_u32 v192, 49152, v194
    v_add_u32 v195, 49152, v197
    v_xor_b32 v193, 64, v192
    v_xor_b32 v196, 32, v195
    s_waitcnt lgkmcnt(6)
    v_mfma_f32_16x16x32_bf16 v[56:59], v[168:171], v[160:163], v[56:59]
    v_mfma_f32_16x16x32_bf16 v[60:63], v[168:171], v[164:167], v[60:63]
    s_waitcnt lgkmcnt(0)
    s_barrier
    ds_read_b128 v[152:155], v192 offset:0
    ds_read_b128 v[156:159], v192 offset:2048
    ds_read_b64_tr_b16 v[184:185], v195 offset:0
    ds_read_b64_tr_b16 v[186:187], v195 offset:1792
    ds_read_b64_tr_b16 v[188:189], v196 offset:0
    ds_read_b64_tr_b16 v[190:191], v196 offset:1792
    v_mfma_f32_16x16x32_bf16 v[64:67], v[172:175], v[160:163], v[64:67]
    v_mfma_f32_16x16x32_bf16 v[68:71], v[172:175], v[164:167], v[68:71]
    v_mfma_f32_16x16x32_bf16 v[72:75], v[176:179], v[160:163], v[72:75]
    ds_read_b64_tr_b16 v[168:169], v195 offset:256
    v_mfma_f32_16x16x32_bf16 v[76:79], v[176:179], v[164:167], v[76:79]
    ds_read_b64_tr_b16 v[170:171], v195 offset:2048
    v_mfma_f32_16x16x32_bf16 v[80:83], v[180:183], v[160:163], v[80:83]
    ds_read_b64_tr_b16 v[172:173], v196 offset:256
    v_mfma_f32_16x16x32_bf16 v[84:87], v[180:183], v[164:167], v[84:87]
    ds_read_b64_tr_b16 v[174:175], v196 offset:2048
    s_waitcnt lgkmcnt(6)
    v_mfma_f32_16x16x32_bf16 v[24:27], v[184:187], v[152:155], v[24:27]
    ds_read_b128 v[160:163], v193 offset:0
    v_mfma_f32_16x16x32_bf16 v[28:31], v[184:187], v[156:159], v[28:31]
    ds_read_b128 v[164:167], v193 offset:2048
    ds_read_b64_tr_b16 v[176:177], v195 offset:512
    ds_read_b64_tr_b16 v[178:179], v195 offset:2304
    s_waitcnt lgkmcnt(8)
    v_mfma_f32_16x16x32_bf16 v[32:35], v[188:191], v[152:155], v[32:35]
    ds_read_b64_tr_b16 v[180:181], v196 offset:512
    v_mfma_f32_16x16x32_bf16 v[36:39], v[188:191], v[156:159], v[36:39]
    ds_read_b64_tr_b16 v[182:183], v196 offset:2304
    s_waitcnt lgkmcnt(8)
    v_mfma_f32_16x16x32_bf16 v[40:43], v[168:171], v[152:155], v[40:43]
    ds_read_b64_tr_b16 v[184:185], v195 offset:768
    v_mfma_f32_16x16x32_bf16 v[44:47], v[168:171], v[156:159], v[44:47]
    ds_read_b64_tr_b16 v[186:187], v195 offset:2560
    s_waitcnt lgkmcnt(8)
    v_mfma_f32_16x16x32_bf16 v[48:51], v[172:175], v[152:155], v[48:51]
    ds_read_b64_tr_b16 v[188:189], v196 offset:768
    v_mfma_f32_16x16x32_bf16 v[52:55], v[172:175], v[156:159], v[52:55]
    ds_read_b64_tr_b16 v[190:191], v196 offset:2560
    s_waitcnt lgkmcnt(6)
    v_mfma_f32_16x16x32_bf16 v[56:59], v[176:179], v[152:155], v[56:59]
    ds_read_b64_tr_b16 v[168:169], v195 offset:14336
    v_mfma_f32_16x16x32_bf16 v[60:63], v[176:179], v[156:159], v[60:63]
    ds_read_b64_tr_b16 v[170:171], v195 offset:16128
    s_waitcnt lgkmcnt(6)
    v_mfma_f32_16x16x32_bf16 v[64:67], v[180:183], v[152:155], v[64:67]
    ds_read_b64_tr_b16 v[172:173], v196 offset:14336
    v_mfma_f32_16x16x32_bf16 v[68:71], v[180:183], v[156:159], v[68:71]
    ds_read_b64_tr_b16 v[174:175], v196 offset:16128
    s_waitcnt lgkmcnt(6)
    v_mfma_f32_16x16x32_bf16 v[72:75], v[184:187], v[152:155], v[72:75]
    ds_read_b64_tr_b16 v[176:177], v195 offset:14592
    v_mfma_f32_16x16x32_bf16 v[76:79], v[184:187], v[156:159], v[76:79]
    ds_read_b64_tr_b16 v[178:179], v195 offset:16384
    s_waitcnt lgkmcnt(6)
    v_mfma_f32_16x16x32_bf16 v[80:83], v[188:191], v[152:155], v[80:83]
    ds_read_b64_tr_b16 v[180:181], v196 offset:14592
    v_mfma_f32_16x16x32_bf16 v[84:87], v[188:191], v[156:159], v[84:87]
    ds_read_b64_tr_b16 v[182:183], v196 offset:16384
    s_waitcnt lgkmcnt(6)
    v_mfma_f32_16x16x32_bf16 v[24:27], v[168:171], v[160:163], v[24:27]
    ds_read_b64_tr_b16 v[184:185], v195 offset:14848
    v_mfma_f32_16x16x32_bf16 v[28:31], v[168:171], v[164:167], v[28:31]
    ds_read_b64_tr_b16 v[186:187], v195 offset:16640
    s_waitcnt lgkmcnt(6)
    v_mfma_f32_16x16x32_bf16 v[32:35], v[172:175], v[160:163], v[32:35]
    ds_read_b64_tr_b16 v[188:189], v196 offset:14848
    v_mfma_f32_16x16x32_bf16 v[36:39], v[172:175], v[164:167], v[36:39]
    ds_read_b64_tr_b16 v[190:191], v196 offset:16640
    s_waitcnt lgkmcnt(6)
    v_mfma_f32_16x16x32_bf16 v[40:43], v[176:179], v[160:163], v[40:43]
    ds_read_b64_tr_b16 v[168:169], v195 offset:15104
    v_mfma_f32_16x16x32_bf16 v[44:47], v[176:179], v[164:167], v[44:47]
    ds_read_b64_tr_b16 v[170:171], v195 offset:16896
    s_waitcnt lgkmcnt(6)
    v_mfma_f32_16x16x32_bf16 v[48:51], v[180:183], v[160:163], v[48:51]
    ds_read_b64_tr_b16 v[172:173], v196 offset:15104
    v_mfma_f32_16x16x32_bf16 v[52:55], v[180:183], v[164:167], v[52:55]
    ds_read_b64_tr_b16 v[174:175], v196 offset:16896
    v_add_u32 v192, 98304, v194
    v_add_u32 v195, 98304, v197
    v_xor_b32 v193, 64, v192
    v_xor_b32 v196, 32, v195
    s_waitcnt lgkmcnt(6)
    v_mfma_f32_16x16x32_bf16 v[56:59], v[184:187], v[160:163], v[56:59]
    v_mfma_f32_16x16x32_bf16 v[60:63], v[184:187], v[164:167], v[60:63]
    s_waitcnt vmcnt(0)
    v_cmp_gt_u32 vcc, 8, v217
    s_nop 0
    s_cmp_eq_u64 vcc, 0
    s_cbranch_scc0 PL_24
PB_25:
    s_waitcnt lgkmcnt(0)
    s_barrier
    ds_read_b128 v[152:155], v192 offset:0
    ds_read_b128 v[156:159], v192 offset:2048
    ds_read_b64_tr_b16 v[176:177], v195 offset:0
    ds_read_b64_tr_b16 v[178:179], v195 offset:1792
    ds_read_b64_tr_b16 v[180:181], v196 offset:0
    ds_read_b64_tr_b16 v[182:183], v196 offset:1792
    v_mfma_f32_16x16x32_bf16 v[64:67], v[188:191], v[160:163], v[64:67]
    v_mfma_f32_16x16x32_bf16 v[68:71], v[188:191], v[164:167], v[68:71]
    v_mfma_f32_16x16x32_bf16 v[72:75], v[168:171], v[160:163], v[72:75]
    ds_read_b64_tr_b16 v[184:185], v195 offset:256
    v_mfma_f32_16x16x32_bf16 v[76:79], v[168:171], v[164:167], v[76:79]
    ds_read_b64_tr_b16 v[186:187], v195 offset:2048
    v_mfma_f32_16x16x32_bf16 v[80:83], v[172:175], v[160:163], v[80:83]
    ds_read_b64_tr_b16 v[188:189], v196 offset:256
    v_mfma_f32_16x16x32_bf16 v[84:87], v[172:175], v[164:167], v[84:87]
    ds_read_b64_tr_b16 v[190:191], v196 offset:2048
    s_waitcnt lgkmcnt(6)
    v_mfma_f32_16x16x32_bf16 v[24:27], v[176:179], v[152:155], v[24:27]
    ds_read_b128 v[160:163], v193 offset:0
    v_mfma_f32_16x16x32_bf16 v[28:31], v[176:179], v[156:159], v[28:31]
    ds_read_b128 v[164:167], v193 offset:2048
    ds_read_b64_tr_b16 v[168:169], v195 offset:512
    ds_read_b64_tr_b16 v[170:171], v195 offset:2304
    v_and_b32 v142, 31, v1
    s_lshl_b32 s65, s46, 2
    s_add_u32 s65, s65, s45
    s_waitcnt lgkmcnt(8)
    v_mfma_f32_16x16x32_bf16 v[32:35], v[180:183], v[152:155], v[32:35]
    ds_read_b64_tr_b16 v[172:173], v196 offset:512
    v_mfma_f32_16x16x32_bf16 v[36:39], v[180:183], v[156:159], v[36:39]
    ds_read_b64_tr_b16 v[174:175], v196 offset:2304
    s_lshl_b32 s65, s65, 7
    s_add_u32 s65, s65, 12850176
    s_add_u32 s66, s65, 8192
    s_waitcnt lgkmcnt(8)
    v_mfma_f32_16x16x32_bf16 v[40:43], v[184:187], v[152:155], v[40:43]
    ds_read_b64_tr_b16 v[176:177], v195 offset:768
    v_mfma_f32_16x16x32_bf16 v[44:47], v[184:187], v[156:159], v[44:47]
    ds_read_b64_tr_b16 v[178:179], v195 offset:2560
    v_lshlrev_b32 v143, 2, v142
    buffer_load_dword v144, v143, s[36:39], s65 offen sc1
    buffer_load_dword v145, v143, s[36:39], s66 offen sc1
    s_waitcnt lgkmcnt(8)
    v_mfma_f32_16x16x32_bf16 v[48:51], v[188:191], v[152:155], v[48:51]
    ds_read_b64_tr_b16 v[180:181], v196 offset:768
    v_mfma_f32_16x16x32_bf16 v[52:55], v[188:191], v[156:159], v[52:55]
    ds_read_b64_tr_b16 v[182:183], v196 offset:2560
    s_lshl_b32 s65, s45, 6
    v_add_u32 v143, s65, v1
    s_lshl_b32 s65, s49, 2
    s_waitcnt lgkmcnt(6)
    v_mfma_f32_16x16x32_bf16 v[56:59], v[168:171], v[152:155], v[56:59]
    ds_read_b64_tr_b16 v[184:185], v195 offset:14336
    v_mfma_f32_16x16x32_bf16 v[60:63], v[168:171], v[156:159], v[60:63]
    ds_read_b64_tr_b16 v[186:187], v195 offset:16128
    s_add_u32 s65, s65, 12803584
    v_lshlrev_b32 v143, 2, v143
    buffer_load_dword v146, v143, s[36:39], s65 offen sc1
    s_waitcnt lgkmcnt(6)
    v_mfma_f32_16x16x32_bf16 v[64:67], v[172:175], v[152:155], v[64:67]
    ds_read_b64_tr_b16 v[188:189], v196 offset:14336
    v_mfma_f32_16x16x32_bf16 v[68:71], v[172:175], v[156:159], v[68:71]
    ds_read_b64_tr_b16 v[190:191], v196 offset:16128
    s_and_b32 s65, s67, 7
    s_mul_i32 s65, s65, 47360
    s_mul_i32 s66, s45, 12288
    s_waitcnt lgkmcnt(6)
    v_mfma_f32_16x16x32_bf16 v[72:75], v[176:179], v[152:155], v[72:75]
    ds_read_b64_tr_b16 v[168:169], v195 offset:14592
    v_mfma_f32_16x16x32_bf16 v[76:79], v[176:179], v[156:159], v[76:79]
    ds_read_b64_tr_b16 v[170:171], v195 offset:16384
    s_add_u32 s65, s65, s66
    s_add_u32 s65, s65, s78
    v_lshlrev_b32 v217, 7, v1
    s_waitcnt lgkmcnt(6)
    v_mfma_f32_16x16x32_bf16 v[80:83], v[180:183], v[152:155], v[80:83]
    ds_read_b64_tr_b16 v[172:173], v196 offset:14592
    v_mfma_f32_16x16x32_bf16 v[84:87], v[180:183], v[156:159], v[84:87]
    ds_read_b64_tr_b16 v[174:175], v196 offset:16384
    buffer_load_dword v216, v217, s[36:39], s65 offen sc1
    s_add_u32 s65, s65, 8192
    s_mov_b32 exec_hi, 0
    buffer_load_dword v216, v217, s[36:39], s65 offen sc1
    s_mov_b32 exec_hi, -1
    s_add_u32 s65, s65, 8192
    s_waitcnt lgkmcnt(6)
    v_mfma_f32_16x16x32_bf16 v[24:27], v[184:187], v[160:163], v[24:27]
    ds_read_b64_tr_b16 v[176:177], v195 offset:14848
    v_mfma_f32_16x16x32_bf16 v[28:31], v[184:187], v[164:167], v[28:31]
    ds_read_b64_tr_b16 v[178:179], v195 offset:16640
    s_waitcnt lgkmcnt(6)
    v_mfma_f32_16x16x32_bf16 v[32:35], v[188:191], v[160:163], v[32:35]
    ds_read_b64_tr_b16 v[180:181], v196 offset:14848
    v_mfma_f32_16x16x32_bf16 v[36:39], v[188:191], v[164:167], v[36:39]
    ds_read_b64_tr_b16 v[182:183], v196 offset:16640
    s_waitcnt lgkmcnt(6)
    v_mfma_f32_16x16x32_bf16 v[40:43], v[168:171], v[160:163], v[40:43]
    ds_read_b64_tr_b16 v[184:185], v195 offset:15104
    v_mfma_f32_16x16x32_bf16 v[44:47], v[168:171], v[164:167], v[44:47]
    ds_read_b64_tr_b16 v[186:187], v195 offset:16896
    s_waitcnt lgkmcnt(6)
    v_mfma_f32_16x16x32_bf16 v[48:51], v[172:175], v[160:163], v[48:51]
    ds_read_b64_tr_b16 v[188:189], v196 offset:15104
    v_mfma_f32_16x16x32_bf16 v[52:55], v[172:175], v[164:167], v[52:55]
    ds_read_b64_tr_b16 v[190:191], v196 offset:16896
    v_add_u32 v192, 0, v194
    v_add_u32 v195, 0, v197
    v_xor_b32 v193, 64, v192
    v_xor_b32 v196, 32, v195
    s_waitcnt lgkmcnt(6)
    v_mfma_f32_16x16x32_bf16 v[56:59], v[176:179], v[160:163], v[56:59]
    v_mfma_f32_16x16x32_bf16 v[60:63], v[176:179], v[164:167], v[60:63]
    v_and_b32 v147, 31, v1
    s_lshl_b32 s65, s45, 5
    v_add_lshl_u32 v147, v147, s65, 2
    v_add_u32 v147, 147456, v147
    s_lshl_b32 s65, s45, 8
    s_add_u32 s65, s65, 161792
    v_lshl_add_u32 v148, v1, 2, s65
    s_waitcnt vmcnt(2)
    v_mul_f32 v144, 0x3acccccd, v144
    v_mul_f32 v145, 0x3acccccd, v145
    v_fma_f32 v145, -v144, v144, v145
    v_max_f32 v145, 0, v145
    v_cvt_pk_bf16_f32 v142, v145, v145
    v_and_b32 v142, 0xffff0000, v142
    v_add_f32 v142, 0x3727c5ac, v142
    v_cvt_pk_bf16_f32 v142, v142, v142
    v_and_b32 v142, 0xffff0000, v142
    v_sqrt_f32 v143, v142
    s_nop 0
    v_cvt_pk_bf16_f32 v143, v143, v143
    v_and_b32 v143, 0xffff0000, v143
    v_mul_f32 v142, v143, v143
    v_rcp_f32 v142, v142
    s_nop 0
    v_mul_f32 v142, v142, v145
    v_cvt_pk_bf16_f32 v142, v142, v142
    v_and_b32 v142, 0xffff0000, v142
    v_add_f32 v142, 0x3727c5ac, v142
    v_cvt_pk_bf16_f32 v142, v142, v142
    v_and_b32 v142, 0xffff0000, v142
    v_sqrt_f32 v142, v142
    s_nop 0
    v_cvt_pk_bf16_f32 v142, v142, v142
    v_and_b32 v142, 0xffff0000, v142
    v_mul_f32 v143, v143, v142
    v_rcp_f32 v142, v143
    ds_write_b32 v147, v144 offset:12288
    ds_write_b32 v147, v142 offset:12800
    ds_write_b32 v147, v143 offset:13312
    ds_write_b32 v148, v146
    s_waitcnt lgkmcnt(0)
    s_barrier
    ds_read_b128 v[152:155], v192 offset:0
    ds_read_b128 v[156:159], v192 offset:2048
    ds_read_b64_tr_b16 v[168:169], v195 offset:0
    ds_read_b64_tr_b16 v[170:171], v195 offset:1792
    ds_read_b64_tr_b16 v[172:173], v196 offset:0
    ds_read_b64_tr_b16 v[174:175], v196 offset:1792
    v_mfma_f32_16x16x32_bf16 v[64:67], v[180:183], v[160:163], v[64:67]
    v_mfma_f32_16x16x32_bf16 v[68:71], v[180:183], v[164:167], v[68:71]
    v_mfma_f32_16x16x32_bf16 v[72:75], v[184:187], v[160:163], v[72:75]
    ds_read_b64_tr_b16 v[176:177], v195 offset:256
    v_mfma_f32_16x16x32_bf16 v[76:79], v[184:187], v[164:167], v[76:79]
    ds_read_b64_tr_b16 v[178:179], v195 offset:2048
    v_mfma_f32_16x16x32_bf16 v[80:83], v[188:191], v[160:163], v[80:83]
    ds_read_b64_tr_b16 v[180:181], v196 offset:256
    v_mfma_f32_16x16x32_bf16 v[84:87], v[188:191], v[164:167], v[84:87]
    ds_read_b64_tr_b16 v[182:183], v196 offset:2048
    s_waitcnt lgkmcnt(6)
    v_mfma_f32_16x16x32_bf16 v[24:27], v[168:171], v[152:155], v[24:27]
    ds_read_b128 v[160:163], v193 offset:0
    v_mfma_f32_16x16x32_bf16 v[28:31], v[168:171], v[156:159], v[28:31]
    ds_read_b128 v[164:167], v193 offset:2048
    ds_read_b64_tr_b16 v[184:185], v195 offset:512
    ds_read_b64_tr_b16 v[186:187], v195 offset:2304
    v_and_b32 v208, 15, v1
    s_lshl_b32 s65, s45, 5
    v_add_lshl_u32 v209, v208, s65, 2
    s_waitcnt lgkmcnt(8)
    v_mfma_f32_16x16x32_bf16 v[32:35], v[172:175], v[152:155], v[32:35]
    ds_read_b64_tr_b16 v[188:189], v196 offset:512
    v_mfma_f32_16x16x32_bf16 v[36:39], v[172:175], v[156:159], v[36:39]
    ds_read_b64_tr_b16 v[190:191], v196 offset:2304
    v_add_u32 v209, 147456, v209
    s_lshl_b32 s65, s79, 7
    s_add_u32 s65, s65, 161792
    s_waitcnt lgkmcnt(8)
    v_mfma_f32_16x16x32_bf16 v[40:43], v[176:179], v[152:155], v[40:43]
    ds_read_b64_tr_b16 v[168:169], v195 offset:768
    v_mfma_f32_16x16x32_bf16 v[44:47], v[176:179], v[156:159], v[44:47]
    ds_read_b64_tr_b16 v[170:171], v195 offset:2560
    v_lshl_add_u32 v208, v208, 2, s65
    ds_read_b32 v210, v209 offset:12288
    ds_read_b32 v4, v209 offset:12800
    s_waitcnt lgkmcnt(10)
    v_mfma_f32_16x16x32_bf16 v[48:51], v[180:183], v[152:155], v[48:51]
    ds_read_b64_tr_b16 v[172:173], v196 offset:768
    v_mfma_f32_16x16x32_bf16 v[52:55], v[180:183], v[156:159], v[52:55]
    ds_read_b64_tr_b16 v[174:175], v196 offset:2560
    ds_read_b32 v5, v209 offset:13312
    ds_read_b32 v211, v209 offset:12352
    ds_read_b32 v252, v209 offset:12864
    s_waitcnt lgkmcnt(11)
    v_mfma_f32_16x16x32_bf16 v[56:59], v[184:187], v[152:155], v[56:59]
    ds_read_b64_tr_b16 v[176:177], v195 offset:14336
    v_mfma_f32_16x16x32_bf16 v[60:63], v[184:187], v[156:159], v[60:63]
    ds_read_b64_tr_b16 v[178:179], v195 offset:16128
    ds_read_b32 v253, v209 offset:13376
    ds_read_b32 v107, v208 offset:0
    ds_read_b32 v111, v208 offset:64
    s_waitcnt lgkmcnt(14)
    v_mfma_f32_16x16x32_bf16 v[64:67], v[188:191], v[152:155], v[64:67]
    ds_read_b64_tr_b16 v[180:181], v196 offset:14336
    v_mfma_f32_16x16x32_bf16 v[68:71], v[188:191], v[156:159], v[68:71]
    ds_read_b64_tr_b16 v[182:183], v196 offset:16128
    ds_read_b32 v115, v208 offset:128
    ds_read_b32 v119, v208 offset:192
    ds_read_b32 v123, v208 offset:256
    s_waitcnt lgkmcnt(15)
    v_mfma_f32_16x16x32_bf16 v[72:75], v[168:171], v[152:155], v[72:75]
    ds_read_b64_tr_b16 v[184:185], v195 offset:14592
    v_mfma_f32_16x16x32_bf16 v[76:79], v[168:171], v[156:159], v[76:79]
    ds_read_b64_tr_b16 v[186:187], v195 offset:16384
    ds_read_b32 v127, v208 offset:320
    ds_read_b32 v131, v208 offset:384
    s_waitcnt lgkmcnt(0)
    v_mfma_f32_16x16x32_bf16 v[80:83], v[172:175], v[152:155], v[80:83]
    ds_read_b64_tr_b16 v[188:189], v196 offset:14592
    v_mfma_f32_16x16x32_bf16 v[84:87], v[172:175], v[156:159], v[84:87]
    ds_read_b64_tr_b16 v[190:191], v196 offset:16384
    ds_read_b32 v135, v208 offset:448
    s_mov_b32 s88, 0xffff
    s_mov_b32 s89, 0
    v_mfma_f32_16x16x32_bf16 v[24:27], v[176:179], v[160:163], v[24:27]
    ds_read_b64_tr_b16 v[168:169], v195 offset:14848
    v_mfma_f32_16x16x32_bf16 v[28:31], v[176:179], v[164:167], v[28:31]
    ds_read_b64_tr_b16 v[170:171], v195 offset:16640
    s_waitcnt lgkmcnt(2)
    v_sub_f32 v210, 0, v210
    v_cvt_pk_bf16_f32 v212, v210, v5
    v_mfma_f32_16x16x32_bf16 v[32:35], v[180:183], v[160:163], v[32:35]
    ds_read_b64_tr_b16 v[172:173], v196 offset:14848
    v_mfma_f32_16x16x32_bf16 v[36:39], v[180:183], v[164:167], v[36:39]
    ds_read_b64_tr_b16 v[174:175], v196 offset:16640
    v_lshlrev_b32 v213, 16, v212
    v_and_b32 v214, 0xffff0000, v212
    v_sub_f32 v213, v210, v213
    v_mfma_f32_16x16x32_bf16 v[40:43], v[184:187], v[160:163], v[40:43]
    ds_read_b64_tr_b16 v[176:177], v195 offset:15104
    v_mfma_f32_16x16x32_bf16 v[44:47], v[184:187], v[164:167], v[44:47]
    ds_read_b64_tr_b16 v[178:179], v195 offset:16896
    v_sub_f32 v214, v5, v214
    v_cvt_pk_bf16_f32 v213, v210, v213
    v_cvt_pk_bf16_f32 v214, v214, v2
    v_mfma_f32_16x16x32_bf16 v[48:51], v[188:191], v[160:163], v[48:51]
    ds_read_b64_tr_b16 v[180:181], v196 offset:15104
    v_mfma_f32_16x16x32_bf16 v[52:55], v[188:191], v[164:167], v[52:55]
    ds_read_b64_tr_b16 v[182:183], v196 offset:16896
    v_cndmask_b32 v144, 0, v213, s[88:89]
    v_cndmask_b32 v145, 0, v212, s[88:89]
    v_cndmask_b32 v146, 0, v214, s[88:89]
    s_waitcnt lgkmcnt(6)
    v_mfma_f32_16x16x32_bf16 v[56:59], v[168:171], v[160:163], v[56:59]
    v_mfma_f32_16x16x32_bf16 v[60:63], v[168:171], v[164:167], v[60:63]
    v_mov_b32 v147, 0
    v_sub_f32 v211, 0, v211
    v_cvt_pk_bf16_f32 v212, v211, v253
    s_waitcnt lgkmcnt(0)
    s_barrier
    v_mfma_f32_16x16x32_bf16 v[64:67], v[172:175], v[160:163], v[64:67]
    v_mfma_f32_16x16x32_bf16 v[68:71], v[172:175], v[164:167], v[68:71]
    v_lshlrev_b32 v213, 16, v212
    v_and_b32 v214, 0xffff0000, v212
    v_sub_f32 v213, v211, v213
    v_mfma_f32_16x16x32_bf16 v[72:75], v[176:179], v[160:163], v[72:75]
    v_mfma_f32_16x16x32_bf16 v[76:79], v[176:179], v[164:167], v[76:79]
    v_sub_f32 v214, v253, v214
    v_cvt_pk_bf16_f32 v213, v211, v213
    v_cvt_pk_bf16_f32 v214, v214, v2
    v_mfma_f32_16x16x32_bf16 v[80:83], v[180:183], v[160:163], v[80:83]
    v_mfma_f32_16x16x32_bf16 v[84:87], v[180:183], v[164:167], v[84:87]
    v_cndmask_b32 v148, 0, v213, s[88:89]
    v_cndmask_b32 v149, 0, v212, s[88:89]
    v_cndmask_b32 v150, 0, v214, s[88:89]
    v_mov_b32 v151, 0
    v_cvt_pk_bf16_f32 v104, v107, v107
    v_and_b32 v105, 0xffff0000, v104
    v_sub_f32 v105, v107, v105
    v_cvt_pk_bf16_f32 v105, v105, v2
    v_lshl_or_b32 v105, v198, 16, v105
    v_mov_b32 v106, v198
    v_mov_b32 v107, 0
    v_cvt_pk_bf16_f32 v108, v111, v111
    v_and_b32 v109, 0xffff0000, v108
    v_sub_f32 v109, v111, v109
    v_cvt_pk_bf16_f32 v109, v109, v2
    v_lshl_or_b32 v109, v199, 16, v109
    v_mov_b32 v110, v199
    v_mov_b32 v111, 0
    v_cvt_pk_bf16_f32 v112, v115, v115
    v_and_b32 v113, 0xffff0000, v112
    v_sub_f32 v113, v115, v113
    v_cvt_pk_bf16_f32 v113, v113, v2
    v_lshl_or_b32 v113, v200, 16, v113
    v_mov_b32 v114, v200
    v_mov_b32 v115, 0
    v_cvt_pk_bf16_f32 v116, v119, v119
    v_and_b32 v117, 0xffff0000, v116
    v_sub_f32 v117, v119, v117
    v_cvt_pk_bf16_f32 v117, v117, v2
    v_lshl_or_b32 v117, v201, 16, v117
    v_mov_b32 v118, v201
    v_mov_b32 v119, 0
    v_cvt_pk_bf16_f32 v120, v123, v123
    v_and_b32 v121, 0xffff0000, v120
    v_sub_f32 v121, v123, v121
    v_cvt_pk_bf16_f32 v121, v121, v2
    v_lshl_or_b32 v121, v202, 16, v121
    v_mov_b32 v122, v202
    v_mov_b32 v123, 0
    v_cvt_pk_bf16_f32 v124, v127, v127
    v_and_b32 v125, 0xffff0000, v124
    v_sub_f32 v125, v127, v125
    v_cvt_pk_bf16_f32 v125, v125, v2
    v_lshl_or_b32 v125, v203, 16, v125
    v_mov_b32 v126, v203
    v_mov_b32 v127, 0
    v_cvt_pk_bf16_f32 v128, v131, v131
    v_and_b32 v129, 0xffff0000, v128
    v_sub_f32 v129, v131, v129
    v_cvt_pk_bf16_f32 v129, v129, v2
    v_lshl_or_b32 v129, v204, 16, v129
    v_mov_b32 v130, v204
    v_mov_b32 v131, 0
    v_cvt_pk_bf16_f32 v132, v135, v135
    v_and_b32 v133, 0xffff0000, v132
    v_sub_f32 v133, v135, v133
    v_cvt_pk_bf16_f32 v133, v133, v2
    v_lshl_or_b32 v133, v205, 16, v133
    v_mov_b32 v134, v205
    v_mov_b32 v135, 0
    v_mfma_f32_16x16x32_bf16 v[24:27], v[104:107], v[144:147], v[24:27]
    v_mfma_f32_16x16x32_bf16 v[28:31], v[104:107], v[148:151], v[28:31]
    v_mfma_f32_16x16x32_bf16 v[32:35], v[108:111], v[144:147], v[32:35]
    v_mfma_f32_16x16x32_bf16 v[36:39], v[108:111], v[148:151], v[36:39]
    v_mfma_f32_16x16x32_bf16 v[40:43], v[112:115], v[144:147], v[40:43]
    v_mfma_f32_16x16x32_bf16 v[44:47], v[112:115], v[148:151], v[44:47]
    v_mfma_f32_16x16x32_bf16 v[48:51], v[116:119], v[144:147], v[48:51]
    v_mfma_f32_16x16x32_bf16 v[52:55], v[116:119], v[148:151], v[52:55]
    v_mfma_f32_16x16x32_bf16 v[56:59], v[120:123], v[144:147], v[56:59]
    v_mfma_f32_16x16x32_bf16 v[60:63], v[120:123], v[148:151], v[60:63]
    v_mfma_f32_16x16x32_bf16 v[64:67], v[124:127], v[144:147], v[64:67]
    v_mfma_f32_16x16x32_bf16 v[68:71], v[124:127], v[148:151], v[68:71]
    v_mfma_f32_16x16x32_bf16 v[72:75], v[128:131], v[144:147], v[72:75]
    v_mfma_f32_16x16x32_bf16 v[76:79], v[128:131], v[148:151], v[76:79]
    v_mfma_f32_16x16x32_bf16 v[80:83], v[132:135], v[144:147], v[80:83]
    v_mfma_f32_16x16x32_bf16 v[84:87], v[132:135], v[148:151], v[84:87]
    s_waitcnt vmcnt(0)
    s_lshl_b32 s57, s46, 1
    s_lshr_b32 s58, s45, 1
    s_add_u32 s57, s57, s58
    s_mul_i32 s57, s57, 303104
    s_and_b32 s58, s45, 1
    s_lshl_b32 s58, s58, 11
    s_add_u32 s57, s57, s58
    v_add_u32 v122, s57, v6
    v_mul_f32 v104, 0xc0135761, v4
    v_mul_f32 v106, v4, v4
    v_mul_f32 v106, v106, v4
    v_mul_f32 v106, 0xbdd2d3e8, v106
    v_mov_b32 v108, v5
    v_mul_f32 v110, 0xc0135761, v252
    v_mul_f32 v112, v252, v252
    v_mul_f32 v112, v112, v252
    v_mul_f32 v112, 0xbdd2d3e8, v112
    v_mov_b32 v114, v253
    s_lshl_b32 s57, s49, 7
    s_lshl_b32 s58, s79, 12
    s_add_u32 s57, s57, s58
    s_setprio 1
    v_pk_mul_f32 v[124:125], v[24:25], v[24:25]
    v_pk_mul_f32 v[126:127], v[26:27], v[26:27]
    v_pk_mul_f32 v[128:129], v[32:33], v[32:33]
    v_pk_mul_f32 v[130:131], v[34:35], v[34:35]
    v_pk_fma_f32 v[124:125], v[124:125], v[106:107], v[104:105] op_sel_hi:[1,0,0]
    v_pk_fma_f32 v[126:127], v[126:127], v[106:107], v[104:105] op_sel_hi:[1,0,0]
    v_pk_fma_f32 v[128:129], v[128:129], v[106:107], v[104:105] op_sel_hi:[1,0,0]
    v_pk_fma_f32 v[130:131], v[130:131], v[106:107], v[104:105] op_sel_hi:[1,0,0]
    v_pk_mul_f32 v[124:125], v[124:125], v[24:25]
    v_pk_mul_f32 v[126:127], v[126:127], v[26:27]
    v_pk_mul_f32 v[128:129], v[128:129], v[32:33]
    v_pk_mul_f32 v[130:131], v[130:131], v[34:35]
    v_exp_f32 v124, v124
    v_exp_f32 v125, v125
    v_exp_f32 v126, v126
    v_exp_f32 v127, v127
    v_exp_f32 v128, v128
    v_exp_f32 v129, v129
    v_exp_f32 v130, v130
    v_exp_f32 v131, v131
    v_pk_fma_f32 v[124:125], v[124:125], v[108:109], v[108:109] op_sel_hi:[1,0,0]
    v_pk_fma_f32 v[126:127], v[126:127], v[108:109], v[108:109] op_sel_hi:[1,0,0]
    v_pk_fma_f32 v[128:129], v[128:129], v[108:109], v[108:109] op_sel_hi:[1,0,0]
    v_pk_fma_f32 v[130:131], v[130:131], v[108:109], v[108:109] op_sel_hi:[1,0,0]
    v_rcp_f32 v124, v124
    v_rcp_f32 v125, v125
    v_rcp_f32 v126, v126
    v_rcp_f32 v127, v127
    v_rcp_f32 v128, v128
    v_rcp_f32 v129, v129
    v_rcp_f32 v130, v130
    v_rcp_f32 v131, v131
    v_pk_mul_f32 v[124:125], v[124:125], v[24:25]
    v_pk_mul_f32 v[126:127], v[126:127], v[26:27]
    v_pk_mul_f32 v[128:129], v[128:129], v[32:33]
    v_pk_mul_f32 v[130:131], v[130:131], v[34:35]
    v_cvt_pk_bf16_f32 v136, v124, v125
    v_cvt_pk_bf16_f32 v137, v126, v127
    v_cvt_pk_bf16_f32 v138, v128, v129
    v_cvt_pk_bf16_f32 v139, v130, v131
    buffer_store_dwordx4 v[136:139], v122, s[36:39], s57 offen offset:0 sc1
    v_pk_mul_f32 v[124:125], v[28:29], v[28:29]
    v_pk_mul_f32 v[126:127], v[30:31], v[30:31]
    v_pk_mul_f32 v[128:129], v[36:37], v[36:37]
    v_pk_mul_f32 v[130:131], v[38:39], v[38:39]
    v_pk_fma_f32 v[124:125], v[124:125], v[112:113], v[110:111] op_sel_hi:[1,0,0]
    v_pk_fma_f32 v[126:127], v[126:127], v[112:113], v[110:111] op_sel_hi:[1,0,0]
    v_pk_fma_f32 v[128:129], v[128:129], v[112:113], v[110:111] op_sel_hi:[1,0,0]
    v_pk_fma_f32 v[130:131], v[130:131], v[112:113], v[110:111] op_sel_hi:[1,0,0]
    v_pk_mul_f32 v[124:125], v[124:125], v[28:29]
    v_pk_mul_f32 v[126:127], v[126:127], v[30:31]
    v_pk_mul_f32 v[128:129], v[128:129], v[36:37]
    v_pk_mul_f32 v[130:131], v[130:131], v[38:39]
    v_exp_f32 v124, v124
    v_exp_f32 v125, v125
    v_exp_f32 v126, v126
    v_exp_f32 v127, v127
    v_exp_f32 v128, v128
    v_exp_f32 v129, v129
    v_exp_f32 v130, v130
    v_exp_f32 v131, v131
    v_pk_fma_f32 v[124:125], v[124:125], v[114:115], v[114:115] op_sel_hi:[1,0,0]
    v_pk_fma_f32 v[126:127], v[126:127], v[114:115], v[114:115] op_sel_hi:[1,0,0]
    v_pk_fma_f32 v[128:129], v[128:129], v[114:115], v[114:115] op_sel_hi:[1,0,0]
    v_pk_fma_f32 v[130:131], v[130:131], v[114:115], v[114:115] op_sel_hi:[1,0,0]
    v_rcp_f32 v124, v124
    v_rcp_f32 v125, v125
    v_rcp_f32 v126, v126
    v_rcp_f32 v127, v127
    v_rcp_f32 v128, v128
    v_rcp_f32 v129, v129
    v_rcp_f32 v130, v130
    v_rcp_f32 v131, v131
    v_pk_mul_f32 v[124:125], v[124:125], v[28:29]
    v_pk_mul_f32 v[126:127], v[126:127], v[30:31]
    v_pk_mul_f32 v[128:129], v[128:129], v[36:37]
    v_pk_mul_f32 v[130:131], v[130:131], v[38:39]
    v_cvt_pk_bf16_f32 v140, v124, v125
    v_cvt_pk_bf16_f32 v141, v126, v127
    v_cvt_pk_bf16_f32 v142, v128, v129
    v_cvt_pk_bf16_f32 v143, v130, v131
    buffer_store_dwordx4 v[140:143], v122, s[36:39], s57 offen offset:1024 sc1
    s_add_u32 s57, s57, 4096
    v_pk_mul_f32 v[124:125], v[40:41], v[40:41]
    v_pk_mul_f32 v[126:127], v[42:43], v[42:43]
    v_pk_mul_f32 v[128:129], v[48:49], v[48:49]
    v_pk_mul_f32 v[130:131], v[50:51], v[50:51]
    v_pk_fma_f32 v[124:125], v[124:125], v[106:107], v[104:105] op_sel_hi:[1,0,0]
    v_pk_fma_f32 v[126:127], v[126:127], v[106:107], v[104:105] op_sel_hi:[1,0,0]
    v_pk_fma_f32 v[128:129], v[128:129], v[106:107], v[104:105] op_sel_hi:[1,0,0]
    v_pk_fma_f32 v[130:131], v[130:131], v[106:107], v[104:105] op_sel_hi:[1,0,0]
    v_pk_mul_f32 v[124:125], v[124:125], v[40:41]
    v_pk_mul_f32 v[126:127], v[126:127], v[42:43]
    v_pk_mul_f32 v[128:129], v[128:129], v[48:49]
    v_pk_mul_f32 v[130:131], v[130:131], v[50:51]
    v_exp_f32 v124, v124
    v_exp_f32 v125, v125
    v_exp_f32 v126, v126
    v_exp_f32 v127, v127
    v_exp_f32 v128, v128
    v_exp_f32 v129, v129
    v_exp_f32 v130, v130
    v_exp_f32 v131, v131
    v_pk_fma_f32 v[124:125], v[124:125], v[108:109], v[108:109] op_sel_hi:[1,0,0]
    v_pk_fma_f32 v[126:127], v[126:127], v[108:109], v[108:109] op_sel_hi:[1,0,0]
    v_pk_fma_f32 v[128:129], v[128:129], v[108:109], v[108:109] op_sel_hi:[1,0,0]
    v_pk_fma_f32 v[130:131], v[130:131], v[108:109], v[108:109] op_sel_hi:[1,0,0]
    v_rcp_f32 v124, v124
    v_rcp_f32 v125, v125
    v_rcp_f32 v126, v126
    v_rcp_f32 v127, v127
    v_rcp_f32 v128, v128
    v_rcp_f32 v129, v129
    v_rcp_f32 v130, v130
    v_rcp_f32 v131, v131
    v_pk_mul_f32 v[124:125], v[124:125], v[40:41]
    v_pk_mul_f32 v[126:127], v[126:127], v[42:43]
    v_pk_mul_f32 v[128:129], v[128:129], v[48:49]
    v_pk_mul_f32 v[130:131], v[130:131], v[50:51]
    v_cvt_pk_bf16_f32 v144, v124, v125
    v_cvt_pk_bf16_f32 v145, v126, v127
    v_cvt_pk_bf16_f32 v146, v128, v129
    v_cvt_pk_bf16_f32 v147, v130, v131
    buffer_store_dwordx4 v[144:147], v122, s[36:39], s57 offen offset:0 sc1
    v_pk_mul_f32 v[124:125], v[44:45], v[44:45]
    v_pk_mul_f32 v[126:127], v[46:47], v[46:47]
    v_pk_mul_f32 v[128:129], v[52:53], v[52:53]
    v_pk_mul_f32 v[130:131], v[54:55], v[54:55]
    v_pk_fma_f32 v[124:125], v[124:125], v[112:113], v[110:111] op_sel_hi:[1,0,0]
    v_pk_fma_f32 v[126:127], v[126:127], v[112:113], v[110:111] op_sel_hi:[1,0,0]
    v_pk_fma_f32 v[128:129], v[128:129], v[112:113], v[110:111] op_sel_hi:[1,0,0]
    v_pk_fma_f32 v[130:131], v[130:131], v[112:113], v[110:111] op_sel_hi:[1,0,0]
    v_pk_mul_f32 v[124:125], v[124:125], v[44:45]
    v_pk_mul_f32 v[126:127], v[126:127], v[46:47]
    v_pk_mul_f32 v[128:129], v[128:129], v[52:53]
    v_pk_mul_f32 v[130:131], v[130:131], v[54:55]
    v_exp_f32 v124, v124
    v_exp_f32 v125, v125
    v_exp_f32 v126, v126
    v_exp_f32 v127, v127
    v_exp_f32 v128, v128
    v_exp_f32 v129, v129
    v_exp_f32 v130, v130
    v_exp_f32 v131, v131
    v_pk_fma_f32 v[124:125], v[124:125], v[114:115], v[114:115] op_sel_hi:[1,0,0]
    v_pk_fma_f32 v[126:127], v[126:127], v[114:115], v[114:115] op_sel_hi:[1,0,0]
    v_pk_fma_f32 v[128:129], v[128:129], v[114:115], v[114:115] op_sel_hi:[1,0,0]
    v_pk_fma_f32 v[130:131], v[130:131], v[114:115], v[114:115] op_sel_hi:[1,0,0]
    v_rcp_f32 v124, v124
    v_rcp_f32 v125, v125
    v_rcp_f32 v126, v126
    v_rcp_f32 v127, v127
    v_rcp_f32 v128, v128
    v_rcp_f32 v129, v129
    v_rcp_f32 v130, v130
    v_rcp_f32 v131, v131
    v_pk_mul_f32 v[124:125], v[124:125], v[44:45]
    v_pk_mul_f32 v[126:127], v[126:127], v[46:47]
    v_pk_mul_f32 v[128:129], v[128:129], v[52:53]
    v_pk_mul_f32 v[130:131], v[130:131], v[54:55]
    v_cvt_pk_bf16_f32 v136, v124, v125
    v_cvt_pk_bf16_f32 v137, v126, v127
    v_cvt_pk_bf16_f32 v138, v128, v129
    v_cvt_pk_bf16_f32 v139, v130, v131
    buffer_store_dwordx4 v[136:139], v122, s[36:39], s57 offen offset:1024 sc1
    s_add_u32 s57, s57, 4096
    v_pk_mul_f32 v[124:125], v[56:57], v[56:57]
    v_pk_mul_f32 v[126:127], v[58:59], v[58:59]
    v_pk_mul_f32 v[128:129], v[64:65], v[64:65]
    v_pk_mul_f32 v[130:131], v[66:67], v[66:67]
    v_pk_fma_f32 v[124:125], v[124:125], v[106:107], v[104:105] op_sel_hi:[1,0,0]
    v_pk_fma_f32 v[126:127], v[126:127], v[106:107], v[104:105] op_sel_hi:[1,0,0]
    v_pk_fma_f32 v[128:129], v[128:129], v[106:107], v[104:105] op_sel_hi:[1,0,0]
    v_pk_fma_f32 v[130:131], v[130:131], v[106:107], v[104:105] op_sel_hi:[1,0,0]
    v_pk_mul_f32 v[124:125], v[124:125], v[56:57]
    v_pk_mul_f32 v[126:127], v[126:127], v[58:59]
    v_pk_mul_f32 v[128:129], v[128:129], v[64:65]
    v_pk_mul_f32 v[130:131], v[130:131], v[66:67]
    v_exp_f32 v124, v124
    v_exp_f32 v125, v125
    v_exp_f32 v126, v126
    v_exp_f32 v127, v127
    v_exp_f32 v128, v128
    v_exp_f32 v129, v129
    v_exp_f32 v130, v130
    v_exp_f32 v131, v131
    v_pk_fma_f32 v[124:125], v[124:125], v[108:109], v[108:109] op_sel_hi:[1,0,0]
    v_pk_fma_f32 v[126:127], v[126:127], v[108:109], v[108:109] op_sel_hi:[1,0,0]
    v_pk_fma_f32 v[128:129], v[128:129], v[108:109], v[108:109] op_sel_hi:[1,0,0]
    v_pk_fma_f32 v[130:131], v[130:131], v[108:109], v[108:109] op_sel_hi:[1,0,0]
    v_rcp_f32 v124, v124
    v_rcp_f32 v125, v125
    v_rcp_f32 v126, v126
    v_rcp_f32 v127, v127
    v_rcp_f32 v128, v128
    v_rcp_f32 v129, v129
    v_rcp_f32 v130, v130
    v_rcp_f32 v131, v131
    v_pk_mul_f32 v[124:125], v[124:125], v[56:57]
    v_pk_mul_f32 v[126:127], v[126:127], v[58:59]
    v_pk_mul_f32 v[128:129], v[128:129], v[64:65]
    v_pk_mul_f32 v[130:131], v[130:131], v[66:67]
    v_cvt_pk_bf16_f32 v140, v124, v125
    v_cvt_pk_bf16_f32 v141, v126, v127
    v_cvt_pk_bf16_f32 v142, v128, v129
    v_cvt_pk_bf16_f32 v143, v130, v131
    buffer_store_dwordx4 v[140:143], v122, s[36:39], s57 offen offset:0 sc1
    v_pk_mul_f32 v[124:125], v[60:61], v[60:61]
    v_pk_mul_f32 v[126:127], v[62:63], v[62:63]
    v_pk_mul_f32 v[128:129], v[68:69], v[68:69]
    v_pk_mul_f32 v[130:131], v[70:71], v[70:71]
    v_pk_fma_f32 v[124:125], v[124:125], v[112:113], v[110:111] op_sel_hi:[1,0,0]
    v_pk_fma_f32 v[126:127], v[126:127], v[112:113], v[110:111] op_sel_hi:[1,0,0]
    v_pk_fma_f32 v[128:129], v[128:129], v[112:113], v[110:111] op_sel_hi:[1,0,0]
    v_pk_fma_f32 v[130:131], v[130:131], v[112:113], v[110:111] op_sel_hi:[1,0,0]
    v_pk_mul_f32 v[124:125], v[124:125], v[60:61]
    v_pk_mul_f32 v[126:127], v[126:127], v[62:63]
    v_pk_mul_f32 v[128:129], v[128:129], v[68:69]
    v_pk_mul_f32 v[130:131], v[130:131], v[70:71]
    v_exp_f32 v124, v124
    v_exp_f32 v125, v125
    v_exp_f32 v126, v126
    v_exp_f32 v127, v127
    v_exp_f32 v128, v128
    v_exp_f32 v129, v129
    v_exp_f32 v130, v130
    v_exp_f32 v131, v131
    v_pk_fma_f32 v[124:125], v[124:125], v[114:115], v[114:115] op_sel_hi:[1,0,0]
    v_pk_fma_f32 v[126:127], v[126:127], v[114:115], v[114:115] op_sel_hi:[1,0,0]
    v_pk_fma_f32 v[128:129], v[128:129], v[114:115], v[114:115] op_sel_hi:[1,0,0]
    v_pk_fma_f32 v[130:131], v[130:131], v[114:115], v[114:115] op_sel_hi:[1,0,0]
    v_rcp_f32 v124, v124
    v_rcp_f32 v125, v125
    v_rcp_f32 v126, v126
    v_rcp_f32 v127, v127
    v_rcp_f32 v128, v128
    v_rcp_f32 v129, v129
    v_rcp_f32 v130, v130
    v_rcp_f32 v131, v131
    v_pk_mul_f32 v[124:125], v[124:125], v[60:61]
    v_pk_mul_f32 v[126:127], v[126:127], v[62:63]
    v_pk_mul_f32 v[128:129], v[128:129], v[68:69]
    v_pk_mul_f32 v[130:131], v[130:131], v[70:71]
    v_cvt_pk_bf16_f32 v144, v124, v125
    v_cvt_pk_bf16_f32 v145, v126, v127
    v_cvt_pk_bf16_f32 v146, v128, v129
    v_cvt_pk_bf16_f32 v147, v130, v131
    buffer_store_dwordx4 v[144:147], v122, s[36:39], s57 offen offset:1024 sc1
    s_add_u32 s57, s57, 4096
    v_pk_mul_f32 v[124:125], v[72:73], v[72:73]
    v_pk_mul_f32 v[126:127], v[74:75], v[74:75]
    v_pk_mul_f32 v[128:129], v[80:81], v[80:81]
    v_pk_mul_f32 v[130:131], v[82:83], v[82:83]
    v_pk_fma_f32 v[124:125], v[124:125], v[106:107], v[104:105] op_sel_hi:[1,0,0]
    v_pk_fma_f32 v[126:127], v[126:127], v[106:107], v[104:105] op_sel_hi:[1,0,0]
    v_pk_fma_f32 v[128:129], v[128:129], v[106:107], v[104:105] op_sel_hi:[1,0,0]
    v_pk_fma_f32 v[130:131], v[130:131], v[106:107], v[104:105] op_sel_hi:[1,0,0]
    v_pk_mul_f32 v[124:125], v[124:125], v[72:73]
    v_pk_mul_f32 v[126:127], v[126:127], v[74:75]
    v_pk_mul_f32 v[128:129], v[128:129], v[80:81]
    v_pk_mul_f32 v[130:131], v[130:131], v[82:83]
    v_exp_f32 v124, v124
    v_exp_f32 v125, v125
    v_exp_f32 v126, v126
    v_exp_f32 v127, v127
    v_exp_f32 v128, v128
    v_exp_f32 v129, v129
    v_exp_f32 v130, v130
    v_exp_f32 v131, v131
    v_pk_fma_f32 v[124:125], v[124:125], v[108:109], v[108:109] op_sel_hi:[1,0,0]
    v_pk_fma_f32 v[126:127], v[126:127], v[108:109], v[108:109] op_sel_hi:[1,0,0]
    v_pk_fma_f32 v[128:129], v[128:129], v[108:109], v[108:109] op_sel_hi:[1,0,0]
    v_pk_fma_f32 v[130:131], v[130:131], v[108:109], v[108:109] op_sel_hi:[1,0,0]
    v_rcp_f32 v124, v124
    v_rcp_f32 v125, v125
    v_rcp_f32 v126, v126
    v_rcp_f32 v127, v127
    v_rcp_f32 v128, v128
    v_rcp_f32 v129, v129
    v_rcp_f32 v130, v130
    v_rcp_f32 v131, v131
    v_pk_mul_f32 v[124:125], v[124:125], v[72:73]
    v_pk_mul_f32 v[126:127], v[126:127], v[74:75]
    v_pk_mul_f32 v[128:129], v[128:129], v[80:81]
    v_pk_mul_f32 v[130:131], v[130:131], v[82:83]
    v_cvt_pk_bf16_f32 v136, v124, v125
    v_cvt_pk_bf16_f32 v137, v126, v127
    v_cvt_pk_bf16_f32 v138, v128, v129
    v_cvt_pk_bf16_f32 v139, v130, v131
    buffer_store_dwordx4 v[136:139], v122, s[36:39], s57 offen offset:0 sc1
    v_pk_mul_f32 v[124:125], v[76:77], v[76:77]
    v_pk_mul_f32 v[126:127], v[78:79], v[78:79]
    v_pk_mul_f32 v[128:129], v[84:85], v[84:85]
    v_pk_mul_f32 v[130:131], v[86:87], v[86:87]
    v_pk_fma_f32 v[124:125], v[124:125], v[112:113], v[110:111] op_sel_hi:[1,0,0]
    v_pk_fma_f32 v[126:127], v[126:127], v[112:113], v[110:111] op_sel_hi:[1,0,0]
    v_pk_fma_f32 v[128:129], v[128:129], v[112:113], v[110:111] op_sel_hi:[1,0,0]
    v_pk_fma_f32 v[130:131], v[130:131], v[112:113], v[110:111] op_sel_hi:[1,0,0]
    v_pk_mul_f32 v[124:125], v[124:125], v[76:77]
    v_pk_mul_f32 v[126:127], v[126:127], v[78:79]
    v_pk_mul_f32 v[128:129], v[128:129], v[84:85]
    v_pk_mul_f32 v[130:131], v[130:131], v[86:87]
    v_exp_f32 v124, v124
    v_exp_f32 v125, v125
    v_exp_f32 v126, v126
    v_exp_f32 v127, v127
    v_exp_f32 v128, v128
    v_exp_f32 v129, v129
    v_exp_f32 v130, v130
    v_exp_f32 v131, v131
    v_pk_fma_f32 v[124:125], v[124:125], v[114:115], v[114:115] op_sel_hi:[1,0,0]
    v_pk_fma_f32 v[126:127], v[126:127], v[114:115], v[114:115] op_sel_hi:[1,0,0]
    v_pk_fma_f32 v[128:129], v[128:129], v[114:115], v[114:115] op_sel_hi:[1,0,0]
    v_pk_fma_f32 v[130:131], v[130:131], v[114:115], v[114:115] op_sel_hi:[1,0,0]
    v_rcp_f32 v124, v124
    v_rcp_f32 v125, v125
    v_rcp_f32 v126, v126
    v_rcp_f32 v127, v127
    v_rcp_f32 v128, v128
    v_rcp_f32 v129, v129
    v_rcp_f32 v130, v130
    v_rcp_f32 v131, v131
    v_pk_mul_f32 v[124:125], v[124:125], v[76:77]
    v_pk_mul_f32 v[126:127], v[126:127], v[78:79]
    v_pk_mul_f32 v[128:129], v[128:129], v[84:85]
    v_pk_mul_f32 v[130:131], v[130:131], v[86:87]
    v_cvt_pk_bf16_f32 v140, v124, v125
    v_cvt_pk_bf16_f32 v141, v126, v127
    v_cvt_pk_bf16_f32 v142, v128, v129
    v_cvt_pk_bf16_f32 v143, v130, v131
    buffer_store_dwordx4 v[140:143], v122, s[36:39], s57 offen offset:1024 sc1
    s_add_u32 s57, s57, 4096
    s_waitcnt vmcnt(0)
    s_setprio 0
    s_barrier
    s_lshl_b32 s58, s46, 3
    s_add_u32 s58, s58, s47
    s_add_u32 s57, s58, 8
    s_lshl_b32 s57, s57, 7
    v_mov_b32 v150, s57
    v_mov_b32 v151, 1
    s_cmp_eq_u32 s44, 0
    s_cselect_b32 exec_lo, 1, 0
    s_mov_b32 exec_hi, 0
    global_atomic_add v150, v151, s[10:11]
    s_mov_b64 exec, -1
    s_add_u32 s65, s75, 0
    s_cmp_ge_u32 s65, s73
    s_cselect_b32 s61, s73, 0
    s_sub_u32 s65, s65, s61
    s_add_u32 s65, s65, s69
    s_mul_i32 s65, s65, 5120
    s_add_u32 s65, s65, s78
    buffer_load_dwordx4 v[152:155], v6, s[36:39], s65 offen offset:0 sc1
    buffer_load_dwordx4 v[156:159], v6, s[36:39], s65 offen offset:1024 sc1
    buffer_load_dwordx4 v[160:163], v6, s[36:39], s65 offen offset:2048 sc1
    buffer_load_dwordx4 v[164:167], v6, s[36:39], s65 offen offset:3072 sc1
    s_add_u32 s65, s65, 4096
    buffer_load_dwordx4 v[168:171], v6, s[36:39], s65 offen offset:0 sc1
    s_add_u32 s65, s75, 1
    s_cmp_ge_u32 s65, s73
    s_cselect_b32 s61, s73, 0
    s_sub_u32 s65, s65, s61
    s_add_u32 s65, s65, s69
    s_mul_i32 s65, s65, 5120
    s_add_u32 s65, s65, s78
    buffer_load_dwordx4 v[172:175], v6, s[36:39], s65 offen offset:0 sc1
    buffer_load_dwordx4 v[176:179], v6, s[36:39], s65 offen offset:1024 sc1
    buffer_load_dwordx4 v[180:183], v6, s[36:39], s65 offen offset:2048 sc1
    buffer_load_dwordx4 v[184:187], v6, s[36:39], s65 offen offset:3072 sc1
    s_add_u32 s65, s65, 4096
    buffer_load_dwordx4 v[188:191], v6, s[36:39], s65 offen offset:0 sc1
    s_add_u32 s65, s75, 2
    s_cmp_ge_u32 s65, s73
    s_cselect_b32 s61, s73, 0
    s_sub_u32 s65, s65, s61
    s_add_u32 s65, s65, s69
    s_mul_i32 s65, s65, 5120
    s_add_u32 s65, s65, s78
    buffer_load_dwordx4 v[192:195], v6, s[36:39], s65 offen offset:0 sc1
    buffer_load_dwordx4 v[196:199], v6, s[36:39], s65 offen offset:1024 sc1
    buffer_load_dwordx4 v[200:203], v6, s[36:39], s65 offen offset:2048 sc1
    buffer_load_dwordx4 v[204:207], v6, s[36:39], s65 offen offset:3072 sc1
    s_add_u32 s65, s65, 4096
    buffer_load_dwordx4 v[208:211], v6, s[36:39], s65 offen offset:0 sc1
    s_add_u32 s65, s75, 3
    s_cmp_ge_u32 s65, s73
    s_cselect_b32 s61, s73, 0
    s_sub_u32 s65, s65, s61
    s_add_u32 s65, s65, s69
    s_mul_i32 s65, s65, 5120
    s_add_u32 s65, s65, s78
    buffer_load_dwordx4 v[212:215], v6, s[36:39], s65 offen offset:0 sc1
    buffer_load_dwordx4 v[216:219], v6, s[36:39], s65 offen offset:1024 sc1
    buffer_load_dwordx4 v[220:223], v6, s[36:39], s65 offen offset:2048 sc1
    buffer_load_dwordx4 v[224:227], v6, s[36:39], s65 offen offset:3072 sc1
    s_add_u32 s65, s65, 4096
    buffer_load_dwordx4 v[228:231], v6, s[36:39], s65 offen offset:0 sc1
    s_add_u32 s65, s75, 4
    s_cmp_ge_u32 s65, s73
    s_cselect_b32 s61, s73, 0
    s_sub_u32 s65, s65, s61
    s_add_u32 s65, s65, s69
    s_mul_i32 s65, s65, 5120
    s_add_u32 s65, s65, s78
    buffer_load_dwordx4 v[232:235], v6, s[36:39], s65 offen offset:0 sc1
    buffer_load_dwordx4 v[236:239], v6, s[36:39], s65 offen offset:1024 sc1
    buffer_load_dwordx4 v[240:243], v6, s[36:39], s65 offen offset:2048 sc1
    buffer_load_dwordx4 v[244:247], v6, s[36:39], s65 offen offset:3072 sc1
    s_add_u32 s65, s65, 4096
    buffer_load_dwordx4 v[248:251], v6, s[36:39], s65 offen offset:0 sc1
    s_add_u32 s65, s76, 0
    s_cmp_ge_u32 s65, s74
    s_cselect_b32 s61, s74, 0
    s_sub_u32 s65, s65, s61
    s_add_u32 s65, s65, s72
    s_mul_i32 s65, s65, 5120
    s_add_u32 s65, s65, s78
    s_mul_i32 s66, s44, 20480
    s_add_u32 m0, s66, 0
    s_nop 0
    buffer_load_dwordx4 v6, s[36:39], s65 offen sc1 lds
    s_add_u32 s65, s65, 1024
    s_add_u32 m0, s66, 1024
    s_nop 0
    buffer_load_dwordx4 v6, s[36:39], s65 offen sc1 lds
    s_add_u32 s65, s65, 1024
    s_add_u32 m0, s66, 2048
    s_nop 0
    buffer_load_dwordx4 v6, s[36:39], s65 offen sc1 lds
    s_add_u32 s65, s65, 1024
    s_add_u32 m0, s66, 3072
    s_nop 0
    buffer_load_dwordx4 v6, s[36:39], s65 offen sc1 lds
    s_add_u32 s65, s65, 1024
    s_add_u32 m0, s66, 4096
    s_nop 0
    buffer_load_dwordx4 v6, s[36:39], s65 offen sc1 lds
    s_add_u32 s65, s76, 1
    s_cmp_ge_u32 s65, s74
    s_cselect_b32 s61, s74, 0
    s_sub_u32 s65, s65, s61
    s_add_u32 s65, s65, s72
    s_mul_i32 s65, s65, 5120
    s_add_u32 s65, s65, s78
    s_mul_i32 s66, s44, 20480
    s_add_u32 m0, s66, 5120
    s_nop 0
    buffer_load_dwordx4 v6, s[36:39], s65 offen sc1 lds
    s_add_u32 s65, s65, 1024
    s_add_u32 m0, s66, 6144
    s_nop 0
    buffer_load_dwordx4 v6, s[36:39], s65 offen sc1 lds
    s_add_u32 s65, s65, 1024
    s_add_u32 m0, s66, 7168
    s_nop 0
    buffer_load_dwordx4 v6, s[36:39], s65 offen sc1 lds
    s_add_u32 s65, s65, 1024
    s_add_u32 m0, s66, 8192
    s_nop 0
    buffer_load_dwordx4 v6, s[36:39], s65 offen sc1 lds
    s_add_u32 s65, s65, 1024
    s_add_u32 m0, s66, 9216
    s_nop 0
    buffer_load_dwordx4 v6, s[36:39], s65 offen sc1 lds
    s_add_u32 s65, s76, 2
    s_cmp_ge_u32 s65, s74
    s_cselect_b32 s61, s74, 0
    s_sub_u32 s65, s65, s61
    s_add_u32 s65, s65, s72
    s_mul_i32 s65, s65, 5120
    s_add_u32 s65, s65, s78
    s_cmp_gt_u32 s74, 2
    s_cselect_b32 s65, s65, 2130706432
    s_mul_i32 s66, s44, 20480
    s_add_u32 m0, s66, 10240
    s_nop 0
    buffer_load_dwordx4 v6, s[36:39], s65 offen sc1 lds
    s_add_u32 s65, s65, 1024
    s_add_u32 m0, s66, 11264
    s_nop 0
    buffer_load_dwordx4 v6, s[36:39], s65 offen sc1 lds
    s_add_u32 s65, s65, 1024
    s_add_u32 m0, s66, 12288
    s_nop 0
    buffer_load_dwordx4 v6, s[36:39], s65 offen sc1 lds
    s_add_u32 s65, s65, 1024
    s_add_u32 m0, s66, 13312
    s_nop 0
    buffer_load_dwordx4 v6, s[36:39], s65 offen sc1 lds
    s_add_u32 s65, s65, 1024
    s_add_u32 m0, s66, 14336
    s_nop 0
    buffer_load_dwordx4 v6, s[36:39], s65 offen sc1 lds
    s_branch PHASE2
ROLE_H1:
    s_mov_b32 s79, 4
    v_lshrrev_b32 v104, 3, v1
    s_lshl_b32 s57, s45, 3
    s_lshl_b32 s58, s46, 7
    s_add_u32 s57, s57, s58
    v_add_u32 v104, s57, v104
    v_mul_u32_u24 v218, 1280, v104
    v_lshrrev_b32 v104, 1, v104
    v_xor_b32 v104, v104, v1
    v_and_b32 v104, 7, v104
    v_lshl_add_u32 v218, v104, 4, v218
    s_lshl_b32 s54, s45, 10
    v_bfe_u32 v104, v1, 2, 2
    v_lshrrev_b32 v105, 4, v1
    v_and_b32 v109, 3, v1
    s_lshl_b32 s57, s47, 1
    s_add_u32 s57, s57, s48
    s_add_u32 s57, s57, s46
    s_mul_i32 s58, s57, 26
    s_lshr_b32 s58, s58, 8
    s_mul_i32 s58, s58, 10
    s_sub_u32 s57, s57, s58
    s_lshl_b32 s50, s57, 7
    s_mul_i32 s51, s57, 221184
    s_mul_i32 s55, s45, 7168
    s_add_u32 s55, s55, 16384
    s_lshl_b32 s57, s45, 4
    v_add_u32 v104, s57, v104
    v_mul_u32_u24 v104, 3456, v104
    v_mov_b32 v112, v109
    s_lshl_b32 s57, s49, 1
    v_add_u32 v104, s57, v104
    s_mov_b32 s57, 13376
    v_add_u32 v109, 0, v105
    v_mul_u32_u24 v110, 37, v109
    v_lshrrev_b32 v110, 8, v110
    v_and_b32 v111, 2, v110
    v_xor_b32 v111, v111, v112
    v_mad_u32_u24 v110, v110, s57, v104
    v_lshl_add_u32 v110, v111, 4, v110
    v_lshl_add_u32 v219, v109, 6, v110
    v_add_u32 v109, 4, v105
    v_mul_u32_u24 v110, 37, v109
    v_lshrrev_b32 v110, 8, v110
    v_and_b32 v111, 2, v110
    v_xor_b32 v111, v111, v112
    v_mad_u32_u24 v110, v110, s57, v104
    v_lshl_add_u32 v110, v111, 4, v110
    v_lshl_add_u32 v220, v109, 6, v110
    v_add_u32 v109, 8, v105
    v_mul_u32_u24 v110, 37, v109
    v_lshrrev_b32 v110, 8, v110
    v_and_b32 v111, 2, v110
    v_xor_b32 v111, v111, v112
    v_mad_u32_u24 v110, v110, s57, v104
    v_lshl_add_u32 v110, v111, 4, v110
    v_lshl_add_u32 v221, v109, 6, v110
    v_add_u32 v109, 12, v105
    v_mul_u32_u24 v110, 37, v109
    v_lshrrev_b32 v110, 8, v110
    v_and_b32 v111, 2, v110
    v_xor_b32 v111, v111, v112
    v_mad_u32_u24 v110, v110, s57, v104
    v_lshl_add_u32 v110, v111, 4, v110
    v_lshl_add_u32 v222, v109, 6, v110
    v_add_u32 v109, 16, v105
    v_mul_u32_u24 v110, 37, v109
    v_lshrrev_b32 v110, 8, v110
    v_and_b32 v111, 2, v110
    v_xor_b32 v111, v111, v112
    v_mad_u32_u24 v110, v110, s57, v104
    v_lshl_add_u32 v110, v111, 4, v110
    v_lshl_add_u32 v223, v109, 6, v110
    v_add_u32 v109, 20, v105
    v_mul_u32_u24 v110, 37, v109
    v_lshrrev_b32 v110, 8, v110
    v_and_b32 v111, 2, v110
    v_xor_b32 v111, v111, v112
    v_mad_u32_u24 v110, v110, s57, v104
    v_lshl_add_u32 v110, v111, 4, v110
    v_lshl_add_u32 v224, v109, 6, v110
    v_add_u32 v109, 24, v105
    v_mul_u32_u24 v110, 37, v109
    v_lshrrev_b32 v110, 8, v110
    v_and_b32 v111, 2, v110
    v_xor_b32 v111, v111, v112
    v_mad_u32_u24 v110, v110, s57, v104
    v_lshl_add_u32 v110, v111, 4, v110
    v_lshl_add_u32 v225, v109, 6, v110
    s_waitcnt lgkmcnt(0)
    s_mov_b32 s28, s4
    s_mov_b32 s29, s5
    s_mov_b32 s30, 2621440
    s_mov_b32 s31, 0x20000
    s_mov_b32 s36, s24
    s_mov_b32 s37, s25
    s_mov_b32 s38, 12866560
    s_mov_b32 s39, 0x20000
    s_add_u32 s10, s24, 12812288
    s_addc_u32 s11, s25, 0
    s_mov_b32 s32, s12
    s_mov_b32 s33, s13
    s_mov_b32 s34, 2211840
    s_mov_b32 s35, 0x20000
    s_add_u32 m0, s55, 0
    s_nop 0
    buffer_load_dwordx4 v219, s[32:35], s51 offen lds
    s_add_u32 m0, s54, 0
    s_add_u32 s53, s50, 0
    buffer_load_dwordx4 v218, s[28:31], s53 offen lds
    s_add_u32 m0, s55, 1024
    s_nop 0
    buffer_load_dwordx4 v220, s[32:35], s51 offen lds
    s_add_u32 m0, s55, 2048
    s_nop 0
    buffer_load_dwordx4 v221, s[32:35], s51 offen lds
    s_add_u32 m0, s54, 4096
    s_add_u32 s53, s50, 40960
    buffer_load_dwordx4 v218, s[28:31], s53 offen lds
    v_and_b32 v140, 15, v1
    s_lshl_b32 s57, s45, 5
    v_add_u32 v140, s57, v140
    v_bfe_u32 v141, v140, 1, 3
    v_lshrrev_b32 v142, 4, v1
    v_xor_b32 v141, v141, v142
    v_lshlrev_b32 v141, 4, v141
    v_lshl_add_u32 v194, v140, 7, v141
    v_mul_u32_u24 v140, 3584, v142
    v_and_b32 v142, 1, v142
    v_lshl_add_u32 v140, v142, 5, v140
    v_bfe_u32 v141, v1, 2, 2
    v_lshl_add_u32 v140, v141, 6, v140
    v_and_b32 v141, 3, v1
    v_lshl_add_u32 v140, v141, 3, v140
    v_add_u32 v197, 17408, v140
    s_min_u32 s57, s44, 6
    s_lshl_b32 s57, s57, 8
    s_add_u32 s57, s57, 16384
    v_add_u32 v226, s57, v140
    v_xor_b32 v227, 32, v226
    v_mov_b32 v136, 0x3f803f80
    v_mov_b32 v137, 0x3f803f80
    v_mov_b32 v138, 0x3f803f80
    v_mov_b32 v139, 0x3f803f80
    s_and_b32 s57, s2, 3
    s_lshl_b32 s57, s57, 3
    s_bfe_u32 s58, s2, 0x30003
    s_add_u32 s67, s57, s58
    s_bfe_u32 s57, s2, 0x10002
    s_lshl_b32 s57, s57, 2
    s_lshr_b32 s58, s2, 6
    s_add_u32 s68, s57, s58
    s_lshl_b32 s57, s45, 3
    s_lshr_b32 s70, 0x302a231c, s57
    s_and_b32 s70, s70, 255
    s_cmp_eq_u32 s48, 0
    s_cselect_b32 s60, 0, 0
    s_mul_i32 s57, s44, 7
    s_add_u32 s58, s70, s60
    s_cmp_lt_u32 s44, 6
    s_cselect_b32 s59, 7, 6
    s_sub_u32 s59, s59, s60
    s_cmp_lt_u32 s44, 4
    s_cselect_b32 s69, s57, s58
    s_cselect_b32 s73, 7, s59
    s_cselect_b32 s71, s60, 0
    s_and_b32 s57, s44, 1
    s_sub_u32 s74, 3, s57
    s_mul_i32 s57, s57, 3
    s_lshr_b32 s58, s44, 1
    s_mul_i32 s58, s58, 5
    s_add_u32 s57, s57, s58
    s_add_u32 s72, s57, 54
    s_and_b32 s57, s68, 3
    s_mul_i32 s75, s57, 2
    s_mul_i32 s76, s57, 1
    s_cmp_ge_u32 s75, s73
    s_cselect_b32 s57, s73, 0
    s_sub_u32 s75, s75, s57
    s_cmp_ge_u32 s75, s73
    s_cselect_b32 s57, s73, 0
    s_sub_u32 s75, s75, s57
    s_cmp_ge_u32 s76, s74
    s_cselect_b32 s57, s74, 0
    s_sub_u32 s76, s76, s57
    s_cmp_ge_u32 s76, s74
    s_cselect_b32 s57, s74, 0
    s_sub_u32 s76, s76, s57
    s_cmp_ge_u32 s76, s74
    s_cselect_b32 s57, s74, 0
    s_sub_u32 s76, s76, s57
    s_mul_i32 s77, s67, 303104
    s_mul_i32 s78, s68, 378880
    s_add_u32 s78, s78, 9699328
    s_mov_b32 s96, s14
    s_mov_b32 s97, s15
    s_mov_b32 s98, 3456
    s_mov_b32 s99, 0x20000
    s_lshl_b32 s57, s79, 5
    s_add_u32 s57, s57, s49
    s_lshl_b32 s57, s57, 1
    v_and_b32 v140, 15, v1
    v_lshlrev_b32 v140, 1, v140
    buffer_load_ushort v198, v140, s[96:99], s57 offen offset:0
    buffer_load_ushort v199, v140, s[96:99], s57 offen offset:32
    buffer_load_ushort v200, v140, s[96:99], s57 offen offset:64
    buffer_load_ushort v201, v140, s[96:99], s57 offen offset:96
    buffer_load_ushort v202, v140, s[96:99], s57 offen offset:128
    buffer_load_ushort v203, v140, s[96:99], s57 offen offset:160
    s_add_u32 m0, s55, 3072
    s_nop 0
    buffer_load_dwordx4 v222, s[32:35], s51 offen lds
    s_add_u32 m0, s55, 4096
    s_nop 0
    buffer_load_dwordx4 v223, s[32:35], s51 offen lds
    s_add_u32 m0, s54, 8192
    s_add_u32 s53, s50, 81920
    buffer_load_dwordx4 v218, s[28:31], s53 offen lds
    s_add_u32 m0, s55, 5120
    s_nop 0
    buffer_load_dwordx4 v224, s[32:35], s51 offen lds
    s_add_u32 m0, s55, 6144
    s_nop 0
    buffer_load_dwordx4 v225, s[32:35], s51 offen lds
    s_add_u32 m0, s54, 12288
    s_add_u32 s53, s50, 122880
    buffer_load_dwordx4 v218, s[28:31], s53 offen lds
    s_barrier
    s_add_u32 s50, s50, 128
    s_add_u32 s51, s51, 221184
    s_cmp_eq_u32 s50, 1280
    s_cselect_b32 s50, 0, s50
    s_cselect_b32 s51, 0, s51
    s_add_u32 m0, s55, 49152
    s_nop 0
    buffer_load_dwordx4 v219, s[32:35], s51 offen lds
    s_add_u32 m0, s54, 49152
    s_add_u32 s53, s50, 0
    buffer_load_dwordx4 v218, s[28:31], s53 offen lds
    s_add_u32 m0, s55, 50176
    s_nop 0
    buffer_load_dwordx4 v220, s[32:35], s51 offen lds
    s_add_u32 m0, s55, 51200
    s_nop 0
    buffer_load_dwordx4 v221, s[32:35], s51 offen lds
    s_add_u32 m0, s54, 53248
    s_add_u32 s53, s50, 40960
    buffer_load_dwordx4 v218, s[28:31], s53 offen lds
    s_add_u32 m0, s55, 52224
    s_nop 0
    buffer_load_dwordx4 v222, s[32:35], s51 offen lds
    s_add_u32 m0, s55, 53248
    s_nop 0
    buffer_load_dwordx4 v223, s[32:35], s51 offen lds
    s_add_u32 m0, s54, 57344
    s_add_u32 s53, s50, 81920
    buffer_load_dwordx4 v218, s[28:31], s53 offen lds
    s_add_u32 m0, s55, 54272
    s_nop 0
    buffer_load_dwordx4 v224, s[32:35], s51 offen lds
    s_add_u32 m0, s55, 55296
    s_nop 0
    buffer_load_dwordx4 v225, s[32:35], s51 offen lds
    s_add_u32 m0, s54, 61440
    s_add_u32 s53, s50, 122880
    buffer_load_dwordx4 v218, s[28:31], s53 offen lds
    v_add_u32 v192, 0, v194
    v_add_u32 v195, 0, v197
    v_xor_b32 v193, 64, v192
    v_xor_b32 v196, 32, v195
    s_waitcnt vmcnt(11)
    s_setprio 1
    s_barrier
    ds_read_b128 v[152:155], v192 offset:0
    ds_read_b128 v[156:159], v192 offset:2048
    ds_read_b64_tr_b16 v[168:169], v195 offset:0
    ds_read_b64_tr_b16 v[170:171], v195 offset:1792
    ds_read_b64_tr_b16 v[172:173], v196 offset:0
    ds_read_b64_tr_b16 v[174:175], v196 offset:1792
    ds_read_b64_tr_b16 v[176:177], v195 offset:256
    ds_read_b64_tr_b16 v[178:179], v195 offset:2048
    ds_read_b64_tr_b16 v[180:181], v196 offset:256
    ds_read_b64_tr_b16 v[182:183], v196 offset:2048
    ds_read_b64_tr_b16 v[184:185], v195 offset:512
    ds_read_b64_tr_b16 v[186:187], v195 offset:2304
    s_waitcnt lgkmcnt(8)
    v_mfma_f32_16x16x32_bf16 v[24:27], v[168:171], v[152:155], 0
    ds_read_b128 v[160:163], v193 offset:0
    v_mfma_f32_16x16x32_bf16 v[28:31], v[168:171], v[156:159], 0
    ds_read_b128 v[164:167], v193 offset:2048
    s_add_u32 s50, s50, 128
    s_add_u32 s51, s51, 221184
    s_cmp_eq_u32 s50, 1280
    s_cselect_b32 s50, 0, s50
    s_cselect_b32 s51, 0, s51
    s_add_u32 m0, s55, 98304
    s_nop 0
    buffer_load_dwordx4 v219, s[32:35], s51 offen lds
    s_add_u32 m0, s54, 98304
    s_add_u32 s53, s50, 0
    buffer_load_dwordx4 v218, s[28:31], s53 offen lds
    ds_read_b64_tr_b16 v[104:105], v226 offset:0
    ds_read_b64_tr_b16 v[106:107], v226 offset:1792
    ds_read_b64_tr_b16 v[108:109], v226 offset:14336
    s_waitcnt lgkmcnt(11)
    v_mfma_f32_16x16x32_bf16 v[32:35], v[172:175], v[152:155], 0
    ds_read_b64_tr_b16 v[188:189], v196 offset:512
    v_mfma_f32_16x16x32_bf16 v[36:39], v[172:175], v[156:159], 0
    ds_read_b64_tr_b16 v[190:191], v196 offset:2304
    s_add_u32 m0, s55, 99328
    s_nop 0
    buffer_load_dwordx4 v220, s[32:35], s51 offen lds
    s_add_u32 m0, s55, 100352
    s_nop 0
    buffer_load_dwordx4 v221, s[32:35], s51 offen lds
    ds_read_b64_tr_b16 v[110:111], v226 offset:16128
    ds_read_b64_tr_b16 v[112:113], v227 offset:0
    ds_read_b64_tr_b16 v[114:115], v227 offset:1792
    s_waitcnt lgkmcnt(14)
    v_mfma_f32_16x16x32_bf16 v[40:43], v[176:179], v[152:155], 0
    ds_read_b64_tr_b16 v[168:169], v195 offset:14336
    v_mfma_f32_16x16x32_bf16 v[44:47], v[176:179], v[156:159], 0
    ds_read_b64_tr_b16 v[170:171], v195 offset:16128
    s_add_u32 m0, s54, 102400
    s_add_u32 s53, s50, 40960
    buffer_load_dwordx4 v218, s[28:31], s53 offen lds
    s_add_u32 m0, s55, 101376
    s_nop 0
    buffer_load_dwordx4 v222, s[32:35], s51 offen lds
    ds_read_b64_tr_b16 v[116:117], v227 offset:14336
    ds_read_b64_tr_b16 v[118:119], v227 offset:16128
    s_waitcnt lgkmcnt(10)
    v_mfma_f32_16x16x32_bf16 v[48:51], v[180:183], v[152:155], 0
    ds_read_b64_tr_b16 v[172:173], v196 offset:14336
    v_mfma_f32_16x16x32_bf16 v[52:55], v[180:183], v[156:159], 0
    ds_read_b64_tr_b16 v[174:175], v196 offset:16128
    s_add_u32 m0, s55, 102400
    s_nop 0
    buffer_load_dwordx4 v223, s[32:35], s51 offen lds
    v_mfma_f32_16x16x32_bf16 v[208:211], v[136:139], v[104:107], 0
    s_waitcnt lgkmcnt(8)
    v_mfma_f32_16x16x32_bf16 v[208:211], v[136:139], v[108:111], v[208:211]
    v_mfma_f32_16x16x32_bf16 v[56:59], v[184:187], v[152:155], 0
    ds_read_b64_tr_b16 v[176:177], v195 offset:14592
    v_mfma_f32_16x16x32_bf16 v[60:63], v[184:187], v[156:159], 0
    ds_read_b64_tr_b16 v[178:179], v195 offset:16384
    s_add_u32 m0, s54, 106496
    s_add_u32 s53, s50, 81920
    buffer_load_dwordx4 v218, s[28:31], s53 offen lds
    s_waitcnt lgkmcnt(8)
    v_mfma_f32_16x16x32_bf16 v[212:215], v[136:139], v[112:115], 0
    s_waitcnt lgkmcnt(4)
    v_mfma_f32_16x16x32_bf16 v[64:67], v[188:191], v[152:155], 0
    ds_read_b64_tr_b16 v[180:181], v196 offset:14592
    v_mfma_f32_16x16x32_bf16 v[68:71], v[188:191], v[156:159], 0
    ds_read_b64_tr_b16 v[182:183], v196 offset:16384
    s_add_u32 m0, s55, 103424
    s_nop 0
    buffer_load_dwordx4 v224, s[32:35], s51 offen lds
    v_mfma_f32_16x16x32_bf16 v[212:215], v[136:139], v[116:119], v[212:215]
    v_mfma_f32_16x16x32_bf16 v[24:27], v[168:171], v[160:163], v[24:27]
    ds_read_b64_tr_b16 v[184:185], v195 offset:14848
    v_mfma_f32_16x16x32_bf16 v[28:31], v[168:171], v[164:167], v[28:31]
    ds_read_b64_tr_b16 v[186:187], v195 offset:16640
    s_add_u32 m0, s55, 104448
    s_nop 0
    buffer_load_dwordx4 v225, s[32:35], s51 offen lds
    s_waitcnt lgkmcnt(6)
    v_mfma_f32_16x16x32_bf16 v[32:35], v[172:175], v[160:163], v[32:35]
    ds_read_b64_tr_b16 v[188:189], v196 offset:14848
    v_mfma_f32_16x16x32_bf16 v[36:39], v[172:175], v[164:167], v[36:39]
    ds_read_b64_tr_b16 v[190:191], v196 offset:16640
    v_add_u32 v192, 49152, v194
    v_add_u32 v195, 49152, v197
    v_xor_b32 v193, 64, v192
    v_xor_b32 v196, 32, v195
    s_add_u32 m0, s54, 110592
    s_add_u32 s53, s50, 122880
    buffer_load_dwordx4 v218, s[28:31], s53 offen lds
    s_waitcnt lgkmcnt(6)
    v_mfma_f32_16x16x32_bf16 v[40:43], v[176:179], v[160:163], v[40:43]
    v_mfma_f32_16x16x32_bf16 v[44:47], v[176:179], v[164:167], v[44:47]
    s_waitcnt vmcnt(11) lgkmcnt(0)
    s_barrier
    ds_read_b128 v[152:155], v192 offset:0
    ds_read_b128 v[156:159], v192 offset:2048
    ds_read_b64_tr_b16 v[168:169], v195 offset:0
    ds_read_b64_tr_b16 v[170:171], v195 offset:1792
    ds_read_b64_tr_b16 v[172:173], v196 offset:0
    ds_read_b64_tr_b16 v[174:175], v196 offset:1792
    v_mfma_f32_16x16x32_bf16 v[48:51], v[180:183], v[160:163], v[48:51]
    v_mfma_f32_16x16x32_bf16 v[52:55], v[180:183], v[164:167], v[52:55]
    s_add_u32 s50, s50, 128
    s_add_u32 s51, s51, 221184
    s_cmp_eq_u32 s50, 1280
    s_cselect_b32 s50, 0, s50
    s_cselect_b32 s51, 0, s51
    s_add_u32 m0, s55, 0
    s_nop 0
    buffer_load_dwordx4 v219, s[32:35], s51 offen lds
    v_mfma_f32_16x16x32_bf16 v[56:59], v[184:187], v[160:163], v[56:59]
    ds_read_b64_tr_b16 v[176:177], v195 offset:256
    v_mfma_f32_16x16x32_bf16 v[60:63], v[184:187], v[164:167], v[60:63]
    ds_read_b64_tr_b16 v[178:179], v195 offset:2048
    s_add_u32 m0, s54, 0
    s_add_u32 s53, s50, 0
    buffer_load_dwordx4 v218, s[28:31], s53 offen lds
    v_mfma_f32_16x16x32_bf16 v[64:67], v[188:191], v[160:163], v[64:67]
    ds_read_b64_tr_b16 v[180:181], v196 offset:256
    v_mfma_f32_16x16x32_bf16 v[68:71], v[188:191], v[164:167], v[68:71]
    ds_read_b64_tr_b16 v[182:183], v196 offset:2048
    s_add_u32 m0, s55, 1024
    s_nop 0
    buffer_load_dwordx4 v220, s[32:35], s51 offen lds
    s_waitcnt lgkmcnt(6)
    v_mfma_f32_16x16x32_bf16 v[24:27], v[168:171], v[152:155], v[24:27]
    ds_read_b128 v[160:163], v193 offset:0
    v_mfma_f32_16x16x32_bf16 v[28:31], v[168:171], v[156:159], v[28:31]
    ds_read_b128 v[164:167], v193 offset:2048
    ds_read_b64_tr_b16 v[184:185], v195 offset:512
    ds_read_b64_tr_b16 v[186:187], v195 offset:2304
    s_add_u32 m0, s55, 2048
    s_nop 0
    buffer_load_dwordx4 v221, s[32:35], s51 offen lds
    s_lshl_b32 s65, s44, 5
    v_add_u32 v140, s65, v1
    s_mov_b32 s90, 0xffff0000
    s_waitcnt lgkmcnt(8)
    v_mfma_f32_16x16x32_bf16 v[32:35], v[172:175], v[152:155], v[32:35]
    ds_read_b64_tr_b16 v[188:189], v196 offset:512
    v_mfma_f32_16x16x32_bf16 v[36:39], v[172:175], v[156:159], v[36:39]
    ds_read_b64_tr_b16 v[190:191], v196 offset:2304
    s_add_u32 m0, s54, 4096
    s_add_u32 s53, s50, 40960
    buffer_load_dwordx4 v218, s[28:31], s53 offen lds
    s_mov_b32 s91, 0
    v_cndmask_b32 v208, v208, v212, s[90:91]
    s_mov_b32 s90, -1
    s_waitcnt lgkmcnt(8)
    v_mfma_f32_16x16x32_bf16 v[40:43], v[176:179], v[152:155], v[40:43]
    ds_read_b64_tr_b16 v[168:169], v195 offset:14336
    v_mfma_f32_16x16x32_bf16 v[44:47], v[176:179], v[156:159], v[44:47]
    ds_read_b64_tr_b16 v[170:171], v195 offset:16128
    s_add_u32 m0, s55, 3072
    s_nop 0
    buffer_load_dwordx4 v222, s[32:35], s51 offen lds
    s_lshl_b32 s65, s49, 2
    s_add_u32 s65, s65, 12803584
    s_lshl_b32 s66, s47, 3
    s_waitcnt lgkmcnt(8)
    v_mfma_f32_16x16x32_bf16 v[48:51], v[180:183], v[152:155], v[48:51]
    ds_read_b64_tr_b16 v[172:173], v196 offset:14336
    v_mfma_f32_16x16x32_bf16 v[52:55], v[180:183], v[156:159], v[52:55]
    ds_read_b64_tr_b16 v[174:175], v196 offset:16128
    s_add_u32 m0, s55, 4096
    s_nop 0
    buffer_load_dwordx4 v223, s[32:35], s51 offen lds
    s_add_u32 s66, s66, s44
    s_sub_u32 s66, s66, 56
    s_cmp_lt_u32 s66, 2
    s_cselect_b32 s65, 2130706432, s65
    s_waitcnt lgkmcnt(6)
    v_mfma_f32_16x16x32_bf16 v[56:59], v[184:187], v[152:155], v[56:59]
    ds_read_b64_tr_b16 v[176:177], v195 offset:14592
    v_mfma_f32_16x16x32_bf16 v[60:63], v[184:187], v[156:159], v[60:63]
    ds_read_b64_tr_b16 v[178:179], v195 offset:16384
    s_add_u32 m0, s54, 8192
    s_add_u32 s53, s50, 81920
    buffer_load_dwordx4 v218, s[28:31], s53 offen lds
    s_cmp_eq_u32 s44, 7
    s_cselect_b32 s65, 2130706432, s65
    s_cmp_ge_u32 s46, 10
    s_cselect_b32 s65, 2130706432, s65
    v_lshlrev_b32 v140, 2, v140
    s_waitcnt lgkmcnt(6)
    v_mfma_f32_16x16x32_bf16 v[64:67], v[188:191], v[152:155], v[64:67]
    ds_read_b64_tr_b16 v[180:181], v196 offset:14592
    v_mfma_f32_16x16x32_bf16 v[68:71], v[188:191], v[156:159], v[68:71]
    ds_read_b64_tr_b16 v[182:183], v196 offset:16384
    s_add_u32 m0, s55, 5120
    s_nop 0
    buffer_load_dwordx4 v224, s[32:35], s51 offen lds
    v_mov_b32 v141, 2130706432
    v_cndmask_b32 v140, v141, v140, s[90:91]
    buffer_atomic_add_f32 v208, v140, s[36:39], s65 offen
    s_waitcnt lgkmcnt(6)
    v_mfma_f32_16x16x32_bf16 v[24:27], v[168:171], v[160:163], v[24:27]
    ds_read_b64_tr_b16 v[184:185], v195 offset:14848
    v_mfma_f32_16x16x32_bf16 v[28:31], v[168:171], v[164:167], v[28:31]
    ds_read_b64_tr_b16 v[186:187], v195 offset:16640
    s_add_u32 m0, s55, 6144
    s_nop 0
    buffer_load_dwordx4 v225, s[32:35], s51 offen lds
    s_waitcnt lgkmcnt(6)
    v_mfma_f32_16x16x32_bf16 v[32:35], v[172:175], v[160:163], v[32:35]
    ds_read_b64_tr_b16 v[188:189], v196 offset:14848
    v_mfma_f32_16x16x32_bf16 v[36:39], v[172:175], v[164:167], v[36:39]
    ds_read_b64_tr_b16 v[190:191], v196 offset:16640
    v_add_u32 v192, 98304, v194
    v_add_u32 v195, 98304, v197
    v_xor_b32 v193, 64, v192
    v_xor_b32 v196, 32, v195
    s_add_u32 m0, s54, 12288
    s_add_u32 s53, s50, 122880
    buffer_load_dwordx4 v218, s[28:31], s53 offen lds
    s_waitcnt lgkmcnt(6)
    v_mfma_f32_16x16x32_bf16 v[40:43], v[176:179], v[160:163], v[40:43]
    v_mfma_f32_16x16x32_bf16 v[44:47], v[176:179], v[164:167], v[44:47]
    s_waitcnt vmcnt(12) lgkmcnt(0)
    s_barrier
    ds_read_b128 v[152:155], v192 offset:0
    ds_read_b128 v[156:159], v192 offset:2048
    ds_read_b64_tr_b16 v[168:169], v195 offset:0
    ds_read_b64_tr_b16 v[170:171], v195 offset:1792
    ds_read_b64_tr_b16 v[172:173], v196 offset:0
    ds_read_b64_tr_b16 v[174:175], v196 offset:1792
    v_mfma_f32_16x16x32_bf16 v[48:51], v[180:183], v[160:163], v[48:51]
    v_mfma_f32_16x16x32_bf16 v[52:55], v[180:183], v[164:167], v[52:55]
    s_add_u32 s50, s50, 128
    s_add_u32 s51, s51, 221184
    s_cmp_eq_u32 s50, 1280
    s_cselect_b32 s50, 0, s50
    s_cselect_b32 s51, 0, s51
    s_add_u32 m0, s55, 49152
    s_nop 0
    buffer_load_dwordx4 v219, s[32:35], s51 offen lds
    v_mfma_f32_16x16x32_bf16 v[56:59], v[184:187], v[160:163], v[56:59]
    ds_read_b64_tr_b16 v[176:177], v195 offset:256
    v_mfma_f32_16x16x32_bf16 v[60:63], v[184:187], v[164:167], v[60:63]
    ds_read_b64_tr_b16 v[178:179], v195 offset:2048
    s_add_u32 m0, s54, 49152
    s_add_u32 s53, s50, 0
    buffer_load_dwordx4 v218, s[28:31], s53 offen lds
    v_mfma_f32_16x16x32_bf16 v[64:67], v[188:191], v[160:163], v[64:67]
    ds_read_b64_tr_b16 v[180:181], v196 offset:256
    v_mfma_f32_16x16x32_bf16 v[68:71], v[188:191], v[164:167], v[68:71]
    ds_read_b64_tr_b16 v[182:183], v196 offset:2048
    s_add_u32 m0, s55, 50176
    s_nop 0
    buffer_load_dwordx4 v220, s[32:35], s51 offen lds
    s_waitcnt lgkmcnt(6)
    v_mfma_f32_16x16x32_bf16 v[24:27], v[168:171], v[152:155], v[24:27]
    ds_read_b128 v[160:163], v193 offset:0
    v_mfma_f32_16x16x32_bf16 v[28:31], v[168:171], v[156:159], v[28:31]
    ds_read_b128 v[164:167], v193 offset:2048
    ds_read_b64_tr_b16 v[184:185], v195 offset:512
    ds_read_b64_tr_b16 v[186:187], v195 offset:2304
    s_add_u32 m0, s55, 51200
    s_nop 0
    buffer_load_dwordx4 v221, s[32:35], s51 offen lds
    s_waitcnt lgkmcnt(8)
    v_mfma_f32_16x16x32_bf16 v[32:35], v[172:175], v[152:155], v[32:35]
    ds_read_b64_tr_b16 v[188:189], v196 offset:512
    v_mfma_f32_16x16x32_bf16 v[36:39], v[172:175], v[156:159], v[36:39]
    ds_read_b64_tr_b16 v[190:191], v196 offset:2304
    s_add_u32 m0, s54, 53248
    s_add_u32 s53, s50, 40960
    buffer_load_dwordx4 v218, s[28:31], s53 offen lds
    s_waitcnt lgkmcnt(8)
    v_mfma_f32_16x16x32_bf16 v[40:43], v[176:179], v[152:155], v[40:43]
    ds_read_b64_tr_b16 v[168:169], v195 offset:14336
    v_mfma_f32_16x16x32_bf16 v[44:47], v[176:179], v[156:159], v[44:47]
    ds_read_b64_tr_b16 v[170:171], v195 offset:16128
    s_add_u32 m0, s55, 52224
    s_nop 0
    buffer_load_dwordx4 v222, s[32:35], s51 offen lds
    s_waitcnt lgkmcnt(8)
    v_mfma_f32_16x16x32_bf16 v[48:51], v[180:183], v[152:155], v[48:51]
    ds_read_b64_tr_b16 v[172:173], v196 offset:14336
    v_mfma_f32_16x16x32_bf16 v[52:55], v[180:183], v[156:159], v[52:55]
    ds_read_b64_tr_b16 v[174:175], v196 offset:16128
    s_add_u32 m0, s55, 53248
    s_nop 0
    buffer_load_dwordx4 v223, s[32:35], s51 offen lds
    s_waitcnt lgkmcnt(6)
    v_mfma_f32_16x16x32_bf16 v[56:59], v[184:187], v[152:155], v[56:59]
    ds_read_b64_tr_b16 v[176:177], v195 offset:14592
    v_mfma_f32_16x16x32_bf16 v[60:63], v[184:187], v[156:159], v[60:63]
    ds_read_b64_tr_b16 v[178:179], v195 offset:16384
    s_add_u32 m0, s54, 57344
    s_add_u32 s53, s50, 81920
    buffer_load_dwordx4 v218, s[28:31], s53 offen lds
    s_waitcnt lgkmcnt(6)
    v_mfma_f32_16x16x32_bf16 v[64:67], v[188:191], v[152:155], v[64:67]
    ds_read_b64_tr_b16 v[180:181], v196 offset:14592
    v_mfma_f32_16x16x32_bf16 v[68:71], v[188:191], v[156:159], v[68:71]
    ds_read_b64_tr_b16 v[182:183], v196 offset:16384
    s_add_u32 m0, s55, 54272
    s_nop 0
    buffer_load_dwordx4 v224, s[32:35], s51 offen lds
    s_waitcnt lgkmcnt(6)
    v_mfma_f32_16x16x32_bf16 v[24:27], v[168:171], v[160:163], v[24:27]
    ds_read_b64_tr_b16 v[184:185], v195 offset:14848
    v_mfma_f32_16x16x32_bf16 v[28:31], v[168:171], v[164:167], v[28:31]
    ds_read_b64_tr_b16 v[186:187], v195 offset:16640
    s_add_u32 m0, s55, 55296
    s_nop 0
    buffer_load_dwordx4 v225, s[32:35], s51 offen lds
    s_waitcnt lgkmcnt(6)
    v_mfma_f32_16x16x32_bf16 v[32:35], v[172:175], v[160:163], v[32:35]
    ds_read_b64_tr_b16 v[188:189], v196 offset:14848
    v_mfma_f32_16x16x32_bf16 v[36:39], v[172:175], v[164:167], v[36:39]
    ds_read_b64_tr_b16 v[190:191], v196 offset:16640
    v_add_u32 v192, 0, v194
    v_add_u32 v195, 0, v197
    v_xor_b32 v193, 64, v192
    v_xor_b32 v196, 32, v195
    s_add_u32 m0, s54, 61440
    s_add_u32 s53, s50, 122880
    buffer_load_dwordx4 v218, s[28:31], s53 offen lds
    s_waitcnt lgkmcnt(6)
    v_mfma_f32_16x16x32_bf16 v[40:43], v[176:179], v[160:163], v[40:43]
    v_mfma_f32_16x16x32_bf16 v[44:47], v[176:179], v[164:167], v[44:47]
    s_waitcnt vmcnt(11) lgkmcnt(0)
    s_barrier
    ds_read_b128 v[152:155], v192 offset:0
    ds_read_b128 v[156:159], v192 offset:2048
    ds_read_b64_tr_b16 v[168:169], v195 offset:0
    ds_read_b64_tr_b16 v[170:171], v195 offset:1792
    ds_read_b64_tr_b16 v[172:173], v196 offset:0
    ds_read_b64_tr_b16 v[174:175], v196 offset:1792
    v_mfma_f32_16x16x32_bf16 v[48:51], v[180:183], v[160:163], v[48:51]
    v_mfma_f32_16x16x32_bf16 v[52:55], v[180:183], v[164:167], v[52:55]
    s_add_u32 s50, s50, 128
    s_add_u32 s51, s51, 221184
    s_cmp_eq_u32 s50, 1280
    s_cselect_b32 s50, 0, s50
    s_cselect_b32 s51, 0, s51
    s_add_u32 m0, s55, 98304
    s_nop 0
    buffer_load_dwordx4 v219, s[32:35], s51 offen lds
    v_mfma_f32_16x16x32_bf16 v[56:59], v[184:187], v[160:163], v[56:59]
    ds_read_b64_tr_b16 v[176:177], v195 offset:256
    v_mfma_f32_16x16x32_bf16 v[60:63], v[184:187], v[164:167], v[60:63]
    ds_read_b64_tr_b16 v[178:179], v195 offset:2048
    s_add_u32 m0, s54, 98304
    s_add_u32 s53, s50, 0
    buffer_load_dwordx4 v218, s[28:31], s53 offen lds
    v_mfma_f32_16x16x32_bf16 v[64:67], v[188:191], v[160:163], v[64:67]
    ds_read_b64_tr_b16 v[180:181], v196 offset:256
    v_mfma_f32_16x16x32_bf16 v[68:71], v[188:191], v[164:167], v[68:71]
    ds_read_b64_tr_b16 v[182:183], v196 offset:2048
    s_add_u32 m0, s55, 99328
    s_nop 0
    buffer_load_dwordx4 v220, s[32:35], s51 offen lds
    s_waitcnt lgkmcnt(6)
    v_mfma_f32_16x16x32_bf16 v[24:27], v[168:171], v[152:155], v[24:27]
    ds_read_b128 v[160:163], v193 offset:0
    v_mfma_f32_16x16x32_bf16 v[28:31], v[168:171], v[156:159], v[28:31]
    ds_read_b128 v[164:167], v193 offset:2048
    ds_read_b64_tr_b16 v[184:185], v195 offset:512
    ds_read_b64_tr_b16 v[186:187], v195 offset:2304
    s_add_u32 m0, s55, 100352
    s_nop 0
    buffer_load_dwordx4 v221, s[32:35], s51 offen lds
    s_waitcnt lgkmcnt(8)
    v_mfma_f32_16x16x32_bf16 v[32:35], v[172:175], v[152:155], v[32:35]
    ds_read_b64_tr_b16 v[188:189], v196 offset:512
    v_mfma_f32_16x16x32_bf16 v[36:39], v[172:175], v[156:159], v[36:39]
    ds_read_b64_tr_b16 v[190:191], v196 offset:2304
    s_add_u32 m0, s54, 102400
    s_add_u32 s53, s50, 40960
    buffer_load_dwordx4 v218, s[28:31], s53 offen lds
    s_waitcnt lgkmcnt(8)
    v_mfma_f32_16x16x32_bf16 v[40:43], v[176:179], v[152:155], v[40:43]
    ds_read_b64_tr_b16 v[168:169], v195 offset:14336
    v_mfma_f32_16x16x32_bf16 v[44:47], v[176:179], v[156:159], v[44:47]
    ds_read_b64_tr_b16 v[170:171], v195 offset:16128
    s_add_u32 m0, s55, 101376
    s_nop 0
    buffer_load_dwordx4 v222, s[32:35], s51 offen lds
    s_waitcnt lgkmcnt(8)
    v_mfma_f32_16x16x32_bf16 v[48:51], v[180:183], v[152:155], v[48:51]
    ds_read_b64_tr_b16 v[172:173], v196 offset:14336
    v_mfma_f32_16x16x32_bf16 v[52:55], v[180:183], v[156:159], v[52:55]
    ds_read_b64_tr_b16 v[174:175], v196 offset:16128
    s_add_u32 m0, s55, 102400
    s_nop 0
    buffer_load_dwordx4 v223, s[32:35], s51 offen lds
    s_waitcnt lgkmcnt(6)
    v_mfma_f32_16x16x32_bf16 v[56:59], v[184:187], v[152:155], v[56:59]
    ds_read_b64_tr_b16 v[176:177], v195 offset:14592
    v_mfma_f32_16x16x32_bf16 v[60:63], v[184:187], v[156:159], v[60:63]
    ds_read_b64_tr_b16 v[178:179], v195 offset:16384
    s_add_u32 m0, s54, 106496
    s_add_u32 s53, s50, 81920
    buffer_load_dwordx4 v218, s[28:31], s53 offen lds
    s_waitcnt lgkmcnt(6)
    v_mfma_f32_16x16x32_bf16 v[64:67], v[188:191], v[152:155], v[64:67]
    ds_read_b64_tr_b16 v[180:181], v196 offset:14592
    v_mfma_f32_16x16x32_bf16 v[68:71], v[188:191], v[156:159], v[68:71]
    ds_read_b64_tr_b16 v[182:183], v196 offset:16384
    s_add_u32 m0, s55, 103424
    s_nop 0
    buffer_load_dwordx4 v224, s[32:35], s51 offen lds
    s_waitcnt lgkmcnt(6)
    v_mfma_f32_16x16x32_bf16 v[24:27], v[168:171], v[160:163], v[24:27]
    ds_read_b64_tr_b16 v[184:185], v195 offset:14848
    v_mfma_f32_16x16x32_bf16 v[28:31], v[168:171], v[164:167], v[28:31]
    ds_read_b64_tr_b16 v[186:187], v195 offset:16640
    s_add_u32 m0, s55, 104448
    s_nop 0
    buffer_load_dwordx4 v225, s[32:35], s51 offen lds
    s_waitcnt lgkmcnt(6)
    v_mfma_f32_16x16x32_bf16 v[32:35], v[172:175], v[160:163], v[32:35]
    ds_read_b64_tr_b16 v[188:189], v196 offset:14848
    v_mfma_f32_16x16x32_bf16 v[36:39], v[172:175], v[164:167], v[36:39]
    ds_read_b64_tr_b16 v[190:191], v196 offset:16640
    v_add_u32 v192, 49152, v194
    v_add_u32 v195, 49152, v197
    v_xor_b32 v193, 64, v192
    v_xor_b32 v196, 32, v195
    s_add_u32 m0, s54, 110592
    s_add_u32 s53, s50, 122880
    buffer_load_dwordx4 v218, s[28:31], s53 offen lds
    s_waitcnt lgkmcnt(6)
    v_mfma_f32_16x16x32_bf16 v[40:43], v[176:179], v[160:163], v[40:43]
    v_mfma_f32_16x16x32_bf16 v[44:47], v[176:179], v[164:167], v[44:47]
    s_waitcnt vmcnt(11) lgkmcnt(0)
    s_barrier
    ds_read_b128 v[152:155], v192 offset:0
    ds_read_b128 v[156:159], v192 offset:2048
    ds_read_b64_tr_b16 v[168:169], v195 offset:0
    ds_read_b64_tr_b16 v[170:171], v195 offset:1792
    ds_read_b64_tr_b16 v[172:173], v196 offset:0
    ds_read_b64_tr_b16 v[174:175], v196 offset:1792
    v_mfma_f32_16x16x32_bf16 v[48:51], v[180:183], v[160:163], v[48:51]
    v_mfma_f32_16x16x32_bf16 v[52:55], v[180:183], v[164:167], v[52:55]
    s_add_u32 s50, s50, 128
    s_add_u32 s51, s51, 221184
    s_cmp_eq_u32 s50, 1280
    s_cselect_b32 s50, 0, s50
    s_cselect_b32 s51, 0, s51
    s_add_u32 m0, s55, 0
    s_nop 0
    buffer_load_dwordx4 v219, s[32:35], s51 offen lds
    v_mfma_f32_16x16x32_bf16 v[56:59], v[184:187], v[160:163], v[56:59]
    ds_read_b64_tr_b16 v[176:177], v195 offset:256
    v_mfma_f32_16x16x32_bf16 v[60:63], v[184:187], v[164:167], v[60:63]
    ds_read_b64_tr_b16 v[178:179], v195 offset:2048
    s_add_u32 m0, s54, 0
    s_add_u32 s53, s50, 0
    buffer_load_dwordx4 v218, s[28:31], s53 offen lds
    v_mfma_f32_16x16x32_bf16 v[64:67], v[188:191], v[160:163], v[64:67]
    ds_read_b64_tr_b16 v[180:181], v196 offset:256
    v_mfma_f32_16x16x32_bf16 v[68:71], v[188:191], v[164:167], v[68:71]
    ds_read_b64_tr_b16 v[182:183], v196 offset:2048
    s_add_u32 m0, s55, 1024
    s_nop 0
    buffer_load_dwordx4 v220, s[32:35], s51 offen lds
    s_waitcnt lgkmcnt(6)
    v_mfma_f32_16x16x32_bf16 v[24:27], v[168:171], v[152:155], v[24:27]
    ds_read_b128 v[160:163], v193 offset:0
    v_mfma_f32_16x16x32_bf16 v[28:31], v[168:171], v[156:159], v[28:31]
    ds_read_b128 v[164:167], v193 offset:2048
    ds_read_b64_tr_b16 v[184:185], v195 offset:512
    ds_read_b64_tr_b16 v[186:187], v195 offset:2304
    s_add_u32 m0, s55, 2048
    s_nop 0
    buffer_load_dwordx4 v221, s[32:35], s51 offen lds
    s_waitcnt lgkmcnt(8)
    v_mfma_f32_16x16x32_bf16 v[32:35], v[172:175], v[152:155], v[32:35]
    ds_read_b64_tr_b16 v[188:189], v196 offset:512
    v_mfma_f32_16x16x32_bf16 v[36:39], v[172:175], v[156:159], v[36:39]
    ds_read_b64_tr_b16 v[190:191], v196 offset:2304
    s_add_u32 m0, s54, 4096
    s_add_u32 s53, s50, 40960
    buffer_load_dwordx4 v218, s[28:31], s53 offen lds
    s_waitcnt lgkmcnt(8)
    v_mfma_f32_16x16x32_bf16 v[40:43], v[176:179], v[152:155], v[40:43]
    ds_read_b64_tr_b16 v[168:169], v195 offset:14336
    v_mfma_f32_16x16x32_bf16 v[44:47], v[176:179], v[156:159], v[44:47]
    ds_read_b64_tr_b16 v[170:171], v195 offset:16128
    s_add_u32 m0, s55, 3072
    s_nop 0
    buffer_load_dwordx4 v222, s[32:35], s51 offen lds
    s_waitcnt lgkmcnt(8)
    v_mfma_f32_16x16x32_bf16 v[48:51], v[180:183], v[152:155], v[48:51]
    ds_read_b64_tr_b16 v[172:173], v196 offset:14336
    v_mfma_f32_16x16x32_bf16 v[52:55], v[180:183], v[156:159], v[52:55]
    ds_read_b64_tr_b16 v[174:175], v196 offset:16128
    s_add_u32 m0, s55, 4096
    s_nop 0
    buffer_load_dwordx4 v223, s[32:35], s51 offen lds
    s_waitcnt lgkmcnt(6)
    v_mfma_f32_16x16x32_bf16 v[56:59], v[184:187], v[152:155], v[56:59]
    ds_read_b64_tr_b16 v[176:177], v195 offset:14592
    v_mfma_f32_16x16x32_bf16 v[60:63], v[184:187], v[156:159], v[60:63]
    ds_read_b64_tr_b16 v[178:179], v195 offset:16384
    s_add_u32 m0, s54, 8192
    s_add_u32 s53, s50, 81920
    buffer_load_dwordx4 v218, s[28:31], s53 offen lds
    s_waitcnt lgkmcnt(6)
    v_mfma_f32_16x16x32_bf16 v[64:67], v[188:191], v[152:155], v[64:67]
    ds_read_b64_tr_b16 v[180:181], v196 offset:14592
    v_mfma_f32_16x16x32_bf16 v[68:71], v[188:191], v[156:159], v[68:71]
    ds_read_b64_tr_b16 v[182:183], v196 offset:16384
    s_add_u32 m0, s55, 5120
    s_nop 0
    buffer_load_dwordx4 v224, s[32:35], s51 offen lds
    s_waitcnt lgkmcnt(6)
    v_mfma_f32_16x16x32_bf16 v[24:27], v[168:171], v[160:163], v[24:27]
    ds_read_b64_tr_b16 v[184:185], v195 offset:14848
    v_mfma_f32_16x16x32_bf16 v[28:31], v[168:171], v[164:167], v[28:31]
    ds_read_b64_tr_b16 v[186:187], v195 offset:16640
    s_add_u32 m0, s55, 6144
    s_nop 0
    buffer_load_dwordx4 v225, s[32:35], s51 offen lds
    s_waitcnt lgkmcnt(6)
    v_mfma_f32_16x16x32_bf16 v[32:35], v[172:175], v[160:163], v[32:35]
    ds_read_b64_tr_b16 v[188:189], v196 offset:14848
    v_mfma_f32_16x16x32_bf16 v[36:39], v[172:175], v[164:167], v[36:39]
    ds_read_b64_tr_b16 v[190:191], v196 offset:16640
    v_add_u32 v192, 98304, v194
    v_add_u32 v195, 98304, v197
    v_xor_b32 v193, 64, v192
    v_xor_b32 v196, 32, v195
    s_add_u32 m0, s54, 12288
    s_add_u32 s53, s50, 122880
    buffer_load_dwordx4 v218, s[28:31], s53 offen lds
    s_waitcnt lgkmcnt(6)
    v_mfma_f32_16x16x32_bf16 v[40:43], v[176:179], v[160:163], v[40:43]
    v_mfma_f32_16x16x32_bf16 v[44:47], v[176:179], v[164:167], v[44:47]
    s_waitcnt vmcnt(11) lgkmcnt(0)
    s_barrier
    ds_read_b128 v[152:155], v192 offset:0
    ds_read_b128 v[156:159], v192 offset:2048
    ds_read_b64_tr_b16 v[168:169], v195 offset:0
    ds_read_b64_tr_b16 v[170:171], v195 offset:1792
    ds_read_b64_tr_b16 v[172:173], v196 offset:0
    ds_read_b64_tr_b16 v[174:175], v196 offset:1792
    v_mfma_f32_16x16x32_bf16 v[48:51], v[180:183], v[160:163], v[48:51]
    v_mfma_f32_16x16x32_bf16 v[52:55], v[180:183], v[164:167], v[52:55]
    s_add_u32 s50, s50, 128
    s_add_u32 s51, s51, 221184
    s_cmp_eq_u32 s50, 1280
    s_cselect_b32 s50, 0, s50
    s_cselect_b32 s51, 0, s51
    s_add_u32 m0, s55, 49152
    s_nop 0
    buffer_load_dwordx4 v219, s[32:35], s51 offen lds
    v_mfma_f32_16x16x32_bf16 v[56:59], v[184:187], v[160:163], v[56:59]
    ds_read_b64_tr_b16 v[176:177], v195 offset:256
    v_mfma_f32_16x16x32_bf16 v[60:63], v[184:187], v[164:167], v[60:63]
    ds_read_b64_tr_b16 v[178:179], v195 offset:2048
    s_add_u32 m0, s54, 49152
    s_add_u32 s53, s50, 0
    buffer_load_dwordx4 v218, s[28:31], s53 offen lds
    v_mfma_f32_16x16x32_bf16 v[64:67], v[188:191], v[160:163], v[64:67]
    ds_read_b64_tr_b16 v[180:181], v196 offset:256
    v_mfma_f32_16x16x32_bf16 v[68:71], v[188:191], v[164:167], v[68:71]
    ds_read_b64_tr_b16 v[182:183], v196 offset:2048
    s_add_u32 m0, s55, 50176
    s_nop 0
    buffer_load_dwordx4 v220, s[32:35], s51 offen lds
    s_waitcnt lgkmcnt(6)
    v_mfma_f32_16x16x32_bf16 v[24:27], v[168:171], v[152:155], v[24:27]
    ds_read_b128 v[160:163], v193 offset:0
    v_mfma_f32_16x16x32_bf16 v[28:31], v[168:171], v[156:159], v[28:31]
    ds_read_b128 v[164:167], v193 offset:2048
    ds_read_b64_tr_b16 v[184:185], v195 offset:512
    ds_read_b64_tr_b16 v[186:187], v195 offset:2304
    s_add_u32 m0, s55, 51200
    s_nop 0
    buffer_load_dwordx4 v221, s[32:35], s51 offen lds
    s_waitcnt lgkmcnt(8)
    v_mfma_f32_16x16x32_bf16 v[32:35], v[172:175], v[152:155], v[32:35]
    ds_read_b64_tr_b16 v[188:189], v196 offset:512
    v_mfma_f32_16x16x32_bf16 v[36:39], v[172:175], v[156:159], v[36:39]
    ds_read_b64_tr_b16 v[190:191], v196 offset:2304
    s_add_u32 m0, s54, 53248
    s_add_u32 s53, s50, 40960
    buffer_load_dwordx4 v218, s[28:31], s53 offen lds
    s_waitcnt lgkmcnt(8)
    v_mfma_f32_16x16x32_bf16 v[40:43], v[176:179], v[152:155], v[40:43]
    ds_read_b64_tr_b16 v[168:169], v195 offset:14336
    v_mfma_f32_16x16x32_bf16 v[44:47], v[176:179], v[156:159], v[44:47]
    ds_read_b64_tr_b16 v[170:171], v195 offset:16128
    s_add_u32 m0, s55, 52224
    s_nop 0
    buffer_load_dwordx4 v222, s[32:35], s51 offen lds
    s_waitcnt lgkmcnt(8)
    v_mfma_f32_16x16x32_bf16 v[48:51], v[180:183], v[152:155], v[48:51]
    ds_read_b64_tr_b16 v[172:173], v196 offset:14336
    v_mfma_f32_16x16x32_bf16 v[52:55], v[180:183], v[156:159], v[52:55]
    ds_read_b64_tr_b16 v[174:175], v196 offset:16128
    s_add_u32 m0, s55, 53248
    s_nop 0
    buffer_load_dwordx4 v223, s[32:35], s51 offen lds
    s_waitcnt lgkmcnt(6)
    v_mfma_f32_16x16x32_bf16 v[56:59], v[184:187], v[152:155], v[56:59]
    ds_read_b64_tr_b16 v[176:177], v195 offset:14592
    v_mfma_f32_16x16x32_bf16 v[60:63], v[184:187], v[156:159], v[60:63]
    ds_read_b64_tr_b16 v[178:179], v195 offset:16384
    s_add_u32 m0, s54, 57344
    s_add_u32 s53, s50, 81920
    buffer_load_dwordx4 v218, s[28:31], s53 offen lds
    s_waitcnt lgkmcnt(6)
    v_mfma_f32_16x16x32_bf16 v[64:67], v[188:191], v[152:155], v[64:67]
    ds_read_b64_tr_b16 v[180:181], v196 offset:14592
    v_mfma_f32_16x16x32_bf16 v[68:71], v[188:191], v[156:159], v[68:71]
    ds_read_b64_tr_b16 v[182:183], v196 offset:16384
    s_add_u32 m0, s55, 54272
    s_nop 0
    buffer_load_dwordx4 v224, s[32:35], s51 offen lds
    s_waitcnt lgkmcnt(6)
    v_mfma_f32_16x16x32_bf16 v[24:27], v[168:171], v[160:163], v[24:27]
    ds_read_b64_tr_b16 v[184:185], v195 offset:14848
    v_mfma_f32_16x16x32_bf16 v[28:31], v[168:171], v[164:167], v[28:31]
    ds_read_b64_tr_b16 v[186:187], v195 offset:16640
    s_add_u32 m0, s55, 55296
    s_nop 0
    buffer_load_dwordx4 v225, s[32:35], s51 offen lds
    s_waitcnt lgkmcnt(6)
    v_mfma_f32_16x16x32_bf16 v[32:35], v[172:175], v[160:163], v[32:35]
    ds_read_b64_tr_b16 v[188:189], v196 offset:14848
    v_mfma_f32_16x16x32_bf16 v[36:39], v[172:175], v[164:167], v[36:39]
    ds_read_b64_tr_b16 v[190:191], v196 offset:16640
    v_add_u32 v192, 0, v194
    v_add_u32 v195, 0, v197
    v_xor_b32 v193, 64, v192
    v_xor_b32 v196, 32, v195
    s_add_u32 m0, s54, 61440
    s_add_u32 s53, s50, 122880
    buffer_load_dwordx4 v218, s[28:31], s53 offen lds
    s_waitcnt lgkmcnt(6)
    v_mfma_f32_16x16x32_bf16 v[40:43], v[176:179], v[160:163], v[40:43]
    v_mfma_f32_16x16x32_bf16 v[44:47], v[176:179], v[164:167], v[44:47]
    s_waitcnt vmcnt(11) lgkmcnt(0)
    s_barrier
    ds_read_b128 v[152:155], v192 offset:0
    ds_read_b128 v[156:159], v192 offset:2048
    ds_read_b64_tr_b16 v[168:169], v195 offset:0
    ds_read_b64_tr_b16 v[170:171], v195 offset:1792
    ds_read_b64_tr_b16 v[172:173], v196 offset:0
    ds_read_b64_tr_b16 v[174:175], v196 offset:1792
    v_mfma_f32_16x16x32_bf16 v[48:51], v[180:183], v[160:163], v[48:51]
    v_mfma_f32_16x16x32_bf16 v[52:55], v[180:183], v[164:167], v[52:55]
    s_add_u32 s50, s50, 128
    s_add_u32 s51, s51, 221184
    s_cmp_eq_u32 s50, 1280
    s_cselect_b32 s50, 0, s50
    s_cselect_b32 s51, 0, s51
    s_add_u32 m0, s55, 98304
    s_nop 0
    buffer_load_dwordx4 v219, s[32:35], s51 offen lds
    v_mfma_f32_16x16x32_bf16 v[56:59], v[184:187], v[160:163], v[56:59]
    ds_read_b64_tr_b16 v[176:177], v195 offset:256
    v_mfma_f32_16x16x32_bf16 v[60:63], v[184:187], v[164:167], v[60:63]
    ds_read_b64_tr_b16 v[178:179], v195 offset:2048
    s_add_u32 m0, s54, 98304
    s_add_u32 s53, s50, 0
    buffer_load_dwordx4 v218, s[28:31], s53 offen lds
    v_mfma_f32_16x16x32_bf16 v[64:67], v[188:191], v[160:163], v[64:67]
    ds_read_b64_tr_b16 v[180:181], v196 offset:256
    v_mfma_f32_16x16x32_bf16 v[68:71], v[188:191], v[164:167], v[68:71]
    ds_read_b64_tr_b16 v[182:183], v196 offset:2048
    s_add_u32 m0, s55, 99328
    s_nop 0
    buffer_load_dwordx4 v220, s[32:35], s51 offen lds
    s_waitcnt lgkmcnt(6)
    v_mfma_f32_16x16x32_bf16 v[24:27], v[168:171], v[152:155], v[24:27]
    ds_read_b128 v[160:163], v193 offset:0
    v_mfma_f32_16x16x32_bf16 v[28:31], v[168:171], v[156:159], v[28:31]
    ds_read_b128 v[164:167], v193 offset:2048
    ds_read_b64_tr_b16 v[184:185], v195 offset:512
    ds_read_b64_tr_b16 v[186:187], v195 offset:2304
    s_add_u32 m0, s55, 100352
    s_nop 0
    buffer_load_dwordx4 v221, s[32:35], s51 offen lds
    s_waitcnt lgkmcnt(8)
    v_mfma_f32_16x16x32_bf16 v[32:35], v[172:175], v[152:155], v[32:35]
    ds_read_b64_tr_b16 v[188:189], v196 offset:512
    v_mfma_f32_16x16x32_bf16 v[36:39], v[172:175], v[156:159], v[36:39]
    ds_read_b64_tr_b16 v[190:191], v196 offset:2304
    s_add_u32 m0, s54, 102400
    s_add_u32 s53, s50, 40960
    buffer_load_dwordx4 v218, s[28:31], s53 offen lds
    s_waitcnt lgkmcnt(8)
    v_mfma_f32_16x16x32_bf16 v[40:43], v[176:179], v[152:155], v[40:43]
    ds_read_b64_tr_b16 v[168:169], v195 offset:14336
    v_mfma_f32_16x16x32_bf16 v[44:47], v[176:179], v[156:159], v[44:47]
    ds_read_b64_tr_b16 v[170:171], v195 offset:16128
    s_add_u32 m0, s55, 101376
    s_nop 0
    buffer_load_dwordx4 v222, s[32:35], s51 offen lds
    s_waitcnt lgkmcnt(8)
    v_mfma_f32_16x16x32_bf16 v[48:51], v[180:183], v[152:155], v[48:51]
    ds_read_b64_tr_b16 v[172:173], v196 offset:14336
    v_mfma_f32_16x16x32_bf16 v[52:55], v[180:183], v[156:159], v[52:55]
    ds_read_b64_tr_b16 v[174:175], v196 offset:16128
    s_add_u32 m0, s55, 102400
    s_nop 0
    buffer_load_dwordx4 v223, s[32:35], s51 offen lds
    s_waitcnt lgkmcnt(6)
    v_mfma_f32_16x16x32_bf16 v[56:59], v[184:187], v[152:155], v[56:59]
    ds_read_b64_tr_b16 v[176:177], v195 offset:14592
    v_mfma_f32_16x16x32_bf16 v[60:63], v[184:187], v[156:159], v[60:63]
    ds_read_b64_tr_b16 v[178:179], v195 offset:16384
    s_add_u32 m0, s54, 106496
    s_add_u32 s53, s50, 81920
    buffer_load_dwordx4 v218, s[28:31], s53 offen lds
    s_waitcnt lgkmcnt(6)
    v_mfma_f32_16x16x32_bf16 v[64:67], v[188:191], v[152:155], v[64:67]
    ds_read_b64_tr_b16 v[180:181], v196 offset:14592
    v_mfma_f32_16x16x32_bf16 v[68:71], v[188:191], v[156:159], v[68:71]
    ds_read_b64_tr_b16 v[182:183], v196 offset:16384
    s_add_u32 m0, s55, 103424
    s_nop 0
    buffer_load_dwordx4 v224, s[32:35], s51 offen lds
    s_waitcnt lgkmcnt(6)
    v_mfma_f32_16x16x32_bf16 v[24:27], v[168:171], v[160:163], v[24:27]
    ds_read_b64_tr_b16 v[184:185], v195 offset:14848
    v_mfma_f32_16x16x32_bf16 v[28:31], v[168:171], v[164:167], v[28:31]
    ds_read_b64_tr_b16 v[186:187], v195 offset:16640
    s_add_u32 m0, s55, 104448
    s_nop 0
    buffer_load_dwordx4 v225, s[32:35], s51 offen lds
    s_waitcnt lgkmcnt(6)
    v_mfma_f32_16x16x32_bf16 v[32:35], v[172:175], v[160:163], v[32:35]
    ds_read_b64_tr_b16 v[188:189], v196 offset:14848
    v_mfma_f32_16x16x32_bf16 v[36:39], v[172:175], v[164:167], v[36:39]
    ds_read_b64_tr_b16 v[190:191], v196 offset:16640
    v_add_u32 v192, 49152, v194
    v_add_u32 v195, 49152, v197
    v_xor_b32 v193, 64, v192
    v_xor_b32 v196, 32, v195
    s_add_u32 m0, s54, 110592
    s_add_u32 s53, s50, 122880
    buffer_load_dwordx4 v218, s[28:31], s53 offen lds
    s_waitcnt lgkmcnt(6)
    v_mfma_f32_16x16x32_bf16 v[40:43], v[176:179], v[160:163], v[40:43]
    v_mfma_f32_16x16x32_bf16 v[44:47], v[176:179], v[164:167], v[44:47]
    s_waitcnt vmcnt(11) lgkmcnt(0)
    s_barrier
    ds_read_b128 v[152:155], v192 offset:0
    ds_read_b128 v[156:159], v192 offset:2048
    ds_read_b64_tr_b16 v[168:169], v195 offset:0
    ds_read_b64_tr_b16 v[170:171], v195 offset:1792
    ds_read_b64_tr_b16 v[172:173], v196 offset:0
    ds_read_b64_tr_b16 v[174:175], v196 offset:1792
    v_mfma_f32_16x16x32_bf16 v[48:51], v[180:183], v[160:163], v[48:51]
    v_mfma_f32_16x16x32_bf16 v[52:55], v[180:183], v[164:167], v[52:55]
    s_add_u32 s50, s50, 128
    s_add_u32 s51, s51, 221184
    s_cmp_eq_u32 s50, 1280
    s_cselect_b32 s50, 0, s50
    s_cselect_b32 s51, 0, s51
    s_add_u32 m0, s55, 0
    s_nop 0
    buffer_load_dwordx4 v219, s[32:35], s51 offen lds
    v_mfma_f32_16x16x32_bf16 v[56:59], v[184:187], v[160:163], v[56:59]
    ds_read_b64_tr_b16 v[176:177], v195 offset:256
    v_mfma_f32_16x16x32_bf16 v[60:63], v[184:187], v[164:167], v[60:63]
    ds_read_b64_tr_b16 v[178:179], v195 offset:2048
    s_add_u32 m0, s54, 0
    s_add_u32 s53, s50, 0
    buffer_load_dwordx4 v218, s[28:31], s53 offen lds
    v_mfma_f32_16x16x32_bf16 v[64:67], v[188:191], v[160:163], v[64:67]
    ds_read_b64_tr_b16 v[180:181], v196 offset:256
    v_mfma_f32_16x16x32_bf16 v[68:71], v[188:191], v[164:167], v[68:71]
    ds_read_b64_tr_b16 v[182:183], v196 offset:2048
    s_add_u32 m0, s55, 1024
    s_nop 0
    buffer_load_dwordx4 v220, s[32:35], s51 offen lds
    s_waitcnt lgkmcnt(6)
    v_mfma_f32_16x16x32_bf16 v[24:27], v[168:171], v[152:155], v[24:27]
    ds_read_b128 v[160:163], v193 offset:0
    v_mfma_f32_16x16x32_bf16 v[28:31], v[168:171], v[156:159], v[28:31]
    ds_read_b128 v[164:167], v193 offset:2048
    ds_read_b64_tr_b16 v[184:185], v195 offset:512
    ds_read_b64_tr_b16 v[186:187], v195 offset:2304
    s_add_u32 m0, s55, 2048
    s_nop 0
    buffer_load_dwordx4 v221, s[32:35], s51 offen lds
    s_waitcnt lgkmcnt(8)
    v_mfma_f32_16x16x32_bf16 v[32:35], v[172:175], v[152:155], v[32:35]
    ds_read_b64_tr_b16 v[188:189], v196 offset:512
    v_mfma_f32_16x16x32_bf16 v[36:39], v[172:175], v[156:159], v[36:39]
    ds_read_b64_tr_b16 v[190:191], v196 offset:2304
    s_add_u32 m0, s54, 4096
    s_add_u32 s53, s50, 40960
    buffer_load_dwordx4 v218, s[28:31], s53 offen lds
    s_waitcnt lgkmcnt(8)
    v_mfma_f32_16x16x32_bf16 v[40:43], v[176:179], v[152:155], v[40:43]
    ds_read_b64_tr_b16 v[168:169], v195 offset:14336
    v_mfma_f32_16x16x32_bf16 v[44:47], v[176:179], v[156:159], v[44:47]
    ds_read_b64_tr_b16 v[170:171], v195 offset:16128
    s_add_u32 m0, s55, 3072
    s_nop 0
    buffer_load_dwordx4 v222, s[32:35], s51 offen lds
    s_waitcnt lgkmcnt(8)
    v_mfma_f32_16x16x32_bf16 v[48:51], v[180:183], v[152:155], v[48:51]
    ds_read_b64_tr_b16 v[172:173], v196 offset:14336
    v_mfma_f32_16x16x32_bf16 v[52:55], v[180:183], v[156:159], v[52:55]
    ds_read_b64_tr_b16 v[174:175], v196 offset:16128
    s_add_u32 m0, s55, 4096
    s_nop 0
    buffer_load_dwordx4 v223, s[32:35], s51 offen lds
    s_waitcnt lgkmcnt(6)
    v_mfma_f32_16x16x32_bf16 v[56:59], v[184:187], v[152:155], v[56:59]
    ds_read_b64_tr_b16 v[176:177], v195 offset:14592
    v_mfma_f32_16x16x32_bf16 v[60:63], v[184:187], v[156:159], v[60:63]
    ds_read_b64_tr_b16 v[178:179], v195 offset:16384
    s_add_u32 m0, s54, 8192
    s_add_u32 s53, s50, 81920
    buffer_load_dwordx4 v218, s[28:31], s53 offen lds
    s_waitcnt lgkmcnt(6)
    v_mfma_f32_16x16x32_bf16 v[64:67], v[188:191], v[152:155], v[64:67]
    ds_read_b64_tr_b16 v[180:181], v196 offset:14592
    v_mfma_f32_16x16x32_bf16 v[68:71], v[188:191], v[156:159], v[68:71]
    ds_read_b64_tr_b16 v[182:183], v196 offset:16384
    s_add_u32 m0, s55, 5120
    s_nop 0
    buffer_load_dwordx4 v224, s[32:35], s51 offen lds
    s_waitcnt lgkmcnt(6)
    v_mfma_f32_16x16x32_bf16 v[24:27], v[168:171], v[160:163], v[24:27]
    ds_read_b64_tr_b16 v[184:185], v195 offset:14848
    v_mfma_f32_16x16x32_bf16 v[28:31], v[168:171], v[164:167], v[28:31]
    ds_read_b64_tr_b16 v[186:187], v195 offset:16640
    s_add_u32 m0, s55, 6144
    s_nop 0
    buffer_load_dwordx4 v225, s[32:35], s51 offen lds
    s_waitcnt lgkmcnt(6)
    v_mfma_f32_16x16x32_bf16 v[32:35], v[172:175], v[160:163], v[32:35]
    ds_read_b64_tr_b16 v[188:189], v196 offset:14848
    v_mfma_f32_16x16x32_bf16 v[36:39], v[172:175], v[164:167], v[36:39]
    ds_read_b64_tr_b16 v[190:191], v196 offset:16640
    v_add_u32 v192, 98304, v194
    v_add_u32 v195, 98304, v197
    v_xor_b32 v193, 64, v192
    v_xor_b32 v196, 32, v195
    s_add_u32 m0, s54, 12288
    s_add_u32 s53, s50, 122880
    buffer_load_dwordx4 v218, s[28:31], s53 offen lds
    s_waitcnt lgkmcnt(6)
    v_mfma_f32_16x16x32_bf16 v[40:43], v[176:179], v[160:163], v[40:43]
    v_mfma_f32_16x16x32_bf16 v[44:47], v[176:179], v[164:167], v[44:47]
    s_waitcnt vmcnt(11) lgkmcnt(0)
    s_barrier
    ds_read_b128 v[152:155], v192 offset:0
    ds_read_b128 v[156:159], v192 offset:2048
    ds_read_b64_tr_b16 v[168:169], v195 offset:0
    ds_read_b64_tr_b16 v[170:171], v195 offset:1792
    ds_read_b64_tr_b16 v[172:173], v196 offset:0
    ds_read_b64_tr_b16 v[174:175], v196 offset:1792
    s_setprio 0
    v_mfma_f32_16x16x32_bf16 v[48:51], v[180:183], v[160:163], v[48:51]
    v_mfma_f32_16x16x32_bf16 v[52:55], v[180:183], v[164:167], v[52:55]
    v_mfma_f32_16x16x32_bf16 v[56:59], v[184:187], v[160:163], v[56:59]
    ds_read_b64_tr_b16 v[176:177], v195 offset:256
    v_mfma_f32_16x16x32_bf16 v[60:63], v[184:187], v[164:167], v[60:63]
    ds_read_b64_tr_b16 v[178:179], v195 offset:2048
    v_mfma_f32_16x16x32_bf16 v[64:67], v[188:191], v[160:163], v[64:67]
    ds_read_b64_tr_b16 v[180:181], v196 offset:256
    v_mfma_f32_16x16x32_bf16 v[68:71], v[188:191], v[164:167], v[68:71]
    ds_read_b64_tr_b16 v[182:183], v196 offset:2048
    s_waitcnt lgkmcnt(6)
    v_mfma_f32_16x16x32_bf16 v[24:27], v[168:171], v[152:155], v[24:27]
    ds_read_b128 v[160:163], v193 offset:0
    v_mfma_f32_16x16x32_bf16 v[28:31], v[168:171], v[156:159], v[28:31]
    ds_read_b128 v[164:167], v193 offset:2048
    ds_read_b64_tr_b16 v[184:185], v195 offset:512
    ds_read_b64_tr_b16 v[186:187], v195 offset:2304
    s_waitcnt lgkmcnt(8)
    v_mfma_f32_16x16x32_bf16 v[32:35], v[172:175], v[152:155], v[32:35]
    ds_read_b64_tr_b16 v[188:189], v196 offset:512
    v_mfma_f32_16x16x32_bf16 v[36:39], v[172:175], v[156:159], v[36:39]
    ds_read_b64_tr_b16 v[190:191], v196 offset:2304
    s_waitcnt lgkmcnt(8)
    v_mfma_f32_16x16x32_bf16 v[40:43], v[176:179], v[152:155], v[40:43]
    ds_read_b64_tr_b16 v[168:169], v195 offset:14336
    v_mfma_f32_16x16x32_bf16 v[44:47], v[176:179], v[156:159], v[44:47]
    ds_read_b64_tr_b16 v[170:171], v195 offset:16128
    s_waitcnt lgkmcnt(8)
    v_mfma_f32_16x16x32_bf16 v[48:51], v[180:183], v[152:155], v[48:51]
    ds_read_b64_tr_b16 v[172:173], v196 offset:14336
    v_mfma_f32_16x16x32_bf16 v[52:55], v[180:183], v[156:159], v[52:55]
    ds_read_b64_tr_b16 v[174:175], v196 offset:16128
    s_waitcnt lgkmcnt(6)
    v_mfma_f32_16x16x32_bf16 v[56:59], v[184:187], v[152:155], v[56:59]
    ds_read_b64_tr_b16 v[176:177], v195 offset:14592
    v_mfma_f32_16x16x32_bf16 v[60:63], v[184:187], v[156:159], v[60:63]
    ds_read_b64_tr_b16 v[178:179], v195 offset:16384
    s_waitcnt lgkmcnt(6)
    v_mfma_f32_16x16x32_bf16 v[64:67], v[188:191], v[152:155], v[64:67]
    ds_read_b64_tr_b16 v[180:181], v196 offset:14592
    v_mfma_f32_16x16x32_bf16 v[68:71], v[188:191], v[156:159], v[68:71]
    ds_read_b64_tr_b16 v[182:183], v196 offset:16384
    s_waitcnt lgkmcnt(6)
    v_mfma_f32_16x16x32_bf16 v[24:27], v[168:171], v[160:163], v[24:27]
    ds_read_b64_tr_b16 v[184:185], v195 offset:14848
    v_mfma_f32_16x16x32_bf16 v[28:31], v[168:171], v[164:167], v[28:31]
    ds_read_b64_tr_b16 v[186:187], v195 offset:16640
    s_waitcnt lgkmcnt(6)
    v_mfma_f32_16x16x32_bf16 v[32:35], v[172:175], v[160:163], v[32:35]
    ds_read_b64_tr_b16 v[188:189], v196 offset:14848
    v_mfma_f32_16x16x32_bf16 v[36:39], v[172:175], v[164:167], v[36:39]
    ds_read_b64_tr_b16 v[190:191], v196 offset:16640
    v_add_u32 v192, 0, v194
    v_add_u32 v195, 0, v197
    v_xor_b32 v193, 64, v192
    v_xor_b32 v196, 32, v195
    s_waitcnt lgkmcnt(6)
    v_mfma_f32_16x16x32_bf16 v[40:43], v[176:179], v[160:163], v[40:43]
    v_mfma_f32_16x16x32_bf16 v[44:47], v[176:179], v[164:167], v[44:47]
    s_waitcnt vmcnt(0) lgkmcnt(0)
    s_barrier
    ds_read_b128 v[152:155], v192 offset:0
    ds_read_b128 v[156:159], v192 offset:2048
    ds_read_b64_tr_b16 v[168:169], v195 offset:0
    ds_read_b64_tr_b16 v[170:171], v195 offset:1792
    ds_read_b64_tr_b16 v[172:173], v196 offset:0
    ds_read_b64_tr_b16 v[174:175], v196 offset:1792
    v_mfma_f32_16x16x32_bf16 v[48:51], v[180:183], v[160:163], v[48:51]
    v_mfma_f32_16x16x32_bf16 v[52:55], v[180:183], v[164:167], v[52:55]
    v_mfma_f32_16x16x32_bf16 v[56:59], v[184:187], v[160:163], v[56:59]
    ds_read_b64_tr_b16 v[176:177], v195 offset:256
    v_mfma_f32_16x16x32_bf16 v[60:63], v[184:187], v[164:167], v[60:63]
    ds_read_b64_tr_b16 v[178:179], v195 offset:2048
    v_mfma_f32_16x16x32_bf16 v[64:67], v[188:191], v[160:163], v[64:67]
    ds_read_b64_tr_b16 v[180:181], v196 offset:256
    v_mfma_f32_16x16x32_bf16 v[68:71], v[188:191], v[164:167], v[68:71]
    ds_read_b64_tr_b16 v[182:183], v196 offset:2048
    s_waitcnt lgkmcnt(6)
    v_mfma_f32_16x16x32_bf16 v[24:27], v[168:171], v[152:155], v[24:27]
    ds_read_b128 v[160:163], v193 offset:0
    v_mfma_f32_16x16x32_bf16 v[28:31], v[168:171], v[156:159], v[28:31]
    ds_read_b128 v[164:167], v193 offset:2048
    ds_read_b64_tr_b16 v[184:185], v195 offset:512
    ds_read_b64_tr_b16 v[186:187], v195 offset:2304
    v_and_b32 v208, 15, v1
    s_lshl_b32 s65, s45, 5
    v_add_lshl_u32 v209, v208, s65, 2
    s_waitcnt lgkmcnt(8)
    v_mfma_f32_16x16x32_bf16 v[32:35], v[172:175], v[152:155], v[32:35]
    ds_read_b64_tr_b16 v[188:189], v196 offset:512
    v_mfma_f32_16x16x32_bf16 v[36:39], v[172:175], v[156:159], v[36:39]
    ds_read_b64_tr_b16 v[190:191], v196 offset:2304
    v_add_u32 v209, 147456, v209
    s_lshl_b32 s65, s79, 7
    s_add_u32 s65, s65, 161792
    s_waitcnt lgkmcnt(8)
    v_mfma_f32_16x16x32_bf16 v[40:43], v[176:179], v[152:155], v[40:43]
    ds_read_b64_tr_b16 v[168:169], v195 offset:14336
    v_mfma_f32_16x16x32_bf16 v[44:47], v[176:179], v[156:159], v[44:47]
    ds_read_b64_tr_b16 v[170:171], v195 offset:16128
    v_lshl_add_u32 v208, v208, 2, s65
    ds_read_b32 v210, v209 offset:12288
    ds_read_b32 v4, v209 offset:12800
    s_waitcnt lgkmcnt(10)
    v_mfma_f32_16x16x32_bf16 v[48:51], v[180:183], v[152:155], v[48:51]
    ds_read_b64_tr_b16 v[172:173], v196 offset:14336
    v_mfma_f32_16x16x32_bf16 v[52:55], v[180:183], v[156:159], v[52:55]
    ds_read_b64_tr_b16 v[174:175], v196 offset:16128
    ds_read_b32 v5, v209 offset:13312
    ds_read_b32 v211, v209 offset:12352
    ds_read_b32 v252, v209 offset:12864
    s_waitcnt lgkmcnt(11)
    v_mfma_f32_16x16x32_bf16 v[56:59], v[184:187], v[152:155], v[56:59]
    ds_read_b64_tr_b16 v[176:177], v195 offset:14592
    v_mfma_f32_16x16x32_bf16 v[60:63], v[184:187], v[156:159], v[60:63]
    ds_read_b64_tr_b16 v[178:179], v195 offset:16384
    ds_read_b32 v253, v209 offset:13376
    ds_read_b32 v107, v208 offset:0
    ds_read_b32 v111, v208 offset:64
    s_waitcnt lgkmcnt(14)
    v_mfma_f32_16x16x32_bf16 v[64:67], v[188:191], v[152:155], v[64:67]
    ds_read_b64_tr_b16 v[180:181], v196 offset:14592
    v_mfma_f32_16x16x32_bf16 v[68:71], v[188:191], v[156:159], v[68:71]
    ds_read_b64_tr_b16 v[182:183], v196 offset:16384
    ds_read_b32 v115, v208 offset:128
    ds_read_b32 v119, v208 offset:192
    ds_read_b32 v123, v208 offset:256
    s_waitcnt lgkmcnt(15)
    v_mfma_f32_16x16x32_bf16 v[24:27], v[168:171], v[160:163], v[24:27]
    ds_read_b64_tr_b16 v[184:185], v195 offset:14848
    v_mfma_f32_16x16x32_bf16 v[28:31], v[168:171], v[164:167], v[28:31]
    ds_read_b64_tr_b16 v[186:187], v195 offset:16640
    ds_read_b32 v127, v208 offset:320
    s_mov_b32 s88, 0xffff
    s_mov_b32 s89, 0
    s_waitcnt lgkmcnt(15)
    v_mfma_f32_16x16x32_bf16 v[32:35], v[172:175], v[160:163], v[32:35]
    ds_read_b64_tr_b16 v[188:189], v196 offset:14848
    v_mfma_f32_16x16x32_bf16 v[36:39], v[172:175], v[164:167], v[36:39]
    ds_read_b64_tr_b16 v[190:191], v196 offset:16640
    s_waitcnt lgkmcnt(2)
    v_sub_f32 v210, 0, v210
    v_cvt_pk_bf16_f32 v212, v210, v5
    v_mfma_f32_16x16x32_bf16 v[40:43], v[176:179], v[160:163], v[40:43]
    v_mfma_f32_16x16x32_bf16 v[44:47], v[176:179], v[164:167], v[44:47]
    v_lshlrev_b32 v213, 16, v212
    v_and_b32 v214, 0xffff0000, v212
    v_sub_f32 v213, v210, v213
    s_waitcnt lgkmcnt(0)
    s_barrier
    v_mfma_f32_16x16x32_bf16 v[48:51], v[180:183], v[160:163], v[48:51]
    v_mfma_f32_16x16x32_bf16 v[52:55], v[180:183], v[164:167], v[52:55]
    v_sub_f32 v214, v5, v214
    v_cvt_pk_bf16_f32 v213, v210, v213
    v_cvt_pk_bf16_f32 v214, v214, v2
    v_mfma_f32_16x16x32_bf16 v[56:59], v[184:187], v[160:163], v[56:59]
    v_mfma_f32_16x16x32_bf16 v[60:63], v[184:187], v[164:167], v[60:63]
    v_cndmask_b32 v144, 0, v213, s[88:89]
    v_cndmask_b32 v145, 0, v212, s[88:89]
    v_cndmask_b32 v146, 0, v214, s[88:89]
    v_mfma_f32_16x16x32_bf16 v[64:67], v[188:191], v[160:163], v[64:67]
    v_mfma_f32_16x16x32_bf16 v[68:71], v[188:191], v[164:167], v[68:71]
    v_mov_b32 v147, 0
    v_sub_f32 v211, 0, v211
    v_cvt_pk_bf16_f32 v212, v211, v253
    v_lshlrev_b32 v213, 16, v212
    v_and_b32 v214, 0xffff0000, v212
    v_sub_f32 v213, v211, v213
    v_sub_f32 v214, v253, v214
    v_cvt_pk_bf16_f32 v213, v211, v213
    v_cvt_pk_bf16_f32 v214, v214, v2
    v_cndmask_b32 v148, 0, v213, s[88:89]
    v_cndmask_b32 v149, 0, v212, s[88:89]
    v_cndmask_b32 v150, 0, v214, s[88:89]
    v_mov_b32 v151, 0
    v_cvt_pk_bf16_f32 v104, v107, v107
    v_and_b32 v105, 0xffff0000, v104
    v_sub_f32 v105, v107, v105
    v_cvt_pk_bf16_f32 v105, v105, v2
    v_lshl_or_b32 v105, v198, 16, v105
    v_mov_b32 v106, v198
    v_mov_b32 v107, 0
    v_cvt_pk_bf16_f32 v108, v111, v111
    v_and_b32 v109, 0xffff0000, v108
    v_sub_f32 v109, v111, v109
    v_cvt_pk_bf16_f32 v109, v109, v2
    v_lshl_or_b32 v109, v199, 16, v109
    v_mov_b32 v110, v199
    v_mov_b32 v111, 0
    v_cvt_pk_bf16_f32 v112, v115, v115
    v_and_b32 v113, 0xffff0000, v112
    v_sub_f32 v113, v115, v113
    v_cvt_pk_bf16_f32 v113, v113, v2
    v_lshl_or_b32 v113, v200, 16, v113
    v_mov_b32 v114, v200
    v_mov_b32 v115, 0
    v_cvt_pk_bf16_f32 v116, v119, v119
    v_and_b32 v117, 0xffff0000, v116
    v_sub_f32 v117, v119, v117
    v_cvt_pk_bf16_f32 v117, v117, v2
    v_lshl_or_b32 v117, v201, 16, v117
    v_mov_b32 v118, v201
    v_mov_b32 v119, 0
    v_cvt_pk_bf16_f32 v120, v123, v123
    v_and_b32 v121, 0xffff0000, v120
    v_sub_f32 v121, v123, v121
    v_cvt_pk_bf16_f32 v121, v121, v2
    v_lshl_or_b32 v121, v202, 16, v121
    v_mov_b32 v122, v202
    v_mov_b32 v123, 0
    v_cvt_pk_bf16_f32 v124, v127, v127
    v_and_b32 v125, 0xffff0000, v124
    v_sub_f32 v125, v127, v125
    v_cvt_pk_bf16_f32 v125, v125, v2
    v_lshl_or_b32 v125, v203, 16, v125
    v_mov_b32 v126, v203
    v_mov_b32 v127, 0
    v_mfma_f32_16x16x32_bf16 v[24:27], v[104:107], v[144:147], v[24:27]
    v_mfma_f32_16x16x32_bf16 v[28:31], v[104:107], v[148:151], v[28:31]
    v_mfma_f32_16x16x32_bf16 v[32:35], v[108:111], v[144:147], v[32:35]
    v_mfma_f32_16x16x32_bf16 v[36:39], v[108:111], v[148:151], v[36:39]
    v_mfma_f32_16x16x32_bf16 v[40:43], v[112:115], v[144:147], v[40:43]
    v_mfma_f32_16x16x32_bf16 v[44:47], v[112:115], v[148:151], v[44:47]
    v_mfma_f32_16x16x32_bf16 v[48:51], v[116:119], v[144:147], v[48:51]
    v_mfma_f32_16x16x32_bf16 v[52:55], v[116:119], v[148:151], v[52:55]
    v_mfma_f32_16x16x32_bf16 v[56:59], v[120:123], v[144:147], v[56:59]
    v_mfma_f32_16x16x32_bf16 v[60:63], v[120:123], v[148:151], v[60:63]
    v_mfma_f32_16x16x32_bf16 v[64:67], v[124:127], v[144:147], v[64:67]
    v_mfma_f32_16x16x32_bf16 v[68:71], v[124:127], v[148:151], v[68:71]
    s_lshl_b32 s57, s46, 1
    s_lshr_b32 s58, s45, 1
    s_add_u32 s57, s57, s58
    s_mul_i32 s57, s57, 303104
    s_and_b32 s58, s45, 1
    s_lshl_b32 s58, s58, 11
    s_add_u32 s57, s57, s58
    v_add_u32 v122, s57, v6
    v_mul_f32 v104, 0xc0135761, v4
    v_mul_f32 v106, v4, v4
    v_mul_f32 v106, v106, v4
    v_mul_f32 v106, 0xbdd2d3e8, v106
    v_mov_b32 v108, v5
    v_mul_f32 v110, 0xc0135761, v252
    v_mul_f32 v112, v252, v252
    v_mul_f32 v112, v112, v252
    v_mul_f32 v112, 0xbdd2d3e8, v112
    v_mov_b32 v114, v253
    s_lshl_b32 s57, s49, 7
    s_lshl_b32 s58, s79, 12
    s_add_u32 s57, s57, s58
    s_setprio 2
    v_pk_mul_f32 v[124:125], v[24:25], v[24:25]
    v_pk_mul_f32 v[126:127], v[26:27], v[26:27]
    v_pk_mul_f32 v[128:129], v[32:33], v[32:33]
    v_pk_mul_f32 v[130:131], v[34:35], v[34:35]
    v_pk_fma_f32 v[124:125], v[124:125], v[106:107], v[104:105] op_sel_hi:[1,0,0]
    v_pk_fma_f32 v[126:127], v[126:127], v[106:107], v[104:105] op_sel_hi:[1,0,0]
    v_pk_fma_f32 v[128:129], v[128:129], v[106:107], v[104:105] op_sel_hi:[1,0,0]
    v_pk_fma_f32 v[130:131], v[130:131], v[106:107], v[104:105] op_sel_hi:[1,0,0]
    v_pk_mul_f32 v[124:125], v[124:125], v[24:25]
    v_pk_mul_f32 v[126:127], v[126:127], v[26:27]
    v_pk_mul_f32 v[128:129], v[128:129], v[32:33]
    v_pk_mul_f32 v[130:131], v[130:131], v[34:35]
    v_exp_f32 v124, v124
    v_exp_f32 v125, v125
    v_exp_f32 v126, v126
    v_exp_f32 v127, v127
    v_exp_f32 v128, v128
    v_exp_f32 v129, v129
    v_exp_f32 v130, v130
    v_exp_f32 v131, v131
    v_pk_fma_f32 v[124:125], v[124:125], v[108:109], v[108:109] op_sel_hi:[1,0,0]
    v_pk_fma_f32 v[126:127], v[126:127], v[108:109], v[108:109] op_sel_hi:[1,0,0]
    v_pk_fma_f32 v[128:129], v[128:129], v[108:109], v[108:109] op_sel_hi:[1,0,0]
    v_pk_fma_f32 v[130:131], v[130:131], v[108:109], v[108:109] op_sel_hi:[1,0,0]
    v_rcp_f32 v124, v124
    v_rcp_f32 v125, v125
    v_rcp_f32 v126, v126
    v_rcp_f32 v127, v127
    v_rcp_f32 v128, v128
    v_rcp_f32 v129, v129
    v_rcp_f32 v130, v130
    v_rcp_f32 v131, v131
    v_pk_mul_f32 v[124:125], v[124:125], v[24:25]
    v_pk_mul_f32 v[126:127], v[126:127], v[26:27]
    v_pk_mul_f32 v[128:129], v[128:129], v[32:33]
    v_pk_mul_f32 v[130:131], v[130:131], v[34:35]
    v_cvt_pk_bf16_f32 v136, v124, v125
    v_cvt_pk_bf16_f32 v137, v126, v127
    v_cvt_pk_bf16_f32 v138, v128, v129
    v_cvt_pk_bf16_f32 v139, v130, v131
    buffer_store_dwordx4 v[136:139], v122, s[36:39], s57 offen offset:0 sc1
    v_pk_mul_f32 v[124:125], v[28:29], v[28:29]
    v_pk_mul_f32 v[126:127], v[30:31], v[30:31]
    v_pk_mul_f32 v[128:129], v[36:37], v[36:37]
    v_pk_mul_f32 v[130:131], v[38:39], v[38:39]
    v_pk_fma_f32 v[124:125], v[124:125], v[112:113], v[110:111] op_sel_hi:[1,0,0]
    v_pk_fma_f32 v[126:127], v[126:127], v[112:113], v[110:111] op_sel_hi:[1,0,0]
    v_pk_fma_f32 v[128:129], v[128:129], v[112:113], v[110:111] op_sel_hi:[1,0,0]
    v_pk_fma_f32 v[130:131], v[130:131], v[112:113], v[110:111] op_sel_hi:[1,0,0]
    v_pk_mul_f32 v[124:125], v[124:125], v[28:29]
    v_pk_mul_f32 v[126:127], v[126:127], v[30:31]
    v_pk_mul_f32 v[128:129], v[128:129], v[36:37]
    v_pk_mul_f32 v[130:131], v[130:131], v[38:39]
    v_exp_f32 v124, v124
    v_exp_f32 v125, v125
    v_exp_f32 v126, v126
    v_exp_f32 v127, v127
    v_exp_f32 v128, v128
    v_exp_f32 v129, v129
    v_exp_f32 v130, v130
    v_exp_f32 v131, v131
    v_pk_fma_f32 v[124:125], v[124:125], v[114:115], v[114:115] op_sel_hi:[1,0,0]
    v_pk_fma_f32 v[126:127], v[126:127], v[114:115], v[114:115] op_sel_hi:[1,0,0]
    v_pk_fma_f32 v[128:129], v[128:129], v[114:115], v[114:115] op_sel_hi:[1,0,0]
    v_pk_fma_f32 v[130:131], v[130:131], v[114:115], v[114:115] op_sel_hi:[1,0,0]
    v_rcp_f32 v124, v124
    v_rcp_f32 v125, v125
    v_rcp_f32 v126, v126
    v_rcp_f32 v127, v127
    v_rcp_f32 v128, v128
    v_rcp_f32 v129, v129
    v_rcp_f32 v130, v130
    v_rcp_f32 v131, v131
    v_pk_mul_f32 v[124:125], v[124:125], v[28:29]
    v_pk_mul_f32 v[126:127], v[126:127], v[30:31]
    v_pk_mul_f32 v[128:129], v[128:129], v[36:37]
    v_pk_mul_f32 v[130:131], v[130:131], v[38:39]
    v_cvt_pk_bf16_f32 v140, v124, v125
    v_cvt_pk_bf16_f32 v141, v126, v127
    v_cvt_pk_bf16_f32 v142, v128, v129
    v_cvt_pk_bf16_f32 v143, v130, v131
    buffer_store_dwordx4 v[140:143], v122, s[36:39], s57 offen offset:1024 sc1
    s_add_u32 s57, s57, 4096
    v_pk_mul_f32 v[124:125], v[40:41], v[40:41]
    v_pk_mul_f32 v[126:127], v[42:43], v[42:43]
    v_pk_mul_f32 v[128:129], v[48:49], v[48:49]
    v_pk_mul_f32 v[130:131], v[50:51], v[50:51]
    v_pk_fma_f32 v[124:125], v[124:125], v[106:107], v[104:105] op_sel_hi:[1,0,0]
    v_pk_fma_f32 v[126:127], v[126:127], v[106:107], v[104:105] op_sel_hi:[1,0,0]
    v_pk_fma_f32 v[128:129], v[128:129], v[106:107], v[104:105] op_sel_hi:[1,0,0]
    v_pk_fma_f32 v[130:131], v[130:131], v[106:107], v[104:105] op_sel_hi:[1,0,0]
    v_pk_mul_f32 v[124:125], v[124:125], v[40:41]
    v_pk_mul_f32 v[126:127], v[126:127], v[42:43]
    v_pk_mul_f32 v[128:129], v[128:129], v[48:49]
    v_pk_mul_f32 v[130:131], v[130:131], v[50:51]
    v_exp_f32 v124, v124
    v_exp_f32 v125, v125
    v_exp_f32 v126, v126
    v_exp_f32 v127, v127
    v_exp_f32 v128, v128
    v_exp_f32 v129, v129
    v_exp_f32 v130, v130
    v_exp_f32 v131, v131
    v_pk_fma_f32 v[124:125], v[124:125], v[108:109], v[108:109] op_sel_hi:[1,0,0]
    v_pk_fma_f32 v[126:127], v[126:127], v[108:109], v[108:109] op_sel_hi:[1,0,0]
    v_pk_fma_f32 v[128:129], v[128:129], v[108:109], v[108:109] op_sel_hi:[1,0,0]
    v_pk_fma_f32 v[130:131], v[130:131], v[108:109], v[108:109] op_sel_hi:[1,0,0]
    v_rcp_f32 v124, v124
    v_rcp_f32 v125, v125
    v_rcp_f32 v126, v126
    v_rcp_f32 v127, v127
    v_rcp_f32 v128, v128
    v_rcp_f32 v129, v129
    v_rcp_f32 v130, v130
    v_rcp_f32 v131, v131
    v_pk_mul_f32 v[124:125], v[124:125], v[40:41]
    v_pk_mul_f32 v[126:127], v[126:127], v[42:43]
    v_pk_mul_f32 v[128:129], v[128:129], v[48:49]
    v_pk_mul_f32 v[130:131], v[130:131], v[50:51]
    v_cvt_pk_bf16_f32 v144, v124, v125
    v_cvt_pk_bf16_f32 v145, v126, v127
    v_cvt_pk_bf16_f32 v146, v128, v129
    v_cvt_pk_bf16_f32 v147, v130, v131
    buffer_store_dwordx4 v[144:147], v122, s[36:39], s57 offen offset:0 sc1
    v_pk_mul_f32 v[124:125], v[44:45], v[44:45]
    v_pk_mul_f32 v[126:127], v[46:47], v[46:47]
    v_pk_mul_f32 v[128:129], v[52:53], v[52:53]
    v_pk_mul_f32 v[130:131], v[54:55], v[54:55]
    v_pk_fma_f32 v[124:125], v[124:125], v[112:113], v[110:111] op_sel_hi:[1,0,0]
    v_pk_fma_f32 v[126:127], v[126:127], v[112:113], v[110:111] op_sel_hi:[1,0,0]
    v_pk_fma_f32 v[128:129], v[128:129], v[112:113], v[110:111] op_sel_hi:[1,0,0]
    v_pk_fma_f32 v[130:131], v[130:131], v[112:113], v[110:111] op_sel_hi:[1,0,0]
    v_pk_mul_f32 v[124:125], v[124:125], v[44:45]
    v_pk_mul_f32 v[126:127], v[126:127], v[46:47]
    v_pk_mul_f32 v[128:129], v[128:129], v[52:53]
    v_pk_mul_f32 v[130:131], v[130:131], v[54:55]
    v_exp_f32 v124, v124
    v_exp_f32 v125, v125
    v_exp_f32 v126, v126
    v_exp_f32 v127, v127
    v_exp_f32 v128, v128
    v_exp_f32 v129, v129
    v_exp_f32 v130, v130
    v_exp_f32 v131, v131
    v_pk_fma_f32 v[124:125], v[124:125], v[114:115], v[114:115] op_sel_hi:[1,0,0]
    v_pk_fma_f32 v[126:127], v[126:127], v[114:115], v[114:115] op_sel_hi:[1,0,0]
    v_pk_fma_f32 v[128:129], v[128:129], v[114:115], v[114:115] op_sel_hi:[1,0,0]
    v_pk_fma_f32 v[130:131], v[130:131], v[114:115], v[114:115] op_sel_hi:[1,0,0]
    v_rcp_f32 v124, v124
    v_rcp_f32 v125, v125
    v_rcp_f32 v126, v126
    v_rcp_f32 v127, v127
    v_rcp_f32 v128, v128
    v_rcp_f32 v129, v129
    v_rcp_f32 v130, v130
    v_rcp_f32 v131, v131
    v_pk_mul_f32 v[124:125], v[124:125], v[44:45]
    v_pk_mul_f32 v[126:127], v[126:127], v[46:47]
    v_pk_mul_f32 v[128:129], v[128:129], v[52:53]
    v_pk_mul_f32 v[130:131], v[130:131], v[54:55]
    v_cvt_pk_bf16_f32 v136, v124, v125
    v_cvt_pk_bf16_f32 v137, v126, v127
    v_cvt_pk_bf16_f32 v138, v128, v129
    v_cvt_pk_bf16_f32 v139, v130, v131
    buffer_store_dwordx4 v[136:139], v122, s[36:39], s57 offen offset:1024 sc1
    s_add_u32 s57, s57, 4096
    v_pk_mul_f32 v[124:125], v[56:57], v[56:57]
    v_pk_mul_f32 v[126:127], v[58:59], v[58:59]
    v_pk_mul_f32 v[128:129], v[64:65], v[64:65]
    v_pk_mul_f32 v[130:131], v[66:67], v[66:67]
    v_pk_fma_f32 v[124:125], v[124:125], v[106:107], v[104:105] op_sel_hi:[1,0,0]
    v_pk_fma_f32 v[126:127], v[126:127], v[106:107], v[104:105] op_sel_hi:[1,0,0]
    v_pk_fma_f32 v[128:129], v[128:129], v[106:107], v[104:105] op_sel_hi:[1,0,0]
    v_pk_fma_f32 v[130:131], v[130:131], v[106:107], v[104:105] op_sel_hi:[1,0,0]
    v_pk_mul_f32 v[124:125], v[124:125], v[56:57]
    v_pk_mul_f32 v[126:127], v[126:127], v[58:59]
    v_pk_mul_f32 v[128:129], v[128:129], v[64:65]
    v_pk_mul_f32 v[130:131], v[130:131], v[66:67]
    v_exp_f32 v124, v124
    v_exp_f32 v125, v125
    v_exp_f32 v126, v126
    v_exp_f32 v127, v127
    v_exp_f32 v128, v128
    v_exp_f32 v129, v129
    v_exp_f32 v130, v130
    v_exp_f32 v131, v131
    v_pk_fma_f32 v[124:125], v[124:125], v[108:109], v[108:109] op_sel_hi:[1,0,0]
    v_pk_fma_f32 v[126:127], v[126:127], v[108:109], v[108:109] op_sel_hi:[1,0,0]
    v_pk_fma_f32 v[128:129], v[128:129], v[108:109], v[108:109] op_sel_hi:[1,0,0]
    v_pk_fma_f32 v[130:131], v[130:131], v[108:109], v[108:109] op_sel_hi:[1,0,0]
    v_rcp_f32 v124, v124
    v_rcp_f32 v125, v125
    v_rcp_f32 v126, v126
    v_rcp_f32 v127, v127
    v_rcp_f32 v128, v128
    v_rcp_f32 v129, v129
    v_rcp_f32 v130, v130
    v_rcp_f32 v131, v131
    v_pk_mul_f32 v[124:125], v[124:125], v[56:57]
    v_pk_mul_f32 v[126:127], v[126:127], v[58:59]
    v_pk_mul_f32 v[128:129], v[128:129], v[64:65]
    v_pk_mul_f32 v[130:131], v[130:131], v[66:67]
    v_cvt_pk_bf16_f32 v140, v124, v125
    v_cvt_pk_bf16_f32 v141, v126, v127
    v_cvt_pk_bf16_f32 v142, v128, v129
    v_cvt_pk_bf16_f32 v143, v130, v131
    buffer_store_dwordx4 v[140:143], v122, s[36:39], s57 offen offset:0 sc1
    v_pk_mul_f32 v[124:125], v[60:61], v[60:61]
    v_pk_mul_f32 v[126:127], v[62:63], v[62:63]
    v_pk_mul_f32 v[128:129], v[68:69], v[68:69]
    v_pk_mul_f32 v[130:131], v[70:71], v[70:71]
    v_pk_fma_f32 v[124:125], v[124:125], v[112:113], v[110:111] op_sel_hi:[1,0,0]
    v_pk_fma_f32 v[126:127], v[126:127], v[112:113], v[110:111] op_sel_hi:[1,0,0]
    v_pk_fma_f32 v[128:129], v[128:129], v[112:113], v[110:111] op_sel_hi:[1,0,0]
    v_pk_fma_f32 v[130:131], v[130:131], v[112:113], v[110:111] op_sel_hi:[1,0,0]
    v_pk_mul_f32 v[124:125], v[124:125], v[60:61]
    v_pk_mul_f32 v[126:127], v[126:127], v[62:63]
    v_pk_mul_f32 v[128:129], v[128:129], v[68:69]
    v_pk_mul_f32 v[130:131], v[130:131], v[70:71]
    v_exp_f32 v124, v124
    v_exp_f32 v125, v125
    v_exp_f32 v126, v126
    v_exp_f32 v127, v127
    v_exp_f32 v128, v128
    v_exp_f32 v129, v129
    v_exp_f32 v130, v130
    v_exp_f32 v131, v131
    v_pk_fma_f32 v[124:125], v[124:125], v[114:115], v[114:115] op_sel_hi:[1,0,0]
    v_pk_fma_f32 v[126:127], v[126:127], v[114:115], v[114:115] op_sel_hi:[1,0,0]
    v_pk_fma_f32 v[128:129], v[128:129], v[114:115], v[114:115] op_sel_hi:[1,0,0]
    v_pk_fma_f32 v[130:131], v[130:131], v[114:115], v[114:115] op_sel_hi:[1,0,0]
    v_rcp_f32 v124, v124
    v_rcp_f32 v125, v125
    v_rcp_f32 v126, v126
    v_rcp_f32 v127, v127
    v_rcp_f32 v128, v128
    v_rcp_f32 v129, v129
    v_rcp_f32 v130, v130
    v_rcp_f32 v131, v131
    v_pk_mul_f32 v[124:125], v[124:125], v[60:61]
    v_pk_mul_f32 v[126:127], v[126:127], v[62:63]
    v_pk_mul_f32 v[128:129], v[128:129], v[68:69]
    v_pk_mul_f32 v[130:131], v[130:131], v[70:71]
    v_cvt_pk_bf16_f32 v144, v124, v125
    v_cvt_pk_bf16_f32 v145, v126, v127
    v_cvt_pk_bf16_f32 v146, v128, v129
    v_cvt_pk_bf16_f32 v147, v130, v131
    buffer_store_dwordx4 v[144:147], v122, s[36:39], s57 offen offset:1024 sc1
    s_add_u32 s57, s57, 4096
    s_setprio 0
    s_add_u32 s65, s75, 0
    s_cmp_ge_u32 s65, s73
    s_cselect_b32 s61, s73, 0
    s_sub_u32 s65, s65, s61
    s_add_u32 s65, s65, s69
    s_mul_i32 s65, s65, 5120
    s_add_u32 s65, s65, s78
    buffer_load_dwordx4 v[152:155], v6, s[36:39], s65 offen offset:0 sc1
    buffer_load_dwordx4 v[156:159], v6, s[36:39], s65 offen offset:1024 sc1
    buffer_load_dwordx4 v[160:163], v6, s[36:39], s65 offen offset:2048 sc1
    buffer_load_dwordx4 v[164:167], v6, s[36:39], s65 offen offset:3072 sc1
    s_add_u32 s65, s65, 4096
    buffer_load_dwordx4 v[168:171], v6, s[36:39], s65 offen offset:0 sc1
    s_add_u32 s65, s75, 1
    s_cmp_ge_u32 s65, s73
    s_cselect_b32 s61, s73, 0
    s_sub_u32 s65, s65, s61
    s_add_u32 s65, s65, s69
    s_mul_i32 s65, s65, 5120
    s_add_u32 s65, s65, s78
    buffer_load_dwordx4 v[172:175], v6, s[36:39], s65 offen offset:0 sc1
    buffer_load_dwordx4 v[176:179], v6, s[36:39], s65 offen offset:1024 sc1
    buffer_load_dwordx4 v[180:183], v6, s[36:39], s65 offen offset:2048 sc1
    buffer_load_dwordx4 v[184:187], v6, s[36:39], s65 offen offset:3072 sc1
    s_add_u32 s65, s65, 4096
    buffer_load_dwordx4 v[188:191], v6, s[36:39], s65 offen offset:0 sc1
    s_add_u32 s65, s75, 2
    s_cmp_ge_u32 s65, s73
    s_cselect_b32 s61, s73, 0
    s_sub_u32 s65, s65, s61
    s_add_u32 s65, s65, s69
    s_mul_i32 s65, s65, 5120
    s_add_u32 s65, s65, s78
    buffer_load_dwordx4 v[192:195], v6, s[36:39], s65 offen offset:0 sc1
    buffer_load_dwordx4 v[196:199], v6, s[36:39], s65 offen offset:1024 sc1
    buffer_load_dwordx4 v[200:203], v6, s[36:39], s65 offen offset:2048 sc1
    buffer_load_dwordx4 v[204:207], v6, s[36:39], s65 offen offset:3072 sc1
    s_add_u32 s65, s65, 4096
    buffer_load_dwordx4 v[208:211], v6, s[36:39], s65 offen offset:0 sc1
    s_add_u32 s65, s75, 3
    s_cmp_ge_u32 s65, s73
    s_cselect_b32 s61, s73, 0
    s_sub_u32 s65, s65, s61
    s_add_u32 s65, s65, s69
    s_mul_i32 s65, s65, 5120
    s_add_u32 s65, s65, s78
    buffer_load_dwordx4 v[212:215], v6, s[36:39], s65 offen offset:0 sc1
    buffer_load_dwordx4 v[216:219], v6, s[36:39], s65 offen offset:1024 sc1
    buffer_load_dwordx4 v[220:223], v6, s[36:39], s65 offen offset:2048 sc1
    buffer_load_dwordx4 v[224:227], v6, s[36:39], s65 offen offset:3072 sc1
    s_add_u32 s65, s65, 4096
    buffer_load_dwordx4 v[228:231], v6, s[36:39], s65 offen offset:0 sc1
    s_add_u32 s65, s75, 4
    s_cmp_ge_u32 s65, s73
    s_cselect_b32 s61, s73, 0
    s_sub_u32 s65, s65, s61
    s_add_u32 s65, s65, s69
    s_mul_i32 s65, s65, 5120
    s_add_u32 s65, s65, s78
    buffer_load_dwordx4 v[232:235], v6, s[36:39], s65 offen offset:0 sc1
    buffer_load_dwordx4 v[236:239], v6, s[36:39], s65 offen offset:1024 sc1
    buffer_load_dwordx4 v[240:243], v6, s[36:39], s65 offen offset:2048 sc1
    buffer_load_dwordx4 v[244:247], v6, s[36:39], s65 offen offset:3072 sc1
    s_add_u32 s65, s65, 4096
    buffer_load_dwordx4 v[248:251], v6, s[36:39], s65 offen offset:0 sc1
    s_waitcnt vmcnt(25)
    s_setprio 0
    s_barrier
    s_lshl_b32 s58, s46, 3
    s_add_u32 s58, s58, s47
    s_add_u32 s57, s58, 8
    s_lshl_b32 s57, s57, 7
    v_mov_b32 v150, s57
    v_mov_b32 v151, 1
    s_cmp_eq_u32 s44, 0
    s_cselect_b32 exec_lo, 1, 0
    s_mov_b32 exec_hi, 0
    global_atomic_add v150, v151, s[10:11]
    s_mov_b64 exec, -1
    s_add_u32 s65, s76, 0
    s_cmp_ge_u32 s65, s74
    s_cselect_b32 s61, s74, 0
    s_sub_u32 s65, s65, s61
    s_add_u32 s65, s65, s72
    s_mul_i32 s65, s65, 5120
    s_add_u32 s65, s65, s78
    s_mul_i32 s66, s44, 20480
    s_add_u32 m0, s66, 0
    s_nop 0
    buffer_load_dwordx4 v6, s[36:39], s65 offen sc1 lds
    s_add_u32 s65, s65, 1024
    s_add_u32 m0, s66, 1024
    s_nop 0
    buffer_load_dwordx4 v6, s[36:39], s65 offen sc1 lds
    s_add_u32 s65, s65, 1024
    s_add_u32 m0, s66, 2048
    s_nop 0
    buffer_load_dwordx4 v6, s[36:39], s65 offen sc1 lds
    s_add_u32 s65, s65, 1024
    s_add_u32 m0, s66, 3072
    s_nop 0
    buffer_load_dwordx4 v6, s[36:39], s65 offen sc1 lds
    s_add_u32 s65, s65, 1024
    s_add_u32 m0, s66, 4096
    s_nop 0
    buffer_load_dwordx4 v6, s[36:39], s65 offen sc1 lds
    s_add_u32 s65, s76, 1
    s_cmp_ge_u32 s65, s74
    s_cselect_b32 s61, s74, 0
    s_sub_u32 s65, s65, s61
    s_add_u32 s65, s65, s72
    s_mul_i32 s65, s65, 5120
    s_add_u32 s65, s65, s78
    s_mul_i32 s66, s44, 20480
    s_add_u32 m0, s66, 5120
    s_nop 0
    buffer_load_dwordx4 v6, s[36:39], s65 offen sc1 lds
    s_add_u32 s65, s65, 1024
    s_add_u32 m0, s66, 6144
    s_nop 0
    buffer_load_dwordx4 v6, s[36:39], s65 offen sc1 lds
    s_add_u32 s65, s65, 1024
    s_add_u32 m0, s66, 7168
    s_nop 0
    buffer_load_dwordx4 v6, s[36:39], s65 offen sc1 lds
    s_add_u32 s65, s65, 1024
    s_add_u32 m0, s66, 8192
    s_nop 0
    buffer_load_dwordx4 v6, s[36:39], s65 offen sc1 lds
    s_add_u32 s65, s65, 1024
    s_add_u32 m0, s66, 9216
    s_nop 0
    buffer_load_dwordx4 v6, s[36:39], s65 offen sc1 lds
    s_add_u32 s65, s76, 2
    s_cmp_ge_u32 s65, s74
    s_cselect_b32 s61, s74, 0
    s_sub_u32 s65, s65, s61
    s_add_u32 s65, s65, s72
    s_mul_i32 s65, s65, 5120
    s_add_u32 s65, s65, s78
    s_cmp_gt_u32 s74, 2
    s_cselect_b32 s65, s65, 2130706432
    s_mul_i32 s66, s44, 20480
    s_add_u32 m0, s66, 10240
    s_nop 0
    buffer_load_dwordx4 v6, s[36:39], s65 offen sc1 lds
    s_add_u32 s65, s65, 1024
    s_add_u32 m0, s66, 11264
    s_nop 0
    buffer_load_dwordx4 v6, s[36:39], s65 offen sc1 lds
    s_add_u32 s65, s65, 1024
    s_add_u32 m0, s66, 12288
    s_nop 0
    buffer_load_dwordx4 v6, s[36:39], s65 offen sc1 lds
    s_add_u32 s65, s65, 1024
    s_add_u32 m0, s66, 13312
    s_nop 0
    buffer_load_dwordx4 v6, s[36:39], s65 offen sc1 lds
    s_add_u32 s65, s65, 1024
    s_add_u32 m0, s66, 14336
    s_nop 0
    buffer_load_dwordx4 v6, s[36:39], s65 offen sc1 lds
PHASE2:
    s_mov_b32 s63, 0
    s_lshr_b32 s57, s67, 1
    s_lshl_b32 s57, s57, 3
    s_add_u32 s57, s57, s44
    s_add_u32 s57, s57, 8
    v_lshlrev_b32 v4, 2, v1
    v_or_b32 v4, s44, v4
    s_sub_u32 s57, s57, s44
    v_add_u32 v4, s57, v4
    v_lshlrev_b32 v4, 7, v4
    s_mov_b64 exec, 3
    global_load_dword v5, v4, s[10:11] sc1
    s_waitcnt vmcnt(0)
    v_cmp_gt_u32 vcc, 1, v5
    s_nop 0
    s_cmp_eq_u64 vcc, 0
    s_cbranch_scc0 PL_26
PB_27:
    s_mov_b64 exec, -1
    s_add_u32 s53, s75, 0
    s_cmp_ge_u32 s53, s73
    s_cselect_b32 s61, s73, 0
    s_sub_u32 s53, s53, s61
    s_add_u32 s53, s53, s69
    s_mul_i32 s53, s53, 4096
    s_add_u32 s53, s53, s77
    s_setprio 3
    buffer_load_dwordx4 v[104:107], v6, s[36:39], s53 offen offset:0 sc1
    buffer_load_dwordx4 v[108:111], v6, s[36:39], s53 offen offset:1024 sc1
    buffer_load_dwordx4 v[112:115], v6, s[36:39], s53 offen offset:2048 sc1
    buffer_load_dwordx4 v[116:119], v6, s[36:39], s53 offen offset:3072 sc1
    s_add_u32 s53, s75, 1
    s_cmp_ge_u32 s53, s73
    s_cselect_b32 s61, s73, 0
    s_sub_u32 s53, s53, s61
    s_add_u32 s53, s53, s69
    s_mul_i32 s53, s53, 4096
    s_add_u32 s53, s53, s77
    s_setprio 2
    buffer_load_dwordx4 v[120:123], v6, s[36:39], s53 offen offset:0 sc1
    buffer_load_dwordx4 v[124:127], v6, s[36:39], s53 offen offset:1024 sc1
    buffer_load_dwordx4 v[128:131], v6, s[36:39], s53 offen offset:2048 sc1
    buffer_load_dwordx4 v[132:135], v6, s[36:39], s53 offen offset:3072 sc1
    s_add_u32 s53, s75, 2
    s_cmp_ge_u32 s53, s73
    s_cselect_b32 s61, s73, 0
    s_sub_u32 s53, s53, s61
    s_add_u32 s53, s53, s69
    s_mul_i32 s53, s53, 4096
    s_add_u32 s53, s53, s77
    s_setprio 1
    buffer_load_dwordx4 v[136:139], v6, s[36:39], s53 offen offset:0 sc1
    buffer_load_dwordx4 v[140:143], v6, s[36:39], s53 offen offset:1024 sc1
    buffer_load_dwordx4 v[144:147], v6, s[36:39], s53 offen offset:2048 sc1
    buffer_load_dwordx4 v[148:151], v6, s[36:39], s53 offen offset:3072 sc1
    s_setprio 0
PHASE2C:
    s_waitcnt vmcnt(8)
    v_mfma_f32_16x16x32_bf16 v[24:27], v[152:155], v[104:107], 0
    s_mov_b32 s40, s20
    s_mov_b32 s41, s21
    s_mov_b32 s42, 2621440
    s_mov_b32 s43, 0x20000
    v_mfma_f32_16x16x32_bf16 v[28:31], v[156:159], v[104:107], 0
    s_mov_b32 s96, s18
    s_mov_b32 s97, s19
    s_mov_b32 s98, 1280
    s_mov_b32 s99, 0x20000
    v_mfma_f32_16x16x32_bf16 v[32:35], v[160:163], v[104:107], 0
    s_mul_i32 s65, s67, 81920
    s_mul_i32 s66, s68, 160
    s_add_u32 s65, s65, s66
    v_add_u32 v14, 0, v0
    v_mfma_f32_16x16x32_bf16 v[36:39], v[164:167], v[104:107], 0
    v_mul_u32_u24 v15, 3277, v14
    v_lshrrev_b32 v15, 16, v15
    v_mul_u32_u24 v16, 20, v15
    v_sub_u32 v16, v14, v16
    v_mfma_f32_16x16x32_bf16 v[40:43], v[168:171], v[104:107], 0
    v_mul_u32_u24 v17, 1280, v15
    v_lshl_add_u32 v17, v16, 3, v17
    v_add_u32 v17, s65, v17
    v_cmp_gt_u32 vcc, 1280, v14
    v_mfma_f32_16x16x32_bf16 v[44:47], v[152:155], v[108:111], 0
    v_mov_b32 v18, 2130706432
    v_cndmask_b32 v7, v18, v17, vcc
    v_bfe_u32 v18, v15, 1, 2
    v_xor_b32 v18, v18, v16
    v_mfma_f32_16x16x32_bf16 v[48:51], v[156:159], v[108:111], 0
    v_mul_u32_u24 v19, 320, v15
    v_lshl_add_u32 v19, v18, 4, v19
    v_cndmask_b32 v10, 0, v19, vcc
    v_lshlrev_b32 v21, 3, v16
    v_mfma_f32_16x16x32_bf16 v[52:55], v[160:163], v[108:111], 0
    v_add_u32 v14, 512, v0
    v_mul_u32_u24 v15, 3277, v14
    v_lshrrev_b32 v15, 16, v15
    v_mul_u32_u24 v16, 20, v15
    v_mfma_f32_16x16x32_bf16 v[56:59], v[164:167], v[108:111], 0
    v_sub_u32 v16, v14, v16
    v_mul_u32_u24 v17, 1280, v15
    v_lshl_add_u32 v17, v16, 3, v17
    v_add_u32 v17, s65, v17
    v_mfma_f32_16x16x32_bf16 v[60:63], v[168:171], v[108:111], 0
    v_cmp_gt_u32 vcc, 1280, v14
    v_mov_b32 v18, 2130706432
    s_nop 0
    v_cndmask_b32 v8, v18, v17, vcc
    v_bfe_u32 v18, v15, 1, 2
    v_mfma_f32_16x16x32_bf16 v[64:67], v[152:155], v[112:115], 0
    v_xor_b32 v18, v18, v16
    v_mul_u32_u24 v19, 320, v15
    v_lshl_add_u32 v19, v18, 4, v19
    v_cndmask_b32 v11, 0, v19, vcc
    v_mfma_f32_16x16x32_bf16 v[68:71], v[156:159], v[112:115], 0
    v_lshlrev_b32 v22, 3, v16
    v_add_u32 v14, 1024, v0
    v_mul_u32_u24 v15, 3277, v14
    v_mfma_f32_16x16x32_bf16 v[72:75], v[160:163], v[112:115], 0
    v_lshrrev_b32 v15, 16, v15
    v_mul_u32_u24 v16, 20, v15
    v_sub_u32 v16, v14, v16
    v_mfma_f32_16x16x32_bf16 v[76:79], v[164:167], v[112:115], 0
    v_mul_u32_u24 v17, 1280, v15
    v_lshl_add_u32 v17, v16, 3, v17
    v_add_u32 v17, s65, v17
    v_mfma_f32_16x16x32_bf16 v[80:83], v[168:171], v[112:115], 0
    v_cmp_gt_u32 vcc, 1280, v14
    v_mov_b32 v18, 2130706432
    s_nop 0
    v_cndmask_b32 v9, v18, v17, vcc
    v_mfma_f32_16x16x32_bf16 v[84:87], v[152:155], v[116:119], 0
    v_bfe_u32 v18, v15, 1, 2
    v_xor_b32 v18, v18, v16
    v_mul_u32_u24 v19, 320, v15
    v_mfma_f32_16x16x32_bf16 v[88:91], v[156:159], v[116:119], 0
    v_lshl_add_u32 v19, v18, 4, v19
    v_cndmask_b32 v12, 0, v19, vcc
    v_lshlrev_b32 v23, 3, v16
    v_mfma_f32_16x16x32_bf16 v[92:95], v[160:163], v[116:119], 0
    v_and_b32 v14, 15, v1
    v_mul_u32_u24 v14, 320, v14
    v_lshrrev_b32 v15, 4, v1
    v_mfma_f32_16x16x32_bf16 v[96:99], v[164:167], v[116:119], 0
    v_bfe_u32 v16, v1, 1, 2
    v_xor_b32 v15, v15, v16
    v_lshl_add_u32 v14, v15, 4, v14
    v_mfma_f32_16x16x32_bf16 v[100:103], v[168:171], v[116:119], 0
    s_mul_i32 s65, s44, 20480
    v_add_u32 v13, s65, v14
    v_add_u32 v20, s65, v6
    s_waitcnt vmcnt(4)
    v_mfma_f32_16x16x32_bf16 v[24:27], v[172:175], v[120:123], v[24:27]
    s_add_u32 s53, s75, 3
    s_cmp_ge_u32 s53, s73
    s_cselect_b32 s61, s73, 0
    s_sub_u32 s53, s53, s61
    s_add_u32 s53, s53, s69
    s_mul_i32 s53, s53, 4096
    s_add_u32 s53, s53, s77
    v_mfma_f32_16x16x32_bf16 v[28:31], v[176:179], v[120:123], v[28:31]
    buffer_load_dwordx4 v[104:107], v6, s[36:39], s53 offen offset:0 sc1
    v_mfma_f32_16x16x32_bf16 v[32:35], v[180:183], v[120:123], v[32:35]
    buffer_load_dwordx4 v[108:111], v6, s[36:39], s53 offen offset:1024 sc1
    v_mfma_f32_16x16x32_bf16 v[36:39], v[184:187], v[120:123], v[36:39]
    buffer_load_dwordx4 v[112:115], v6, s[36:39], s53 offen offset:2048 sc1
    v_mfma_f32_16x16x32_bf16 v[40:43], v[188:191], v[120:123], v[40:43]
    buffer_load_dwordx4 v[116:119], v6, s[36:39], s53 offen offset:3072 sc1
    v_mfma_f32_16x16x32_bf16 v[44:47], v[172:175], v[124:127], v[44:47]
    s_add_u32 s65, s75, 5
    s_cmp_ge_u32 s65, s73
    s_cselect_b32 s61, s73, 0
    s_sub_u32 s65, s65, s61
    s_add_u32 s65, s65, s69
    s_mul_i32 s65, s65, 5120
    s_add_u32 s65, s65, s78
    buffer_load_dwordx4 v[152:155], v6, s[36:39], s65 offen offset:0 sc1
    v_mfma_f32_16x16x32_bf16 v[48:51], v[176:179], v[124:127], v[48:51]
    buffer_load_dwordx4 v[156:159], v6, s[36:39], s65 offen offset:1024 sc1
    v_mfma_f32_16x16x32_bf16 v[52:55], v[180:183], v[124:127], v[52:55]
    buffer_load_dwordx4 v[160:163], v6, s[36:39], s65 offen offset:2048 sc1
    v_mfma_f32_16x16x32_bf16 v[56:59], v[184:187], v[124:127], v[56:59]
    buffer_load_dwordx4 v[164:167], v6, s[36:39], s65 offen offset:3072 sc1
    v_mfma_f32_16x16x32_bf16 v[60:63], v[188:191], v[124:127], v[60:63]
    s_add_u32 s65, s65, 4096
    buffer_load_dwordx4 v[168:171], v6, s[36:39], s65 offen offset:0 sc1
    v_mfma_f32_16x16x32_bf16 v[64:67], v[172:175], v[128:131], v[64:67]
    v_mfma_f32_16x16x32_bf16 v[68:71], v[176:179], v[128:131], v[68:71]
    v_mfma_f32_16x16x32_bf16 v[72:75], v[180:183], v[128:131], v[72:75]
    v_mfma_f32_16x16x32_bf16 v[76:79], v[184:187], v[128:131], v[76:79]
    v_mfma_f32_16x16x32_bf16 v[80:83], v[188:191], v[128:131], v[80:83]
    v_mfma_f32_16x16x32_bf16 v[84:87], v[172:175], v[132:135], v[84:87]
    v_mfma_f32_16x16x32_bf16 v[88:91], v[176:179], v[132:135], v[88:91]
    v_mfma_f32_16x16x32_bf16 v[92:95], v[180:183], v[132:135], v[92:95]
    v_mfma_f32_16x16x32_bf16 v[96:99], v[184:187], v[132:135], v[96:99]
    v_mfma_f32_16x16x32_bf16 v[100:103], v[188:191], v[132:135], v[100:103]
    s_waitcnt vmcnt(9)
    v_mfma_f32_16x16x32_bf16 v[24:27], v[192:195], v[136:139], v[24:27]
    s_add_u32 s53, s75, 4
    s_cmp_ge_u32 s53, s73
    s_cselect_b32 s61, s73, 0
    s_sub_u32 s53, s53, s61
    s_add_u32 s53, s53, s69
    s_mul_i32 s53, s53, 4096
    s_add_u32 s53, s53, s77
    v_mfma_f32_16x16x32_bf16 v[28:31], v[196:199], v[136:139], v[28:31]
    buffer_load_dwordx4 v[120:123], v6, s[36:39], s53 offen offset:0 sc1
    v_mfma_f32_16x16x32_bf16 v[32:35], v[200:203], v[136:139], v[32:35]
    buffer_load_dwordx4 v[124:127], v6, s[36:39], s53 offen offset:1024 sc1
    v_mfma_f32_16x16x32_bf16 v[36:39], v[204:207], v[136:139], v[36:39]
    buffer_load_dwordx4 v[128:131], v6, s[36:39], s53 offen offset:2048 sc1
    v_mfma_f32_16x16x32_bf16 v[40:43], v[208:211], v[136:139], v[40:43]
    buffer_load_dwordx4 v[132:135], v6, s[36:39], s53 offen offset:3072 sc1
    v_mfma_f32_16x16x32_bf16 v[44:47], v[192:195], v[140:143], v[44:47]
    s_add_u32 s65, s75, 6
    s_cmp_ge_u32 s65, s73
    s_cselect_b32 s61, s73, 0
    s_sub_u32 s65, s65, s61
    s_add_u32 s65, s65, s69
    s_mul_i32 s65, s65, 5120
    s_add_u32 s65, s65, s78
    s_cmp_gt_u32 s73, 6
    s_cselect_b32 s65, s65, 2130706432
    buffer_load_dwordx4 v[172:175], v6, s[36:39], s65 offen offset:0 sc1
    v_mfma_f32_16x16x32_bf16 v[48:51], v[196:199], v[140:143], v[48:51]
    buffer_load_dwordx4 v[176:179], v6, s[36:39], s65 offen offset:1024 sc1
    v_mfma_f32_16x16x32_bf16 v[52:55], v[200:203], v[140:143], v[52:55]
    buffer_load_dwordx4 v[180:183], v6, s[36:39], s65 offen offset:2048 sc1
    v_mfma_f32_16x16x32_bf16 v[56:59], v[204:207], v[140:143], v[56:59]
    buffer_load_dwordx4 v[184:187], v6, s[36:39], s65 offen offset:3072 sc1
    v_mfma_f32_16x16x32_bf16 v[60:63], v[208:211], v[140:143], v[60:63]
    s_add_u32 s65, s65, 4096
    buffer_load_dwordx4 v[188:191], v6, s[36:39], s65 offen offset:0 sc1
    v_mfma_f32_16x16x32_bf16 v[64:67], v[192:195], v[144:147], v[64:67]
    v_mfma_f32_16x16x32_bf16 v[68:71], v[196:199], v[144:147], v[68:71]
    v_mfma_f32_16x16x32_bf16 v[72:75], v[200:203], v[144:147], v[72:75]
    v_mfma_f32_16x16x32_bf16 v[76:79], v[204:207], v[144:147], v[76:79]
    v_mfma_f32_16x16x32_bf16 v[80:83], v[208:211], v[144:147], v[80:83]
    v_mfma_f32_16x16x32_bf16 v[84:87], v[192:195], v[148:151], v[84:87]
    v_mfma_f32_16x16x32_bf16 v[88:91], v[196:199], v[148:151], v[88:91]
    v_mfma_f32_16x16x32_bf16 v[92:95], v[200:203], v[148:151], v[92:95]
    v_mfma_f32_16x16x32_bf16 v[96:99], v[204:207], v[148:151], v[96:99]
    v_mfma_f32_16x16x32_bf16 v[100:103], v[208:211], v[148:151], v[100:103]
    s_waitcnt vmcnt(14)
    v_mfma_f32_16x16x32_bf16 v[24:27], v[212:215], v[104:107], v[24:27]
    s_add_u32 s53, s75, 5
    s_cmp_ge_u32 s53, s73
    s_cselect_b32 s61, s73, 0
    s_sub_u32 s53, s53, s61
    s_add_u32 s53, s53, s69
    s_mul_i32 s53, s53, 4096
    s_add_u32 s53, s53, s77
    v_mfma_f32_16x16x32_bf16 v[28:31], v[216:219], v[104:107], v[28:31]
    buffer_load_dwordx4 v[136:139], v6, s[36:39], s53 offen offset:0 sc1
    v_mfma_f32_16x16x32_bf16 v[32:35], v[220:223], v[104:107], v[32:35]
    buffer_load_dwordx4 v[140:143], v6, s[36:39], s53 offen offset:1024 sc1
    v_mfma_f32_16x16x32_bf16 v[36:39], v[224:227], v[104:107], v[36:39]
    buffer_load_dwordx4 v[144:147], v6, s[36:39], s53 offen offset:2048 sc1
    v_mfma_f32_16x16x32_bf16 v[40:43], v[228:231], v[104:107], v[40:43]
    buffer_load_dwordx4 v[148:151], v6, s[36:39], s53 offen offset:3072 sc1
    v_mfma_f32_16x16x32_bf16 v[44:47], v[212:215], v[108:111], v[44:47]
    v_mfma_f32_16x16x32_bf16 v[48:51], v[216:219], v[108:111], v[48:51]
    v_mfma_f32_16x16x32_bf16 v[52:55], v[220:223], v[108:111], v[52:55]
    v_mfma_f32_16x16x32_bf16 v[56:59], v[224:227], v[108:111], v[56:59]
    v_mfma_f32_16x16x32_bf16 v[60:63], v[228:231], v[108:111], v[60:63]
    v_mfma_f32_16x16x32_bf16 v[64:67], v[212:215], v[112:115], v[64:67]
    v_mfma_f32_16x16x32_bf16 v[68:71], v[216:219], v[112:115], v[68:71]
    v_mfma_f32_16x16x32_bf16 v[72:75], v[220:223], v[112:115], v[72:75]
    v_mfma_f32_16x16x32_bf16 v[76:79], v[224:227], v[112:115], v[76:79]
    v_mfma_f32_16x16x32_bf16 v[80:83], v[228:231], v[112:115], v[80:83]
    v_mfma_f32_16x16x32_bf16 v[84:87], v[212:215], v[116:119], v[84:87]
    v_mfma_f32_16x16x32_bf16 v[88:91], v[216:219], v[116:119], v[88:91]
    v_mfma_f32_16x16x32_bf16 v[92:95], v[220:223], v[116:119], v[92:95]
    v_mfma_f32_16x16x32_bf16 v[96:99], v[224:227], v[116:119], v[96:99]
    v_mfma_f32_16x16x32_bf16 v[100:103], v[228:231], v[116:119], v[100:103]
    s_waitcnt vmcnt(9)
    v_mfma_f32_16x16x32_bf16 v[24:27], v[232:235], v[120:123], v[24:27]
    s_add_u32 s53, s75, 6
    s_cmp_ge_u32 s53, s73
    s_cselect_b32 s61, s73, 0
    s_sub_u32 s53, s53, s61
    s_add_u32 s53, s53, s69
    s_mul_i32 s53, s53, 4096
    s_add_u32 s53, s53, s77
    s_cmp_gt_u32 s73, 6
    s_cselect_b32 s53, s53, 2130706432
    v_mfma_f32_16x16x32_bf16 v[28:31], v[236:239], v[120:123], v[28:31]
    buffer_load_dwordx4 v[104:107], v6, s[36:39], s53 offen offset:0 sc1
    v_mfma_f32_16x16x32_bf16 v[32:35], v[240:243], v[120:123], v[32:35]
    buffer_load_dwordx4 v[108:111], v6, s[36:39], s53 offen offset:1024 sc1
    v_mfma_f32_16x16x32_bf16 v[36:39], v[244:247], v[120:123], v[36:39]
    buffer_load_dwordx4 v[112:115], v6, s[36:39], s53 offen offset:2048 sc1
    v_mfma_f32_16x16x32_bf16 v[40:43], v[248:251], v[120:123], v[40:43]
    buffer_load_dwordx4 v[116:119], v6, s[36:39], s53 offen offset:3072 sc1
    v_mfma_f32_16x16x32_bf16 v[44:47], v[232:235], v[124:127], v[44:47]
    s_lshr_b32 s57, s67, 1
    s_lshl_b32 s57, s57, 3
    s_add_u32 s57, s57, s44
    s_add_u32 s57, s57, 136
    v_or_b32 v4, s57, v1
    v_lshlrev_b32 v4, 7, v4
    s_mov_b64 exec, 3
    global_load_dword v5, v4, s[10:11] sc1
    s_mov_b64 exec, -1
    v_mfma_f32_16x16x32_bf16 v[48:51], v[236:239], v[124:127], v[48:51]
    v_mfma_f32_16x16x32_bf16 v[52:55], v[240:243], v[124:127], v[52:55]
    v_mfma_f32_16x16x32_bf16 v[56:59], v[244:247], v[124:127], v[56:59]
    v_mfma_f32_16x16x32_bf16 v[60:63], v[248:251], v[124:127], v[60:63]
    v_mfma_f32_16x16x32_bf16 v[64:67], v[232:235], v[128:131], v[64:67]
    v_mfma_f32_16x16x32_bf16 v[68:71], v[236:239], v[128:131], v[68:71]
    v_mfma_f32_16x16x32_bf16 v[72:75], v[240:243], v[128:131], v[72:75]
    v_mfma_f32_16x16x32_bf16 v[76:79], v[244:247], v[128:131], v[76:79]
    v_mfma_f32_16x16x32_bf16 v[80:83], v[248:251], v[128:131], v[80:83]
    v_mfma_f32_16x16x32_bf16 v[84:87], v[232:235], v[132:135], v[84:87]
    v_mfma_f32_16x16x32_bf16 v[88:91], v[236:239], v[132:135], v[88:91]
    v_mfma_f32_16x16x32_bf16 v[92:95], v[240:243], v[132:135], v[92:95]
    v_mfma_f32_16x16x32_bf16 v[96:99], v[244:247], v[132:135], v[96:99]
    v_mfma_f32_16x16x32_bf16 v[100:103], v[248:251], v[132:135], v[100:103]
    s_waitcnt vmcnt(5)
    v_mfma_f32_16x16x32_bf16 v[24:27], v[152:155], v[136:139], v[24:27]
    s_mul_i32 s66, s68, 160
    v_mfma_f32_16x16x32_bf16 v[28:31], v[156:159], v[136:139], v[28:31]
    buffer_load_dwordx2 v[120:121], v7, s[28:31], 0 offen
    v_mfma_f32_16x16x32_bf16 v[32:35], v[160:163], v[136:139], v[32:35]
    buffer_load_dwordx2 v[126:127], v21, s[96:99], s66 offen
    v_mfma_f32_16x16x32_bf16 v[36:39], v[164:167], v[136:139], v[36:39]
    buffer_load_dwordx2 v[122:123], v8, s[28:31], 0 offen
    v_mfma_f32_16x16x32_bf16 v[40:43], v[168:171], v[136:139], v[40:43]
    buffer_load_dwordx2 v[128:129], v22, s[96:99], s66 offen
    v_mfma_f32_16x16x32_bf16 v[44:47], v[152:155], v[140:143], v[44:47]
    buffer_load_dwordx2 v[124:125], v9, s[28:31], 0 offen
    v_mfma_f32_16x16x32_bf16 v[48:51], v[156:159], v[140:143], v[48:51]
    buffer_load_dwordx2 v[130:131], v23, s[96:99], s66 offen
    v_mfma_f32_16x16x32_bf16 v[52:55], v[160:163], v[140:143], v[52:55]
    v_mfma_f32_16x16x32_bf16 v[56:59], v[164:167], v[140:143], v[56:59]
    v_mfma_f32_16x16x32_bf16 v[60:63], v[168:171], v[140:143], v[60:63]
    v_mfma_f32_16x16x32_bf16 v[64:67], v[152:155], v[144:147], v[64:67]
    v_mfma_f32_16x16x32_bf16 v[68:71], v[156:159], v[144:147], v[68:71]
    v_mfma_f32_16x16x32_bf16 v[72:75], v[160:163], v[144:147], v[72:75]
    v_mfma_f32_16x16x32_bf16 v[76:79], v[164:167], v[144:147], v[76:79]
    v_mfma_f32_16x16x32_bf16 v[80:83], v[168:171], v[144:147], v[80:83]
    v_mfma_f32_16x16x32_bf16 v[84:87], v[152:155], v[148:151], v[84:87]
    v_mfma_f32_16x16x32_bf16 v[88:91], v[156:159], v[148:151], v[88:91]
    v_mfma_f32_16x16x32_bf16 v[92:95], v[160:163], v[148:151], v[92:95]
    v_mfma_f32_16x16x32_bf16 v[96:99], v[164:167], v[148:151], v[96:99]
    v_mfma_f32_16x16x32_bf16 v[100:103], v[168:171], v[148:151], v[100:103]
    s_waitcnt vmcnt(7)
    ds_read_b128 v[152:155], v20 offset:0
    ds_read_b128 v[156:159], v20 offset:1024
    ds_read_b128 v[160:163], v20 offset:2048
    ds_read_b128 v[164:167], v20 offset:3072
    ds_read_b128 v[168:171], v20 offset:4096
    s_waitcnt vmcnt(6)
    s_mov_b32 s64, 0
    v_cmp_gt_u32 vcc, 4, v5
    s_nop 0
    s_and_b32 s57, vcc_lo, 3
    s_cbranch_scc1 OT_28
    s_mov_b32 s64, 1
    s_add_u32 s53, s76, 0
    s_cmp_ge_u32 s53, s74
    s_cselect_b32 s61, s74, 0
    s_sub_u32 s53, s53, s61
    s_add_u32 s53, s53, s72
    s_mul_i32 s53, s53, 4096
    s_add_u32 s53, s53, s77
    buffer_load_dwordx4 v[192:195], v6, s[36:39], s53 offen offset:0 sc1
    buffer_load_dwordx4 v[196:199], v6, s[36:39], s53 offen offset:1024 sc1
    buffer_load_dwordx4 v[200:203], v6, s[36:39], s53 offen offset:2048 sc1
    buffer_load_dwordx4 v[204:207], v6, s[36:39], s53 offen offset:3072 sc1
    s_add_u32 s53, s76, 1
    s_cmp_ge_u32 s53, s74
    s_cselect_b32 s61, s74, 0
    s_sub_u32 s53, s53, s61
    s_add_u32 s53, s53, s72
    s_mul_i32 s53, s53, 4096
    s_add_u32 s53, s53, s77
    buffer_load_dwordx4 v[212:215], v6, s[36:39], s53 offen offset:0 sc1
    buffer_load_dwordx4 v[216:219], v6, s[36:39], s53 offen offset:1024 sc1
    buffer_load_dwordx4 v[220:223], v6, s[36:39], s53 offen offset:2048 sc1
    buffer_load_dwordx4 v[224:227], v6, s[36:39], s53 offen offset:3072 sc1
    s_add_u32 s53, s76, 2
    s_cmp_ge_u32 s53, s74
    s_cselect_b32 s61, s74, 0
    s_sub_u32 s53, s53, s61
    s_add_u32 s53, s53, s72
    s_mul_i32 s53, s53, 4096
    s_add_u32 s53, s53, s77
    s_cmp_gt_u32 s74, 2
    s_cselect_b32 s53, s53, 2130706432
    buffer_load_dwordx4 v[232:235], v6, s[36:39], s53 offen offset:0 sc1
    buffer_load_dwordx4 v[236:239], v6, s[36:39], s53 offen offset:1024 sc1
    buffer_load_dwordx4 v[240:243], v6, s[36:39], s53 offen offset:2048 sc1
    buffer_load_dwordx4 v[244:247], v6, s[36:39], s53 offen offset:3072 sc1
OT_28:
    s_cmp_gt_u32 s73, 6
    s_cbranch_scc0 OPT_29
    v_mfma_f32_16x16x32_bf16 v[24:27], v[172:175], v[104:107], v[24:27]
    v_mfma_f32_16x16x32_bf16 v[28:31], v[176:179], v[104:107], v[28:31]
    v_mfma_f32_16x16x32_bf16 v[32:35], v[180:183], v[104:107], v[32:35]
    v_mfma_f32_16x16x32_bf16 v[36:39], v[184:187], v[104:107], v[36:39]
    v_mfma_f32_16x16x32_bf16 v[40:43], v[188:191], v[104:107], v[40:43]
    v_mfma_f32_16x16x32_bf16 v[44:47], v[172:175], v[108:111], v[44:47]
    v_mfma_f32_16x16x32_bf16 v[48:51], v[176:179], v[108:111], v[48:51]
    v_mfma_f32_16x16x32_bf16 v[52:55], v[180:183], v[108:111], v[52:55]
    v_mfma_f32_16x16x32_bf16 v[56:59], v[184:187], v[108:111], v[56:59]
    v_mfma_f32_16x16x32_bf16 v[60:63], v[188:191], v[108:111], v[60:63]
    v_mfma_f32_16x16x32_bf16 v[64:67], v[172:175], v[112:115], v[64:67]
    v_mfma_f32_16x16x32_bf16 v[68:71], v[176:179], v[112:115], v[68:71]
    v_mfma_f32_16x16x32_bf16 v[72:75], v[180:183], v[112:115], v[72:75]
    v_mfma_f32_16x16x32_bf16 v[76:79], v[184:187], v[112:115], v[76:79]
    v_mfma_f32_16x16x32_bf16 v[80:83], v[188:191], v[112:115], v[80:83]
    v_mfma_f32_16x16x32_bf16 v[84:87], v[172:175], v[116:119], v[84:87]
    v_mfma_f32_16x16x32_bf16 v[88:91], v[176:179], v[116:119], v[88:91]
    v_mfma_f32_16x16x32_bf16 v[92:95], v[180:183], v[116:119], v[92:95]
    v_mfma_f32_16x16x32_bf16 v[96:99], v[184:187], v[116:119], v[96:99]
    v_mfma_f32_16x16x32_bf16 v[100:103], v[188:191], v[116:119], v[100:103]
OPT_29:
    ds_read_b128 v[172:175], v20 offset:5120
    ds_read_b128 v[176:179], v20 offset:6144
    ds_read_b128 v[180:183], v20 offset:7168
    ds_read_b128 v[184:187], v20 offset:8192
    ds_read_b128 v[188:191], v20 offset:9216
    s_cmp_eq_u32 s64, 1
    s_cbranch_scc1 OW_30
    s_lshr_b32 s57, s67, 1
    s_lshl_b32 s57, s57, 3
    s_add_u32 s57, s57, s44
    s_add_u32 s57, s57, 136
    v_or_b32 v4, s57, v1
    v_lshlrev_b32 v4, 7, v4
    s_mov_b64 exec, 3
    global_load_dword v5, v4, s[10:11] sc1
    s_waitcnt vmcnt(0)
    v_cmp_gt_u32 vcc, 4, v5
    s_nop 0
    s_cmp_eq_u64 vcc, 0
    s_cbranch_scc0 PL_31
PB_32:
    s_mov_b64 exec, -1
    s_add_u32 s53, s76, 0
    s_cmp_ge_u32 s53, s74
    s_cselect_b32 s61, s74, 0
    s_sub_u32 s53, s53, s61
    s_add_u32 s53, s53, s72
    s_mul_i32 s53, s53, 4096
    s_add_u32 s53, s53, s77
    buffer_load_dwordx4 v[192:195], v6, s[36:39], s53 offen offset:0 sc1
    buffer_load_dwordx4 v[196:199], v6, s[36:39], s53 offen offset:1024 sc1
    buffer_load_dwordx4 v[200:203], v6, s[36:39], s53 offen offset:2048 sc1
    buffer_load_dwordx4 v[204:207], v6, s[36:39], s53 offen offset:3072 sc1
    s_add_u32 s53, s76, 1
    s_cmp_ge_u32 s53, s74
    s_cselect_b32 s61, s74, 0
    s_sub_u32 s53, s53, s61
    s_add_u32 s53, s53, s72
    s_mul_i32 s53, s53, 4096
    s_add_u32 s53, s53, s77
    buffer_load_dwordx4 v[212:215], v6, s[36:39], s53 offen offset:0 sc1
    buffer_load_dwordx4 v[216:219], v6, s[36:39], s53 offen offset:1024 sc1
    buffer_load_dwordx4 v[220:223], v6, s[36:39], s53 offen offset:2048 sc1
    buffer_load_dwordx4 v[224:227], v6, s[36:39], s53 offen offset:3072 sc1
    s_add_u32 s53, s76, 2
    s_cmp_ge_u32 s53, s74
    s_cselect_b32 s61, s74, 0
    s_sub_u32 s53, s53, s61
    s_add_u32 s53, s53, s72
    s_mul_i32 s53, s53, 4096
    s_add_u32 s53, s53, s77
    s_cmp_gt_u32 s74, 2
    s_cselect_b32 s53, s53, 2130706432
    buffer_load_dwordx4 v[232:235], v6, s[36:39], s53 offen offset:0 sc1
    buffer_load_dwordx4 v[236:239], v6, s[36:39], s53 offen offset:1024 sc1
    buffer_load_dwordx4 v[240:243], v6, s[36:39], s53 offen offset:2048 sc1
    buffer_load_dwordx4 v[244:247], v6, s[36:39], s53 offen offset:3072 sc1
OW_30:
    s_waitcnt vmcnt(8)
    s_waitcnt lgkmcnt(5)
    v_mfma_f32_16x16x32_bf16 v[24:27], v[152:155], v[192:195], v[24:27]
    v_mfma_f32_16x16x32_bf16 v[28:31], v[156:159], v[192:195], v[28:31]
    v_mfma_f32_16x16x32_bf16 v[32:35], v[160:163], v[192:195], v[32:35]
    v_mfma_f32_16x16x32_bf16 v[36:39], v[164:167], v[192:195], v[36:39]
    v_mfma_f32_16x16x32_bf16 v[40:43], v[168:171], v[192:195], v[40:43]
    v_mfma_f32_16x16x32_bf16 v[44:47], v[152:155], v[196:199], v[44:47]
    v_mfma_f32_16x16x32_bf16 v[48:51], v[156:159], v[196:199], v[48:51]
    v_mfma_f32_16x16x32_bf16 v[52:55], v[160:163], v[196:199], v[52:55]
    v_mfma_f32_16x16x32_bf16 v[56:59], v[164:167], v[196:199], v[56:59]
    v_mfma_f32_16x16x32_bf16 v[60:63], v[168:171], v[196:199], v[60:63]
    v_mfma_f32_16x16x32_bf16 v[64:67], v[152:155], v[200:203], v[64:67]
    v_mfma_f32_16x16x32_bf16 v[68:71], v[156:159], v[200:203], v[68:71]
    v_mfma_f32_16x16x32_bf16 v[72:75], v[160:163], v[200:203], v[72:75]
    v_mfma_f32_16x16x32_bf16 v[76:79], v[164:167], v[200:203], v[76:79]
    v_mfma_f32_16x16x32_bf16 v[80:83], v[168:171], v[200:203], v[80:83]
    v_mfma_f32_16x16x32_bf16 v[84:87], v[152:155], v[204:207], v[84:87]
    v_mfma_f32_16x16x32_bf16 v[88:91], v[156:159], v[204:207], v[88:91]
    v_mfma_f32_16x16x32_bf16 v[92:95], v[160:163], v[204:207], v[92:95]
    v_mfma_f32_16x16x32_bf16 v[96:99], v[164:167], v[204:207], v[96:99]
    v_mfma_f32_16x16x32_bf16 v[100:103], v[168:171], v[204:207], v[100:103]
    ds_read_b128 v[152:155], v20 offset:10240
    ds_read_b128 v[156:159], v20 offset:11264
    ds_read_b128 v[160:163], v20 offset:12288
    ds_read_b128 v[164:167], v20 offset:13312
    ds_read_b128 v[168:171], v20 offset:14336
    s_cmp_gt_u32 s74, 2
    s_cbranch_scc1 P2_THREE
    s_waitcnt lgkmcnt(0)
    s_waitcnt vmcnt(4)
    v_mfma_f32_16x16x32_bf16 v[24:27], v[172:175], v[212:215], v[24:27]
    v_mfma_f32_16x16x32_bf16 v[28:31], v[176:179], v[212:215], v[28:31]
    v_mfma_f32_16x16x32_bf16 v[32:35], v[180:183], v[212:215], v[32:35]
    v_mfma_f32_16x16x32_bf16 v[36:39], v[184:187], v[212:215], v[36:39]
    v_mfma_f32_16x16x32_bf16 v[40:43], v[188:191], v[212:215], v[40:43]
    v_mfma_f32_16x16x32_bf16 v[44:47], v[172:175], v[216:219], v[44:47]
    v_mfma_f32_16x16x32_bf16 v[48:51], v[176:179], v[216:219], v[48:51]
    v_mfma_f32_16x16x32_bf16 v[52:55], v[180:183], v[216:219], v[52:55]
    v_mfma_f32_16x16x32_bf16 v[56:59], v[184:187], v[216:219], v[56:59]
    ds_write_b128 v13, v[24:27] offset:0
    v_mfma_f32_16x16x32_bf16 v[60:63], v[188:191], v[216:219], v[60:63]
    ds_write_b128 v13, v[28:31] offset:64
    v_mfma_f32_16x16x32_bf16 v[64:67], v[172:175], v[220:223], v[64:67]
    ds_write_b128 v13, v[32:35] offset:128
    v_mfma_f32_16x16x32_bf16 v[68:71], v[176:179], v[220:223], v[68:71]
    ds_write_b128 v13, v[36:39] offset:192
    v_mfma_f32_16x16x32_bf16 v[72:75], v[180:183], v[220:223], v[72:75]
    ds_write_b128 v13, v[40:43] offset:256
    v_mfma_f32_16x16x32_bf16 v[76:79], v[184:187], v[220:223], v[76:79]
    ds_write_b128 v13, v[44:47] offset:5120
    v_mfma_f32_16x16x32_bf16 v[80:83], v[188:191], v[220:223], v[80:83]
    ds_write_b128 v13, v[48:51] offset:5184
    v_mfma_f32_16x16x32_bf16 v[84:87], v[172:175], v[224:227], v[84:87]
    ds_write_b128 v13, v[52:55] offset:5248
    v_mfma_f32_16x16x32_bf16 v[88:91], v[176:179], v[224:227], v[88:91]
    ds_write_b128 v13, v[56:59] offset:5312
    v_mfma_f32_16x16x32_bf16 v[92:95], v[180:183], v[224:227], v[92:95]
    ds_write_b128 v13, v[60:63] offset:5376
    v_mfma_f32_16x16x32_bf16 v[96:99], v[184:187], v[224:227], v[96:99]
    ds_write_b128 v13, v[64:67] offset:10240
    v_mfma_f32_16x16x32_bf16 v[100:103], v[188:191], v[224:227], v[100:103]
    ds_write_b128 v13, v[68:71] offset:10304
    ds_write_b128 v13, v[72:75] offset:10368
    ds_write_b128 v13, v[76:79] offset:10432
    ds_write_b128 v13, v[80:83] offset:10496
    ds_write_b128 v13, v[84:87] offset:15360
    ds_write_b128 v13, v[88:91] offset:15424
    ds_write_b128 v13, v[92:95] offset:15488
    ds_write_b128 v13, v[96:99] offset:15552
    ds_write_b128 v13, v[100:103] offset:15616
    s_branch P2_RED
P2_THREE:
    s_waitcnt vmcnt(4)
    s_waitcnt lgkmcnt(5)
    v_mfma_f32_16x16x32_bf16 v[24:27], v[172:175], v[212:215], v[24:27]
    v_mfma_f32_16x16x32_bf16 v[28:31], v[176:179], v[212:215], v[28:31]
    v_mfma_f32_16x16x32_bf16 v[32:35], v[180:183], v[212:215], v[32:35]
    v_mfma_f32_16x16x32_bf16 v[36:39], v[184:187], v[212:215], v[36:39]
    v_mfma_f32_16x16x32_bf16 v[40:43], v[188:191], v[212:215], v[40:43]
    v_mfma_f32_16x16x32_bf16 v[44:47], v[172:175], v[216:219], v[44:47]
    v_mfma_f32_16x16x32_bf16 v[48:51], v[176:179], v[216:219], v[48:51]
    v_mfma_f32_16x16x32_bf16 v[52:55], v[180:183], v[216:219], v[52:55]
    v_mfma_f32_16x16x32_bf16 v[56:59], v[184:187], v[216:219], v[56:59]
    v_mfma_f32_16x16x32_bf16 v[60:63], v[188:191], v[216:219], v[60:63]
    v_mfma_f32_16x16x32_bf16 v[64:67], v[172:175], v[220:223], v[64:67]
    v_mfma_f32_16x16x32_bf16 v[68:71], v[176:179], v[220:223], v[68:71]
    v_mfma_f32_16x16x32_bf16 v[72:75], v[180:183], v[220:223], v[72:75]
    v_mfma_f32_16x16x32_bf16 v[76:79], v[184:187], v[220:223], v[76:79]
    v_mfma_f32_16x16x32_bf16 v[80:83], v[188:191], v[220:223], v[80:83]
    v_mfma_f32_16x16x32_bf16 v[84:87], v[172:175], v[224:227], v[84:87]
    v_mfma_f32_16x16x32_bf16 v[88:91], v[176:179], v[224:227], v[88:91]
    v_mfma_f32_16x16x32_bf16 v[92:95], v[180:183], v[224:227], v[92:95]
    v_mfma_f32_16x16x32_bf16 v[96:99], v[184:187], v[224:227], v[96:99]
    v_mfma_f32_16x16x32_bf16 v[100:103], v[188:191], v[224:227], v[100:103]
    s_waitcnt lgkmcnt(0)
    s_waitcnt vmcnt(0)
    v_mfma_f32_16x16x32_bf16 v[24:27], v[152:155], v[232:235], v[24:27]
    v_mfma_f32_16x16x32_bf16 v[28:31], v[156:159], v[232:235], v[28:31]
    v_mfma_f32_16x16x32_bf16 v[32:35], v[160:163], v[232:235], v[32:35]
    v_mfma_f32_16x16x32_bf16 v[36:39], v[164:167], v[232:235], v[36:39]
    v_mfma_f32_16x16x32_bf16 v[40:43], v[168:171], v[232:235], v[40:43]
    v_mfma_f32_16x16x32_bf16 v[44:47], v[152:155], v[236:239], v[44:47]
    v_mfma_f32_16x16x32_bf16 v[48:51], v[156:159], v[236:239], v[48:51]
    v_mfma_f32_16x16x32_bf16 v[52:55], v[160:163], v[236:239], v[52:55]
    v_mfma_f32_16x16x32_bf16 v[56:59], v[164:167], v[236:239], v[56:59]
    ds_write_b128 v13, v[24:27] offset:0
    v_mfma_f32_16x16x32_bf16 v[60:63], v[168:171], v[236:239], v[60:63]
    ds_write_b128 v13, v[28:31] offset:64
    v_mfma_f32_16x16x32_bf16 v[64:67], v[152:155], v[240:243], v[64:67]
    ds_write_b128 v13, v[32:35] offset:128
    v_mfma_f32_16x16x32_bf16 v[68:71], v[156:159], v[240:243], v[68:71]
    ds_write_b128 v13, v[36:39] offset:192
    v_mfma_f32_16x16x32_bf16 v[72:75], v[160:163], v[240:243], v[72:75]
    ds_write_b128 v13, v[40:43] offset:256
    v_mfma_f32_16x16x32_bf16 v[76:79], v[164:167], v[240:243], v[76:79]
    ds_write_b128 v13, v[44:47] offset:5120
    v_mfma_f32_16x16x32_bf16 v[80:83], v[168:171], v[240:243], v[80:83]
    ds_write_b128 v13, v[48:51] offset:5184
    v_mfma_f32_16x16x32_bf16 v[84:87], v[152:155], v[244:247], v[84:87]
    ds_write_b128 v13, v[52:55] offset:5248
    v_mfma_f32_16x16x32_bf16 v[88:91], v[156:159], v[244:247], v[88:91]
    ds_write_b128 v13, v[56:59] offset:5312
    v_mfma_f32_16x16x32_bf16 v[92:95], v[160:163], v[244:247], v[92:95]
    ds_write_b128 v13, v[60:63] offset:5376
    v_mfma_f32_16x16x32_bf16 v[96:99], v[164:167], v[244:247], v[96:99]
    ds_write_b128 v13, v[64:67] offset:10240
    v_mfma_f32_16x16x32_bf16 v[100:103], v[168:171], v[244:247], v[100:103]
    ds_write_b128 v13, v[68:71] offset:10304
    ds_write_b128 v13, v[72:75] offset:10368
    ds_write_b128 v13, v[76:79] offset:10432
    ds_write_b128 v13, v[80:83] offset:10496
    ds_write_b128 v13, v[84:87] offset:15360
    ds_write_b128 v13, v[88:91] offset:15424
    ds_write_b128 v13, v[92:95] offset:15488
    ds_write_b128 v13, v[96:99] offset:15552
    ds_write_b128 v13, v[100:103] offset:15616
P2_RED:
    s_waitcnt vmcnt(0)
    s_waitcnt lgkmcnt(0)
    s_barrier
    v_add_u32 v112, 81920, v10
    ds_read_b128 v[24:27], v10 offset:0
    ds_read_b128 v[28:31], v10 offset:20480
    ds_read_b128 v[32:35], v10 offset:40960
    ds_read_b128 v[36:39], v10 offset:61440
    ds_read_b128 v[40:43], v112 offset:0
    ds_read_b128 v[44:47], v112 offset:20480
    ds_read_b128 v[48:51], v112 offset:40960
    ds_read_b128 v[52:55], v112 offset:61440
    v_add_u32 v112, 81920, v11
    ds_read_b128 v[56:59], v11 offset:0
    ds_read_b128 v[60:63], v11 offset:20480
    ds_read_b128 v[64:67], v11 offset:40960
    ds_read_b128 v[68:71], v11 offset:61440
    ds_read_b128 v[72:75], v112 offset:0
    ds_read_b128 v[76:79], v112 offset:20480
    ds_read_b128 v[80:83], v112 offset:40960
    s_waitcnt lgkmcnt(7)
    ds_read_b128 v[84:87], v112 offset:61440
    s_cmp_ge_u32 s44, 4
    s_cbranch_scc1 R2_33
    s_waitcnt lgkmcnt(7)
    v_add_u32 v113, 81920, v12
    ds_read_b128 v[152:155], v12 offset:0
    ds_read_b128 v[156:159], v12 offset:20480
    ds_read_b128 v[160:163], v12 offset:40960
    ds_read_b128 v[164:167], v12 offset:61440
    ds_read_b128 v[168:171], v113 offset:0
    ds_read_b128 v[172:175], v113 offset:20480
    ds_read_b128 v[176:179], v113 offset:40960
    ds_read_b128 v[180:183], v113 offset:61440
R2_33:
    v_lshlrev_b32 v104, 16, v120
    v_and_b32 v105, 0xffff0000, v120
    v_lshlrev_b32 v106, 16, v121
    v_and_b32 v107, 0xffff0000, v121
    v_lshlrev_b32 v108, 16, v126
    v_and_b32 v109, 0xffff0000, v126
    v_lshlrev_b32 v110, 16, v127
    v_and_b32 v111, 0xffff0000, v127
    v_pk_add_f32 v[104:105], v[104:105], v[108:109]
    v_pk_add_f32 v[106:107], v[106:107], v[110:111]
    v_pk_add_f32 v[104:105], v[104:105], v[24:25]
    v_pk_add_f32 v[106:107], v[106:107], v[26:27]
    v_pk_add_f32 v[104:105], v[104:105], v[28:29]
    v_pk_add_f32 v[106:107], v[106:107], v[30:31]
    v_pk_add_f32 v[104:105], v[104:105], v[32:33]
    v_pk_add_f32 v[106:107], v[106:107], v[34:35]
    v_pk_add_f32 v[104:105], v[104:105], v[36:37]
    v_pk_add_f32 v[106:107], v[106:107], v[38:39]
    v_pk_add_f32 v[104:105], v[104:105], v[40:41]
    v_pk_add_f32 v[106:107], v[106:107], v[42:43]
    v_pk_add_f32 v[104:105], v[104:105], v[44:45]
    v_pk_add_f32 v[106:107], v[106:107], v[46:47]
    v_pk_add_f32 v[104:105], v[104:105], v[48:49]
    v_pk_add_f32 v[106:107], v[106:107], v[50:51]
    v_pk_add_f32 v[104:105], v[104:105], v[52:53]
    v_pk_add_f32 v[106:107], v[106:107], v[54:55]
    v_cvt_pk_bf16_f32 v114, v104, v105
    v_cvt_pk_bf16_f32 v115, v106, v107
    buffer_store_dwordx2 v[114:115], v7, s[40:43], 0 offen
    v_lshlrev_b32 v104, 16, v122
    v_and_b32 v105, 0xffff0000, v122
    v_lshlrev_b32 v106, 16, v123
    v_and_b32 v107, 0xffff0000, v123
    v_lshlrev_b32 v108, 16, v128
    v_and_b32 v109, 0xffff0000, v128
    v_lshlrev_b32 v110, 16, v129
    v_and_b32 v111, 0xffff0000, v129
    v_pk_add_f32 v[104:105], v[104:105], v[108:109]
    v_pk_add_f32 v[106:107], v[106:107], v[110:111]
    s_waitcnt lgkmcnt(7)
    v_pk_add_f32 v[104:105], v[104:105], v[56:57]
    v_pk_add_f32 v[106:107], v[106:107], v[58:59]
    s_waitcnt lgkmcnt(6)
    v_pk_add_f32 v[104:105], v[104:105], v[60:61]
    v_pk_add_f32 v[106:107], v[106:107], v[62:63]
    s_waitcnt lgkmcnt(5)
    v_pk_add_f32 v[104:105], v[104:105], v[64:65]
    v_pk_add_f32 v[106:107], v[106:107], v[66:67]
    s_waitcnt lgkmcnt(4)
    v_pk_add_f32 v[104:105], v[104:105], v[68:69]
    v_pk_add_f32 v[106:107], v[106:107], v[70:71]
    s_waitcnt lgkmcnt(3)
    v_pk_add_f32 v[104:105], v[104:105], v[72:73]
    v_pk_add_f32 v[106:107], v[106:107], v[74:75]
    s_waitcnt lgkmcnt(2)
    v_pk_add_f32 v[104:105], v[104:105], v[76:77]
    v_pk_add_f32 v[106:107], v[106:107], v[78:79]
    s_waitcnt lgkmcnt(1)
    v_pk_add_f32 v[104:105], v[104:105], v[80:81]
    v_pk_add_f32 v[106:107], v[106:107], v[82:83]
    s_waitcnt lgkmcnt(0)
    v_pk_add_f32 v[104:105], v[104:105], v[84:85]
    v_pk_add_f32 v[106:107], v[106:107], v[86:87]
    v_cvt_pk_bf16_f32 v116, v104, v105
    v_cvt_pk_bf16_f32 v117, v106, v107
    buffer_store_dwordx2 v[116:117], v8, s[40:43], 0 offen
    s_cmp_ge_u32 s44, 4
    s_cbranch_scc1 FIN
    s_waitcnt lgkmcnt(0)
    v_lshlrev_b32 v104, 16, v124
    v_and_b32 v105, 0xffff0000, v124
    v_lshlrev_b32 v106, 16, v125
    v_and_b32 v107, 0xffff0000, v125
    v_lshlrev_b32 v108, 16, v130
    v_and_b32 v109, 0xffff0000, v130
    v_lshlrev_b32 v110, 16, v131
    v_and_b32 v111, 0xffff0000, v131
    v_pk_add_f32 v[104:105], v[104:105], v[108:109]
    v_pk_add_f32 v[106:107], v[106:107], v[110:111]
    v_pk_add_f32 v[104:105], v[104:105], v[152:153]
    v_pk_add_f32 v[106:107], v[106:107], v[154:155]
    v_pk_add_f32 v[104:105], v[104:105], v[156:157]
    v_pk_add_f32 v[106:107], v[106:107], v[158:159]
    v_pk_add_f32 v[104:105], v[104:105], v[160:161]
    v_pk_add_f32 v[106:107], v[106:107], v[162:163]
    v_pk_add_f32 v[104:105], v[104:105], v[164:165]
    v_pk_add_f32 v[106:107], v[106:107], v[166:167]
    v_pk_add_f32 v[104:105], v[104:105], v[168:169]
    v_pk_add_f32 v[106:107], v[106:107], v[170:171]
    v_pk_add_f32 v[104:105], v[104:105], v[172:173]
    v_pk_add_f32 v[106:107], v[106:107], v[174:175]
    v_pk_add_f32 v[104:105], v[104:105], v[176:177]
    v_pk_add_f32 v[106:107], v[106:107], v[178:179]
    v_pk_add_f32 v[104:105], v[104:105], v[180:181]
    v_pk_add_f32 v[106:107], v[106:107], v[182:183]
    v_cvt_pk_bf16_f32 v118, v104, v105
    v_cvt_pk_bf16_f32 v119, v106, v107
    buffer_store_dwordx2 v[118:119], v9, s[40:43], 0 offen
FIN:
END:
    s_endpgm
PL_4:
    s_mov_b32 s61, 0
PL_34:
    s_sleep 4
    global_load_dword v5, v4, s[10:11] sc1
    s_waitcnt vmcnt(0)
    v_readfirstlane_b32 s57, v5
    s_nop 0
    s_cmp_ge_u32 s57, 16
    s_cbranch_scc1 PB_5
    s_add_u32 s61, s61, 1
    s_cmp_lt_u32 s61, 0x20000
    s_cbranch_scc1 PL_34
    v_mov_b32 v5, 258
    global_store_dword v2, v5, s[22:23] offset:32
    s_branch PB_5
PL_6:
    s_mov_b32 s61, 0
PL_35:
    s_sleep 1
    ds_read_b32 v5, v4 offset:0
    s_waitcnt lgkmcnt(0)
    v_readfirstlane_b32 s57, v5
    s_nop 0
    s_cmp_ge_u32 s57, 1
    s_cbranch_scc1 PB_7
    s_add_u32 s61, s61, 1
    s_cmp_lt_u32 s61, 0x20000
    s_cbranch_scc1 PL_35
    v_mov_b32 v5, 265
    global_store_dword v2, v5, s[22:23] offset:32
    s_branch PB_7
PL_8:
    s_mov_b32 s61, 0
PL_36:
    s_sleep 1
    ds_read_b32 v5, v4 offset:4
    s_waitcnt lgkmcnt(0)
    v_readfirstlane_b32 s57, v5
    s_nop 0
    s_cmp_ge_u32 s57, 4
    s_cbranch_scc1 PB_9
    s_add_u32 s61, s61, 1
    s_cmp_lt_u32 s61, 0x20000
    s_cbranch_scc1 PL_36
    v_mov_b32 v5, 266
    global_store_dword v2, v5, s[22:23] offset:32
    s_branch PB_9
PL_10:
    s_mov_b32 s61, 0
PL_37:
    s_sleep 3
    global_load_dword v5, v4, s[10:11] sc1
    s_waitcnt vmcnt(0)
    v_cmp_gt_u32 vcc, 1, v5
    s_nop 0
    s_cmp_eq_u64 vcc, 0
    s_cbranch_scc1 PB_11
    s_add_u32 s61, s61, 1
    s_cmp_lt_u32 s61, 0x20000
    s_cbranch_scc1 PL_37
    v_mov_b32 v5, 267
    global_store_dword v2, v5, s[22:23] offset:32
    s_branch PB_11
PL_14:
    s_mov_b32 s61, 0
PL_38:
    s_sleep 8
    global_load_dword v148, v2, s[22:23] sc1
    s_waitcnt vmcnt(0)
    v_readfirstlane_b32 s65, v148
    s_nop 0
    s_cmp_ge_u32 s65, 32
    s_cbranch_scc1 PB_15
    s_add_u32 s61, s61, 1
    s_cmp_lt_u32 s61, 0x20000
    s_cbranch_scc1 PL_38
    v_mov_b32 v5, 257
    global_store_dword v2, v5, s[22:23] offset:32
    s_branch PB_15
PL_16:
    s_mov_b32 s61, 0
PL_39:
    s_sleep 8
    s_mov_b32 exec_lo, -1
    s_mov_b32 exec_hi, 0
    global_load_dword v217, v216, s[10:11] sc1
    s_mov_b64 exec, -1
    s_waitcnt vmcnt(0)
    v_cmp_gt_u32 vcc, 8, v217
    s_nop 0
    s_cmp_eq_u64 vcc, 0
    s_cbranch_scc1 PB_17
    s_add_u32 s61, s61, 1
    s_cmp_lt_u32 s61, 0x20000
    s_cbranch_scc1 PL_39
    v_mov_b32 v5, 260
    global_store_dword v2, v5, s[22:23] offset:32
    s_branch PB_17
PL_22:
    s_mov_b32 s61, 0
PL_40:
    s_sleep 8
    global_load_dword v148, v2, s[22:23] sc1
    s_waitcnt vmcnt(0)
    v_readfirstlane_b32 s65, v148
    s_nop 0
    s_cmp_ge_u32 s65, 32
    s_cbranch_scc1 PB_23
    s_add_u32 s61, s61, 1
    s_cmp_lt_u32 s61, 0x20000
    s_cbranch_scc1 PL_40
    v_mov_b32 v5, 257
    global_store_dword v2, v5, s[22:23] offset:32
    s_branch PB_23
PL_24:
    s_mov_b32 s61, 0
PL_41:
    s_sleep 8
    s_mov_b32 exec_lo, -1
    s_mov_b32 exec_hi, 0
    global_load_dword v217, v216, s[10:11] sc1
    s_mov_b64 exec, -1
    s_waitcnt vmcnt(0)
    v_cmp_gt_u32 vcc, 8, v217
    s_nop 0
    s_cmp_eq_u64 vcc, 0
    s_cbranch_scc1 PB_25
    s_add_u32 s61, s61, 1
    s_cmp_lt_u32 s61, 0x20000
    s_cbranch_scc1 PL_41
    v_mov_b32 v5, 260
    global_store_dword v2, v5, s[22:23] offset:32
    s_branch PB_25
PL_26:
    s_mov_b32 s61, 0
PL_42:
    s_sleep 3
    global_load_dword v5, v4, s[10:11] sc1
    s_waitcnt vmcnt(0)
    v_cmp_gt_u32 vcc, 1, v5
    s_nop 0
    s_cmp_eq_u64 vcc, 0
    s_cbranch_scc1 PB_27
    s_add_u32 s61, s61, 1
    s_cmp_lt_u32 s61, 0x20000
    s_cbranch_scc1 PL_42
    v_mov_b32 v5, 261
    global_store_dword v2, v5, s[22:23] offset:32
    s_branch PB_27
PL_31:
    s_mov_b32 s61, 0
PL_43:
    s_sleep 3
    global_load_dword v5, v4, s[10:11] sc1
    s_waitcnt vmcnt(0)
    v_cmp_gt_u32 vcc, 4, v5
    s_nop 0
    s_cmp_eq_u64 vcc, 0
    s_cbranch_scc1 PB_32
    s_add_u32 s61, s61, 1
    s_cmp_lt_u32 s61, 0x20000
    s_cbranch_scc1 PL_43
    v_mov_b32 v5, 262
    global_store_dword v2, v5, s[22:23] offset:32
    s_branch PB_32
CODE_END:
    s_endpgm
.section .rodata,"a"
.p2align 6
.amdhsa_kernel parallel_sum__linear_attn_block__mixer_channel_mlp__prompt_kernel
  .amdhsa_next_free_vgpr 256
  .amdhsa_next_free_sgpr 102
  .amdhsa_accum_offset 256
  .amdhsa_group_segment_fixed_size 0
  .amdhsa_kernarg_size 88
  .amdhsa_user_sgpr_count 2
  .amdhsa_user_sgpr_kernarg_segment_ptr 1
  .amdhsa_system_sgpr_workgroup_id_x 1
  .amdhsa_float_denorm_mode_32 3
.end_amdhsa_kernel
```
